```python
import torch

def _softmax(x, axis=-1):
    return torch.softmax(x, dim=axis)

def _gelu(x):
    return torch.nn.functional.gelu(x, approximate='tanh')

def _silu(x):
    return torch.nn.functional.silu(x)

def _sigmoid(x):
    return torch.sigmoid(x)

def _layernorm(x, axis=-1, eps=1e-05):
    m = x.mean(dim=axis, keepdim=True)
    v = x.var(dim=axis, keepdim=True, unbiased=False)
    return (x - m) / torch.sqrt(v + eps)

def _scatter_add(tgt, idx, src, axis=0):
    return tgt.clone().index_add_(axis, idx, src)

def _segment_sum(src, seg, n):
    out = torch.zeros((n,) + src.shape[1:], dtype=src.dtype)
    return out.index_add_(0, seg, src)

def _pad(x, pw):
    flat = tuple((v for pair in reversed(pw) for v in pair))
    return torch.nn.functional.pad(x, flat)
kernel_name = 'adaLN_cond__ssm_conv_h3__geglu_ffn__prompt'

def setup_inputs():

    _w = lambda a: (lambda t: t.to(torch.bfloat16) if t.is_floating_point() else t)(torch.as_tensor(a))

    def _A_setup():
        B, S, D = (1, 2048, 576)
        ks = 4
        return {'q': _w((lambda *s: torch.randn(*s, dtype=torch.bfloat16) * 0.05)(B, S, D)), 'k': _w((lambda *s: torch.randn(*s, dtype=torch.bfloat16) * 0.8)(B, S, D)), 'v': _w((lambda *s: torch.randn(*s, dtype=torch.bfloat16) * 0.8)(B, S, D)), 'shift_k': _w((lambda *s: torch.randn(*s, dtype=torch.bfloat16) * 0.8)(D, ks) * 0.5), 'ssm_k': _w((lambda *s: torch.randn(*s, dtype=torch.bfloat16) * 0.8)(D, S) * (1.0 / S ** 0.5)), 'ssm_D': _w((lambda *s: torch.randn(*s, dtype=torch.bfloat16) * 0.8)(D))}
    _A_in = _A_setup()

    def _B_setup():
        B, S, D, F = (1, 2048, 576, 4608)
        return {'x': _w((lambda *s: torch.randn(*s, dtype=torch.bfloat16) * 0.05)(B, S, D)), 'w_gate': _w((lambda *s: torch.randn(*s, dtype=torch.bfloat16) * 0.05)(D, F)), 'w_up': _w((lambda *s: torch.randn(*s, dtype=torch.bfloat16) * 0.05)(D, F)), 'w_down': _w((lambda *s: torch.randn(*s, dtype=torch.bfloat16) * 0.05)(F, D))}
    _B_in = _B_setup()
    return {'A_q': _A_in['q'], 'A_k': _A_in['k'], 'A_v': _A_in['v'], 'A_shift_k': _A_in['shift_k'], 'A_ssm_k': _A_in['ssm_k'], 'A_ssm_D': _A_in['ssm_D'], 'B_x': _B_in['x'], 'B_w_gate': _B_in['w_gate'], 'B_w_up': _B_in['w_up'], 'B_w_down': _B_in['w_down'], 'c': _w((lambda *s: torch.randn(*s, dtype=torch.bfloat16) * 0.1)(1, 576) * 8.0), 'w_mod': _w((lambda *s: torch.randn(*s, dtype=torch.bfloat16) * 0.1)(576, 6 * 576) * 576 ** (-0.5) * 8.0)}

def reference(A_q, A_k, A_v, A_shift_k, A_ssm_k, A_ssm_D, B_x, B_w_gate, B_w_up, B_w_down, c, w_mod):

    def _A_ref(q, k, v, shift_k, ssm_k, ssm_D):
        B, S, D = q.shape
        ks = shift_k.shape[-1]
        k_pad = _pad(k, ((0, 0), (ks - 1, 0), (0, 0)))
        k_shift = torch.zeros_like(k)
        for t in range(ks):
            k_shift = k_shift + k_pad[:, t:t + S, :] * shift_k[:, ks - 1 - t][None, None, :]
        kv = k_shift * v
        L = 2 * S
        kv_pad = _pad(kv, ((0, 0), (0, S), (0, 0)))
        kf_pad = _pad(ssm_k, ((0, 0), (0, S)))
        kv_f = (lambda x, axes=(-2, -1): torch.fft.rfft2(x.float(), dim=axes))(kv_pad[:, None, :, :], axes=(1, 2))
        kf_f = (lambda x, axes=(-2, -1): torch.fft.rfft2(x.float(), dim=axes))(kf_pad[:, None, :], axes=(1, 2))
        kf_f = (lambda x, *d: x.permute(*d))(kf_f, 1, 2, 0)
        y_f = kv_f * kf_f[None, :, :, :]
        y = (lambda x, s, axes=(-2, -1): torch.fft.irfft2(x, s=s, dim=axes).to(torch.bfloat16))(y_f, (1, L), axes=(1, 2))[:, 0, :S, :]
        y = y + kv * ssm_D[None, None, :]
        return q * y

    def _B_ref(x, w_gate, w_up, w_down):
        return _gelu(x @ w_gate) * (x @ w_up) @ w_down
    x = A_q
    mod = (_silu(c) @ w_mod).reshape(c.shape[0], 6, 1, -1)
    sa, ca, ga, sb, cb, gb = (mod[:, 0].clone(), mod[:, 1].clone(), mod[:, 2].clone(), mod[:, 3].clone(), mod[:, 4].clone(), mod[:, 5].clone())
    h = _layernorm(x, axis=-1) * (1 + ca) + sa
    x = x + ga * _A_ref(h, A_k, A_v, A_shift_k, A_ssm_k, A_ssm_D)
    h = _layernorm(x, axis=-1) * (1 + cb) + sb
    x = x + gb * _B_ref(h, B_w_gate, B_w_up, B_w_down)
    return x
```

```asm
; @launch kernel=mega_kernel grid=(256,1,1) block=(256,1,1) lds=163840
.amdgcn_target "amdgcn-amd-amdhsa--gfx950"
.text
.globl mega_kernel
.p2align 8
.type mega_kernel,@function
mega_kernel:
  s_cmp_ge_u32 s2, 256
  s_cbranch_scc1 MG_exit
  s_getpc_b64 s[4:5]
MG_pc:
  v_lshlrev_b32 v250, 7, v0
  v_add_u32 v251, 0x8000, v250
  v_min_u32 v251, MG_end - MG_pc - 4, v251
  global_load_dword v252, v250, s[4:5]
  global_load_dword v253, v251, s[4:5]
  s_cmp_lt_u32 s2, 144
  s_cbranch_scc1 FM_chain
  s_cmp_lt_u32 s2, 256
  s_cbranch_scc1 FM_bg
MG_exit:
  s_endpgm
FM_bg:
  s_load_dwordx2 s[82:83], s[0:1], 0
  s_load_dwordx4 s[60:63], s[0:1], 104
  s_load_dwordx4 s[4:7], s[0:1], 56
  s_load_dwordx2 s[24:25], s[0:1], 72
  v_lshrrev_b32 v2, 6, v0
  v_and_b32 v1, 63, v0
  s_sub_u32 s76, s2, 144
  v_readfirstlane_b32 s101, v2
  v_readfirstlane_b32 s30, v2
  s_cmp_lt_u32 s76, 54
  s_cbranch_scc0 BG_a1
  s_add_u32 s77, s76, 90
  s_add_u32 s79, s76, 26
  s_cmp_lt_u32 s76, 0
  s_cselect_b32 s78, 2, 0
  s_branch BG_a3
BG_a1:
  s_sub_u32 s79, s76, 54
  s_cmp_lt_u32 s79, 32
  s_cbranch_scc0 BG_a2
  s_lshl_b32 s77, s79, 1
  s_add_u32 s79, s77, 1
  s_mov_b32 s78, 1
  s_branch BG_a3
BG_a2:
  s_add_u32 s77, s79, 32
  s_sub_u32 s79, s79, 32
  s_mov_b32 s78, 0
BG_a3:
  v_lshrrev_b32 v2, 3, v1
  v_bfe_u32 v3, v1, 1, 2
  v_and_b32 v4, 1, v1
  v_bfe_u32 v5, v1, 4, 1
  s_and_b32 s31, s30, 1
  s_lshl_b32 s31, s31, 1
  v_or_b32 v5, s31, v5
  v_xor_b32 v5, v5, v3
  v_mul_u32_u24 v6, 9216, v2
  v_lshl_add_u32 v6, v5, 5, v6
  v_lshl_add_u32 v6, v4, 4, v6
  v_bfe_u32 v5, v1, 4, 2
  v_xor_b32 v5, v5, v3
  v_mul_u32_u24 v7, 1152, v2
  v_lshl_add_u32 v7, v5, 5, v7
  v_lshl_add_u32 v7, v4, 4, v7
  v_lshrrev_b32 v8, 4, v1
  v_bfe_u32 v9, v1, 2, 2
  v_and_b32 v10, 3, v1
  v_lshrrev_b32 v11, 1, v9
  v_and_b32 v12, 1, v8
  v_lshl_or_b32 v11, v12, 1, v11
  v_xor_b32 v11, s30, v11
  v_lshl_add_u32 v12, v8, 3, v9
  v_lshlrev_b32 v12, 7, v12
  v_lshl_add_u32 v12, v11, 5, v12
  v_lshl_add_u32 v12, v10, 3, v12
  v_lshrrev_b32 v11, 1, v9
  v_lshl_add_u32 v11, v8, 1, v11
  v_and_b32 v11, 3, v11
  v_xor_b32 v11, s30, v11
  v_lshl_add_u32 v13, v8, 2, v9
  v_lshlrev_b32 v13, 7, v13
  v_lshl_add_u32 v13, v11, 5, v13
  v_lshl_add_u32 v13, v10, 3, v13
  v_lshlrev_b32 v14, 4, v1
  s_waitcnt lgkmcnt(0)
  s_mov_b32 s8, s4
  s_mov_b32 s9, s5
  s_mov_b32 s10, 5308416
  s_mov_b32 s11, 0x20000
  s_mov_b32 s12, s6
  s_mov_b32 s13, s7
  s_mov_b32 s14, 5308416
  s_mov_b32 s15, 0x20000
  s_add_u32 s20, s62, 30408704
  s_addc_u32 s21, s63, 0
  s_mov_b32 s22, 15925248
  s_mov_b32 s23, 0x20000
  s_mov_b32 s84, s82
  s_mov_b32 s85, s83
  s_mov_b32 s86, 2359296
  s_mov_b32 s87, 0x20000
  s_mov_b32 s48, s60
  s_mov_b32 s49, s61
  s_mov_b32 s50, 256
  s_mov_b32 s51, 0x20000
  s_add_u32 s44, s62, 47185920
  s_addc_u32 s45, s63, 0
  s_mov_b32 s46, 491520
  s_mov_b32 s47, 0x20000
  s_mov_b32 s60, s77
  s_mov_b32 s80, 0
  s_mul_hi_u32 s32, s60, 238609295
  s_mul_i32 s33, s32, 18
  s_sub_u32 s33, s60, s33
  s_lshl_b32 s36, s33, 5
  s_lshl_b32 s37, s30, 3
  s_add_u32 s36, s36, s37
  s_mul_i32 s36, s36, 9216
  s_mul_i32 s37, s32, 1152
  s_add_u32 s36, s36, s37
  s_lshl_b32 s38, s30, 10
  s_add_u32 s38, s38, s80
  s_add_u32 m0, s38, 0
  s_nop 0
  buffer_load_dwordx4 v6, s[8:11], s36 offen nt lds
  s_add_u32 m0, s38, 4096
  s_nop 0
  buffer_load_dwordx4 v6, s[12:15], s36 offen nt lds
  s_add_u32 m0, s38, 8192
  s_add_u32 s36, s36, 128
  buffer_load_dwordx4 v6, s[8:11], s36 offen nt lds
  s_add_u32 m0, s38, 12288
  s_nop 0
  buffer_load_dwordx4 v6, s[12:15], s36 offen nt lds
  s_add_u32 m0, s38, 16384
  s_add_u32 s36, s36, 128
  buffer_load_dwordx4 v6, s[8:11], s36 offen nt lds
  s_add_u32 m0, s38, 20480
  s_nop 0
  buffer_load_dwordx4 v6, s[12:15], s36 offen nt lds
  s_add_u32 m0, s38, 24576
  s_add_u32 s36, s36, 128
  buffer_load_dwordx4 v6, s[8:11], s36 offen nt lds
  s_add_u32 m0, s38, 28672
  s_nop 0
  buffer_load_dwordx4 v6, s[12:15], s36 offen nt lds
  s_add_u32 m0, s38, 32768
  s_add_u32 s36, s36, 128
  buffer_load_dwordx4 v6, s[8:11], s36 offen nt lds
  s_add_u32 m0, s38, 36864
  s_nop 0
  buffer_load_dwordx4 v6, s[12:15], s36 offen nt lds
  s_add_u32 m0, s38, 40960
  s_add_u32 s36, s36, 128
  buffer_load_dwordx4 v6, s[8:11], s36 offen nt lds
  s_add_u32 m0, s38, 45056
  s_nop 0
  buffer_load_dwordx4 v6, s[12:15], s36 offen nt lds
  s_add_u32 m0, s38, 49152
  s_add_u32 s36, s36, 128
  buffer_load_dwordx4 v6, s[8:11], s36 offen nt lds
  s_add_u32 m0, s38, 53248
  s_nop 0
  buffer_load_dwordx4 v6, s[12:15], s36 offen nt lds
  s_add_u32 m0, s38, 57344
  s_add_u32 s36, s36, 128
  buffer_load_dwordx4 v6, s[8:11], s36 offen nt lds
  s_add_u32 m0, s38, 61440
  s_nop 0
  buffer_load_dwordx4 v6, s[12:15], s36 offen nt lds
  s_add_u32 m0, s38, 65536
  s_add_u32 s36, s36, 128
  buffer_load_dwordx4 v6, s[8:11], s36 offen nt lds
  s_add_u32 m0, s38, 69632
  s_nop 0
  buffer_load_dwordx4 v6, s[12:15], s36 offen nt lds
  s_mul_i32 s72, s32, 1990656
  s_mul_i32 s40, s30, 497664
  s_add_u32 s72, s72, s40
  s_lshl_b32 s40, s33, 11
  s_add_u32 s72, s72, s40
  s_mov_b32 s60, s79
  s_mov_b32 s80, 73728
  s_cmp_eq_u32 s78, 0
  s_cbranch_scc1 BG_iss
  s_mul_hi_u32 s32, s60, 238609295
  s_mul_i32 s33, s32, 18
  s_sub_u32 s33, s60, s33
  s_lshl_b32 s36, s33, 5
  s_lshl_b32 s37, s30, 3
  s_add_u32 s36, s36, s37
  s_mul_i32 s36, s36, 9216
  s_mul_i32 s37, s32, 1152
  s_add_u32 s36, s36, s37
  s_lshl_b32 s38, s30, 10
  s_add_u32 s38, s38, s80
  s_add_u32 m0, s38, 0
  s_nop 0
  buffer_load_dwordx4 v6, s[8:11], s36 offen nt lds
  s_add_u32 m0, s38, 4096
  s_nop 0
  buffer_load_dwordx4 v6, s[12:15], s36 offen nt lds
  s_add_u32 m0, s38, 8192
  s_add_u32 s36, s36, 128
  buffer_load_dwordx4 v6, s[8:11], s36 offen nt lds
  s_add_u32 m0, s38, 12288
  s_nop 0
  buffer_load_dwordx4 v6, s[12:15], s36 offen nt lds
  s_add_u32 m0, s38, 16384
  s_add_u32 s36, s36, 128
  buffer_load_dwordx4 v6, s[8:11], s36 offen nt lds
  s_add_u32 m0, s38, 20480
  s_nop 0
  buffer_load_dwordx4 v6, s[12:15], s36 offen nt lds
  s_add_u32 m0, s38, 24576
  s_add_u32 s36, s36, 128
  buffer_load_dwordx4 v6, s[8:11], s36 offen nt lds
  s_add_u32 m0, s38, 28672
  s_nop 0
  buffer_load_dwordx4 v6, s[12:15], s36 offen nt lds
  s_add_u32 m0, s38, 32768
  s_add_u32 s36, s36, 128
  buffer_load_dwordx4 v6, s[8:11], s36 offen nt lds
  s_add_u32 m0, s38, 36864
  s_nop 0
  buffer_load_dwordx4 v6, s[12:15], s36 offen nt lds
  s_add_u32 m0, s38, 40960
  s_add_u32 s36, s36, 128
  buffer_load_dwordx4 v6, s[8:11], s36 offen nt lds
  s_add_u32 m0, s38, 45056
  s_nop 0
  buffer_load_dwordx4 v6, s[12:15], s36 offen nt lds
  s_add_u32 m0, s38, 49152
  s_add_u32 s36, s36, 128
  buffer_load_dwordx4 v6, s[8:11], s36 offen nt lds
  s_add_u32 m0, s38, 53248
  s_nop 0
  buffer_load_dwordx4 v6, s[12:15], s36 offen nt lds
  s_add_u32 m0, s38, 57344
  s_add_u32 s36, s36, 128
  buffer_load_dwordx4 v6, s[8:11], s36 offen nt lds
  s_add_u32 m0, s38, 61440
  s_nop 0
  buffer_load_dwordx4 v6, s[12:15], s36 offen nt lds
  s_add_u32 m0, s38, 65536
  s_add_u32 s36, s36, 128
  buffer_load_dwordx4 v6, s[8:11], s36 offen nt lds
  s_add_u32 m0, s38, 69632
  s_nop 0
  buffer_load_dwordx4 v6, s[12:15], s36 offen nt lds
  s_mul_i32 s74, s32, 1990656
  s_mul_i32 s40, s30, 497664
  s_add_u32 s74, s74, s40
  s_lshl_b32 s40, s33, 11
  s_add_u32 s74, s74, s40
BG_iss:
  s_lshr_b32 s90, s2, 6
  s_lshl_b32 s90, s90, 3
  s_and_b32 s91, s2, 7
  s_add_u32 s90, s90, s91
  s_lshl_b32 s90, s90, 6
  s_bfe_u32 s91, s2, 0x30003
  s_lshl_b32 s91, s91, 3
  s_add_u32 s90, s90, s91
  s_mul_i32 s90, s90, 1152
  v_lshlrev_b32 v161, 7, v0
  v_cmp_gt_u32 vcc, 72, v0
  v_add_u32 v161, s90, v161
  s_nop 0
  v_cndmask_b32 v161, -1, v161, vcc
  buffer_load_dword v162, v161, s[84:87], 0 offen
  s_cmp_ge_u32 s76, 54
  s_cbranch_scc1 BG_nomod
  s_load_dwordx4 s[4:7], s[0:1], 80
  s_load_dwordx2 s[26:27], s[0:1], 112
  s_sub_u32 s28, s2, 144
  v_and_b32 v1, 7, v0
  v_lshrrev_b32 v2, 3, v0
  s_lshl_b32 s29, s28, 7
  v_mul_u32_u24 v3, 6912, v2
  v_lshl_add_u32 v3, v1, 4, v3
  v_add_u32 v3, s29, v3
  v_lshlrev_b32 v4, 1, v2
  s_waitcnt lgkmcnt(0)
  s_mov_b32 s8, s4
  s_mov_b32 s9, s5
  s_mov_b32 s10, 1152
  s_mov_b32 s11, 0x20000
  s_mov_b32 s12, s6
  s_mov_b32 s13, s7
  s_mov_b32 s14, 3981312
  s_mov_b32 s15, 0x20000
  s_add_u32 s16, s26, 4718592
  s_addc_u32 s17, s27, 0
  s_mov_b32 s18, 6912
  s_mov_b32 s19, 0x20000
  buffer_load_ushort v8, v4, s[8:11], 0 offen offset:0
  buffer_load_ushort v9, v4, s[8:11], 0 offen offset:64
  buffer_load_ushort v10, v4, s[8:11], 0 offen offset:128
  buffer_load_ushort v11, v4, s[8:11], 0 offen offset:192
  buffer_load_ushort v12, v4, s[8:11], 0 offen offset:256
  buffer_load_ushort v13, v4, s[8:11], 0 offen offset:320
  buffer_load_ushort v14, v4, s[8:11], 0 offen offset:384
  buffer_load_ushort v15, v4, s[8:11], 0 offen offset:448
  buffer_load_ushort v16, v4, s[8:11], 0 offen offset:512
  buffer_load_ushort v17, v4, s[8:11], 0 offen offset:576
  buffer_load_ushort v18, v4, s[8:11], 0 offen offset:640
  buffer_load_ushort v19, v4, s[8:11], 0 offen offset:704
  buffer_load_ushort v20, v4, s[8:11], 0 offen offset:768
  buffer_load_ushort v21, v4, s[8:11], 0 offen offset:832
  buffer_load_ushort v22, v4, s[8:11], 0 offen offset:896
  buffer_load_ushort v23, v4, s[8:11], 0 offen offset:960
  buffer_load_ushort v24, v4, s[8:11], 0 offen offset:1024
  buffer_load_ushort v25, v4, s[8:11], 0 offen offset:1088
  s_mov_b32 s30, 0
  buffer_load_dwordx4 v[32:35], v3, s[12:15], s30 offen nt
  s_add_u32 s30, s30, 221184
  buffer_load_dwordx4 v[36:39], v3, s[12:15], s30 offen nt
  s_add_u32 s30, s30, 221184
  buffer_load_dwordx4 v[40:43], v3, s[12:15], s30 offen nt
  s_add_u32 s30, s30, 221184
  buffer_load_dwordx4 v[44:47], v3, s[12:15], s30 offen nt
  s_add_u32 s30, s30, 221184
  buffer_load_dwordx4 v[48:51], v3, s[12:15], s30 offen nt
  s_add_u32 s30, s30, 221184
  buffer_load_dwordx4 v[52:55], v3, s[12:15], s30 offen nt
  s_add_u32 s30, s30, 221184
  buffer_load_dwordx4 v[56:59], v3, s[12:15], s30 offen nt
  s_add_u32 s30, s30, 221184
  buffer_load_dwordx4 v[60:63], v3, s[12:15], s30 offen nt
  s_add_u32 s30, s30, 221184
  buffer_load_dwordx4 v[64:67], v3, s[12:15], s30 offen nt
  s_add_u32 s30, s30, 221184
  buffer_load_dwordx4 v[68:71], v3, s[12:15], s30 offen nt
  s_add_u32 s30, s30, 221184
  buffer_load_dwordx4 v[72:75], v3, s[12:15], s30 offen nt
  s_add_u32 s30, s30, 221184
  buffer_load_dwordx4 v[76:79], v3, s[12:15], s30 offen nt
  s_add_u32 s30, s30, 221184
  buffer_load_dwordx4 v[80:83], v3, s[12:15], s30 offen nt
  s_add_u32 s30, s30, 221184
  buffer_load_dwordx4 v[84:87], v3, s[12:15], s30 offen nt
  s_add_u32 s30, s30, 221184
  buffer_load_dwordx4 v[88:91], v3, s[12:15], s30 offen nt
  s_add_u32 s30, s30, 221184
  buffer_load_dwordx4 v[92:95], v3, s[12:15], s30 offen nt
  s_add_u32 s30, s30, 221184
  buffer_load_dwordx4 v[96:99], v3, s[12:15], s30 offen nt
  s_add_u32 s30, s30, 221184
  buffer_load_dwordx4 v[100:103], v3, s[12:15], s30 offen nt
  s_waitcnt vmcnt(18)
  v_lshlrev_b32 v8, 16, v8
  v_lshlrev_b32 v9, 16, v9
  v_lshlrev_b32 v10, 16, v10
  v_lshlrev_b32 v11, 16, v11
  v_lshlrev_b32 v12, 16, v12
  v_lshlrev_b32 v13, 16, v13
  v_lshlrev_b32 v14, 16, v14
  v_lshlrev_b32 v15, 16, v15
  v_lshlrev_b32 v16, 16, v16
  v_lshlrev_b32 v17, 16, v17
  v_lshlrev_b32 v18, 16, v18
  v_lshlrev_b32 v19, 16, v19
  v_lshlrev_b32 v20, 16, v20
  v_lshlrev_b32 v21, 16, v21
  v_lshlrev_b32 v22, 16, v22
  v_lshlrev_b32 v23, 16, v23
  v_lshlrev_b32 v24, 16, v24
  v_lshlrev_b32 v25, 16, v25
  v_mul_f32 v110, 0xbfb8aa3b, v8
  v_mul_f32 v111, 0xbfb8aa3b, v9
  v_mul_f32 v112, 0xbfb8aa3b, v10
  v_mul_f32 v113, 0xbfb8aa3b, v11
  v_mul_f32 v114, 0xbfb8aa3b, v12
  v_mul_f32 v115, 0xbfb8aa3b, v13
  v_mul_f32 v116, 0xbfb8aa3b, v14
  v_mul_f32 v117, 0xbfb8aa3b, v15
  v_mul_f32 v118, 0xbfb8aa3b, v16
  v_mul_f32 v119, 0xbfb8aa3b, v17
  v_mul_f32 v120, 0xbfb8aa3b, v18
  v_mul_f32 v121, 0xbfb8aa3b, v19
  v_mul_f32 v122, 0xbfb8aa3b, v20
  v_mul_f32 v123, 0xbfb8aa3b, v21
  v_mul_f32 v124, 0xbfb8aa3b, v22
  v_mul_f32 v125, 0xbfb8aa3b, v23
  v_mul_f32 v126, 0xbfb8aa3b, v24
  v_mul_f32 v127, 0xbfb8aa3b, v25
  v_exp_f32 v110, v110
  v_exp_f32 v111, v111
  v_exp_f32 v112, v112
  v_exp_f32 v113, v113
  v_exp_f32 v114, v114
  v_exp_f32 v115, v115
  v_exp_f32 v116, v116
  v_exp_f32 v117, v117
  v_exp_f32 v118, v118
  v_exp_f32 v119, v119
  v_exp_f32 v120, v120
  v_exp_f32 v121, v121
  v_exp_f32 v122, v122
  v_exp_f32 v123, v123
  v_exp_f32 v124, v124
  v_exp_f32 v125, v125
  v_exp_f32 v126, v126
  v_exp_f32 v127, v127
  v_add_f32 v110, 1.0, v110
  v_add_f32 v111, 1.0, v111
  v_add_f32 v112, 1.0, v112
  v_add_f32 v113, 1.0, v113
  v_add_f32 v114, 1.0, v114
  v_add_f32 v115, 1.0, v115
  v_add_f32 v116, 1.0, v116
  v_add_f32 v117, 1.0, v117
  v_add_f32 v118, 1.0, v118
  v_add_f32 v119, 1.0, v119
  v_add_f32 v120, 1.0, v120
  v_add_f32 v121, 1.0, v121
  v_add_f32 v122, 1.0, v122
  v_add_f32 v123, 1.0, v123
  v_add_f32 v124, 1.0, v124
  v_add_f32 v125, 1.0, v125
  v_add_f32 v126, 1.0, v126
  v_add_f32 v127, 1.0, v127
  v_rcp_f32 v110, v110
  v_rcp_f32 v111, v111
  v_rcp_f32 v112, v112
  v_rcp_f32 v113, v113
  v_rcp_f32 v114, v114
  v_rcp_f32 v115, v115
  v_rcp_f32 v116, v116
  v_rcp_f32 v117, v117
  v_rcp_f32 v118, v118
  v_rcp_f32 v119, v119
  v_rcp_f32 v120, v120
  v_rcp_f32 v121, v121
  v_rcp_f32 v122, v122
  v_rcp_f32 v123, v123
  v_rcp_f32 v124, v124
  v_rcp_f32 v125, v125
  v_rcp_f32 v126, v126
  v_rcp_f32 v127, v127
  s_nop 0
  v_mul_f32 v8, v8, v110
  v_mul_f32 v9, v9, v111
  v_mul_f32 v10, v10, v112
  v_mul_f32 v11, v11, v113
  v_mul_f32 v12, v12, v114
  v_mul_f32 v13, v13, v115
  v_mul_f32 v14, v14, v116
  v_mul_f32 v15, v15, v117
  v_mul_f32 v16, v16, v118
  v_mul_f32 v17, v17, v119
  v_mul_f32 v18, v18, v120
  v_mul_f32 v19, v19, v121
  v_mul_f32 v20, v20, v122
  v_mul_f32 v21, v21, v123
  v_mul_f32 v22, v22, v124
  v_mul_f32 v23, v23, v125
  v_mul_f32 v24, v24, v126
  v_mul_f32 v25, v25, v127
  v_cvt_pk_bf16_f32 v8, v8, v8
  v_cvt_pk_bf16_f32 v9, v9, v9
  v_cvt_pk_bf16_f32 v10, v10, v10
  v_cvt_pk_bf16_f32 v11, v11, v11
  v_cvt_pk_bf16_f32 v12, v12, v12
  v_cvt_pk_bf16_f32 v13, v13, v13
  v_cvt_pk_bf16_f32 v14, v14, v14
  v_cvt_pk_bf16_f32 v15, v15, v15
  v_cvt_pk_bf16_f32 v16, v16, v16
  v_cvt_pk_bf16_f32 v17, v17, v17
  v_cvt_pk_bf16_f32 v18, v18, v18
  v_cvt_pk_bf16_f32 v19, v19, v19
  v_cvt_pk_bf16_f32 v20, v20, v20
  v_cvt_pk_bf16_f32 v21, v21, v21
  v_cvt_pk_bf16_f32 v22, v22, v22
  v_cvt_pk_bf16_f32 v23, v23, v23
  v_cvt_pk_bf16_f32 v24, v24, v24
  v_cvt_pk_bf16_f32 v25, v25, v25
  v_lshlrev_b32 v8, 16, v8
  v_lshlrev_b32 v9, 16, v9
  v_lshlrev_b32 v10, 16, v10
  v_lshlrev_b32 v11, 16, v11
  v_lshlrev_b32 v12, 16, v12
  v_lshlrev_b32 v13, 16, v13
  v_lshlrev_b32 v14, 16, v14
  v_lshlrev_b32 v15, 16, v15
  v_lshlrev_b32 v16, 16, v16
  v_lshlrev_b32 v17, 16, v17
  v_lshlrev_b32 v18, 16, v18
  v_lshlrev_b32 v19, 16, v19
  v_lshlrev_b32 v20, 16, v20
  v_lshlrev_b32 v21, 16, v21
  v_lshlrev_b32 v22, 16, v22
  v_lshlrev_b32 v23, 16, v23
  v_lshlrev_b32 v24, 16, v24
  v_lshlrev_b32 v25, 16, v25
  v_mov_b32 v130, 0
  v_mov_b32 v131, 0
  v_mov_b32 v132, 0
  v_mov_b32 v133, 0
  v_mov_b32 v134, 0
  v_mov_b32 v135, 0
  v_mov_b32 v136, 0
  v_mov_b32 v137, 0
  s_waitcnt vmcnt(17)
  v_lshlrev_b32 v140, 16, v32
  v_and_b32 v141, 0xffff0000, v32
  v_fmac_f32 v130, v140, v8
  v_fmac_f32 v131, v141, v8
  v_lshlrev_b32 v140, 16, v33
  v_and_b32 v141, 0xffff0000, v33
  v_fmac_f32 v132, v140, v8
  v_fmac_f32 v133, v141, v8
  v_lshlrev_b32 v140, 16, v34
  v_and_b32 v141, 0xffff0000, v34
  v_fmac_f32 v134, v140, v8
  v_fmac_f32 v135, v141, v8
  v_lshlrev_b32 v140, 16, v35
  v_and_b32 v141, 0xffff0000, v35
  v_fmac_f32 v136, v140, v8
  v_fmac_f32 v137, v141, v8
  s_waitcnt vmcnt(16)
  v_lshlrev_b32 v140, 16, v36
  v_and_b32 v141, 0xffff0000, v36
  v_fmac_f32 v130, v140, v9
  v_fmac_f32 v131, v141, v9
  v_lshlrev_b32 v140, 16, v37
  v_and_b32 v141, 0xffff0000, v37
  v_fmac_f32 v132, v140, v9
  v_fmac_f32 v133, v141, v9
  v_lshlrev_b32 v140, 16, v38
  v_and_b32 v141, 0xffff0000, v38
  v_fmac_f32 v134, v140, v9
  v_fmac_f32 v135, v141, v9
  v_lshlrev_b32 v140, 16, v39
  v_and_b32 v141, 0xffff0000, v39
  v_fmac_f32 v136, v140, v9
  v_fmac_f32 v137, v141, v9
  s_waitcnt vmcnt(15)
  v_lshlrev_b32 v140, 16, v40
  v_and_b32 v141, 0xffff0000, v40
  v_fmac_f32 v130, v140, v10
  v_fmac_f32 v131, v141, v10
  v_lshlrev_b32 v140, 16, v41
  v_and_b32 v141, 0xffff0000, v41
  v_fmac_f32 v132, v140, v10
  v_fmac_f32 v133, v141, v10
  v_lshlrev_b32 v140, 16, v42
  v_and_b32 v141, 0xffff0000, v42
  v_fmac_f32 v134, v140, v10
  v_fmac_f32 v135, v141, v10
  v_lshlrev_b32 v140, 16, v43
  v_and_b32 v141, 0xffff0000, v43
  v_fmac_f32 v136, v140, v10
  v_fmac_f32 v137, v141, v10
  s_waitcnt vmcnt(14)
  v_lshlrev_b32 v140, 16, v44
  v_and_b32 v141, 0xffff0000, v44
  v_fmac_f32 v130, v140, v11
  v_fmac_f32 v131, v141, v11
  v_lshlrev_b32 v140, 16, v45
  v_and_b32 v141, 0xffff0000, v45
  v_fmac_f32 v132, v140, v11
  v_fmac_f32 v133, v141, v11
  v_lshlrev_b32 v140, 16, v46
  v_and_b32 v141, 0xffff0000, v46
  v_fmac_f32 v134, v140, v11
  v_fmac_f32 v135, v141, v11
  v_lshlrev_b32 v140, 16, v47
  v_and_b32 v141, 0xffff0000, v47
  v_fmac_f32 v136, v140, v11
  v_fmac_f32 v137, v141, v11
  s_waitcnt vmcnt(13)
  v_lshlrev_b32 v140, 16, v48
  v_and_b32 v141, 0xffff0000, v48
  v_fmac_f32 v130, v140, v12
  v_fmac_f32 v131, v141, v12
  v_lshlrev_b32 v140, 16, v49
  v_and_b32 v141, 0xffff0000, v49
  v_fmac_f32 v132, v140, v12
  v_fmac_f32 v133, v141, v12
  v_lshlrev_b32 v140, 16, v50
  v_and_b32 v141, 0xffff0000, v50
  v_fmac_f32 v134, v140, v12
  v_fmac_f32 v135, v141, v12
  v_lshlrev_b32 v140, 16, v51
  v_and_b32 v141, 0xffff0000, v51
  v_fmac_f32 v136, v140, v12
  v_fmac_f32 v137, v141, v12
  s_waitcnt vmcnt(12)
  v_lshlrev_b32 v140, 16, v52
  v_and_b32 v141, 0xffff0000, v52
  v_fmac_f32 v130, v140, v13
  v_fmac_f32 v131, v141, v13
  v_lshlrev_b32 v140, 16, v53
  v_and_b32 v141, 0xffff0000, v53
  v_fmac_f32 v132, v140, v13
  v_fmac_f32 v133, v141, v13
  v_lshlrev_b32 v140, 16, v54
  v_and_b32 v141, 0xffff0000, v54
  v_fmac_f32 v134, v140, v13
  v_fmac_f32 v135, v141, v13
  v_lshlrev_b32 v140, 16, v55
  v_and_b32 v141, 0xffff0000, v55
  v_fmac_f32 v136, v140, v13
  v_fmac_f32 v137, v141, v13
  s_waitcnt vmcnt(11)
  v_lshlrev_b32 v140, 16, v56
  v_and_b32 v141, 0xffff0000, v56
  v_fmac_f32 v130, v140, v14
  v_fmac_f32 v131, v141, v14
  v_lshlrev_b32 v140, 16, v57
  v_and_b32 v141, 0xffff0000, v57
  v_fmac_f32 v132, v140, v14
  v_fmac_f32 v133, v141, v14
  v_lshlrev_b32 v140, 16, v58
  v_and_b32 v141, 0xffff0000, v58
  v_fmac_f32 v134, v140, v14
  v_fmac_f32 v135, v141, v14
  v_lshlrev_b32 v140, 16, v59
  v_and_b32 v141, 0xffff0000, v59
  v_fmac_f32 v136, v140, v14
  v_fmac_f32 v137, v141, v14
  s_waitcnt vmcnt(10)
  v_lshlrev_b32 v140, 16, v60
  v_and_b32 v141, 0xffff0000, v60
  v_fmac_f32 v130, v140, v15
  v_fmac_f32 v131, v141, v15
  v_lshlrev_b32 v140, 16, v61
  v_and_b32 v141, 0xffff0000, v61
  v_fmac_f32 v132, v140, v15
  v_fmac_f32 v133, v141, v15
  v_lshlrev_b32 v140, 16, v62
  v_and_b32 v141, 0xffff0000, v62
  v_fmac_f32 v134, v140, v15
  v_fmac_f32 v135, v141, v15
  v_lshlrev_b32 v140, 16, v63
  v_and_b32 v141, 0xffff0000, v63
  v_fmac_f32 v136, v140, v15
  v_fmac_f32 v137, v141, v15
  s_waitcnt vmcnt(9)
  v_lshlrev_b32 v140, 16, v64
  v_and_b32 v141, 0xffff0000, v64
  v_fmac_f32 v130, v140, v16
  v_fmac_f32 v131, v141, v16
  v_lshlrev_b32 v140, 16, v65
  v_and_b32 v141, 0xffff0000, v65
  v_fmac_f32 v132, v140, v16
  v_fmac_f32 v133, v141, v16
  v_lshlrev_b32 v140, 16, v66
  v_and_b32 v141, 0xffff0000, v66
  v_fmac_f32 v134, v140, v16
  v_fmac_f32 v135, v141, v16
  v_lshlrev_b32 v140, 16, v67
  v_and_b32 v141, 0xffff0000, v67
  v_fmac_f32 v136, v140, v16
  v_fmac_f32 v137, v141, v16
  s_waitcnt vmcnt(8)
  v_lshlrev_b32 v140, 16, v68
  v_and_b32 v141, 0xffff0000, v68
  v_fmac_f32 v130, v140, v17
  v_fmac_f32 v131, v141, v17
  v_lshlrev_b32 v140, 16, v69
  v_and_b32 v141, 0xffff0000, v69
  v_fmac_f32 v132, v140, v17
  v_fmac_f32 v133, v141, v17
  v_lshlrev_b32 v140, 16, v70
  v_and_b32 v141, 0xffff0000, v70
  v_fmac_f32 v134, v140, v17
  v_fmac_f32 v135, v141, v17
  v_lshlrev_b32 v140, 16, v71
  v_and_b32 v141, 0xffff0000, v71
  v_fmac_f32 v136, v140, v17
  v_fmac_f32 v137, v141, v17
  s_waitcnt vmcnt(7)
  v_lshlrev_b32 v140, 16, v72
  v_and_b32 v141, 0xffff0000, v72
  v_fmac_f32 v130, v140, v18
  v_fmac_f32 v131, v141, v18
  v_lshlrev_b32 v140, 16, v73
  v_and_b32 v141, 0xffff0000, v73
  v_fmac_f32 v132, v140, v18
  v_fmac_f32 v133, v141, v18
  v_lshlrev_b32 v140, 16, v74
  v_and_b32 v141, 0xffff0000, v74
  v_fmac_f32 v134, v140, v18
  v_fmac_f32 v135, v141, v18
  v_lshlrev_b32 v140, 16, v75
  v_and_b32 v141, 0xffff0000, v75
  v_fmac_f32 v136, v140, v18
  v_fmac_f32 v137, v141, v18
  s_waitcnt vmcnt(6)
  v_lshlrev_b32 v140, 16, v76
  v_and_b32 v141, 0xffff0000, v76
  v_fmac_f32 v130, v140, v19
  v_fmac_f32 v131, v141, v19
  v_lshlrev_b32 v140, 16, v77
  v_and_b32 v141, 0xffff0000, v77
  v_fmac_f32 v132, v140, v19
  v_fmac_f32 v133, v141, v19
  v_lshlrev_b32 v140, 16, v78
  v_and_b32 v141, 0xffff0000, v78
  v_fmac_f32 v134, v140, v19
  v_fmac_f32 v135, v141, v19
  v_lshlrev_b32 v140, 16, v79
  v_and_b32 v141, 0xffff0000, v79
  v_fmac_f32 v136, v140, v19
  v_fmac_f32 v137, v141, v19
  s_waitcnt vmcnt(5)
  v_lshlrev_b32 v140, 16, v80
  v_and_b32 v141, 0xffff0000, v80
  v_fmac_f32 v130, v140, v20
  v_fmac_f32 v131, v141, v20
  v_lshlrev_b32 v140, 16, v81
  v_and_b32 v141, 0xffff0000, v81
  v_fmac_f32 v132, v140, v20
  v_fmac_f32 v133, v141, v20
  v_lshlrev_b32 v140, 16, v82
  v_and_b32 v141, 0xffff0000, v82
  v_fmac_f32 v134, v140, v20
  v_fmac_f32 v135, v141, v20
  v_lshlrev_b32 v140, 16, v83
  v_and_b32 v141, 0xffff0000, v83
  v_fmac_f32 v136, v140, v20
  v_fmac_f32 v137, v141, v20
  s_waitcnt vmcnt(4)
  v_lshlrev_b32 v140, 16, v84
  v_and_b32 v141, 0xffff0000, v84
  v_fmac_f32 v130, v140, v21
  v_fmac_f32 v131, v141, v21
  v_lshlrev_b32 v140, 16, v85
  v_and_b32 v141, 0xffff0000, v85
  v_fmac_f32 v132, v140, v21
  v_fmac_f32 v133, v141, v21
  v_lshlrev_b32 v140, 16, v86
  v_and_b32 v141, 0xffff0000, v86
  v_fmac_f32 v134, v140, v21
  v_fmac_f32 v135, v141, v21
  v_lshlrev_b32 v140, 16, v87
  v_and_b32 v141, 0xffff0000, v87
  v_fmac_f32 v136, v140, v21
  v_fmac_f32 v137, v141, v21
  s_waitcnt vmcnt(3)
  v_lshlrev_b32 v140, 16, v88
  v_and_b32 v141, 0xffff0000, v88
  v_fmac_f32 v130, v140, v22
  v_fmac_f32 v131, v141, v22
  v_lshlrev_b32 v140, 16, v89
  v_and_b32 v141, 0xffff0000, v89
  v_fmac_f32 v132, v140, v22
  v_fmac_f32 v133, v141, v22
  v_lshlrev_b32 v140, 16, v90
  v_and_b32 v141, 0xffff0000, v90
  v_fmac_f32 v134, v140, v22
  v_fmac_f32 v135, v141, v22
  v_lshlrev_b32 v140, 16, v91
  v_and_b32 v141, 0xffff0000, v91
  v_fmac_f32 v136, v140, v22
  v_fmac_f32 v137, v141, v22
  s_waitcnt vmcnt(2)
  v_lshlrev_b32 v140, 16, v92
  v_and_b32 v141, 0xffff0000, v92
  v_fmac_f32 v130, v140, v23
  v_fmac_f32 v131, v141, v23
  v_lshlrev_b32 v140, 16, v93
  v_and_b32 v141, 0xffff0000, v93
  v_fmac_f32 v132, v140, v23
  v_fmac_f32 v133, v141, v23
  v_lshlrev_b32 v140, 16, v94
  v_and_b32 v141, 0xffff0000, v94
  v_fmac_f32 v134, v140, v23
  v_fmac_f32 v135, v141, v23
  v_lshlrev_b32 v140, 16, v95
  v_and_b32 v141, 0xffff0000, v95
  v_fmac_f32 v136, v140, v23
  v_fmac_f32 v137, v141, v23
  s_waitcnt vmcnt(1)
  v_lshlrev_b32 v140, 16, v96
  v_and_b32 v141, 0xffff0000, v96
  v_fmac_f32 v130, v140, v24
  v_fmac_f32 v131, v141, v24
  v_lshlrev_b32 v140, 16, v97
  v_and_b32 v141, 0xffff0000, v97
  v_fmac_f32 v132, v140, v24
  v_fmac_f32 v133, v141, v24
  v_lshlrev_b32 v140, 16, v98
  v_and_b32 v141, 0xffff0000, v98
  v_fmac_f32 v134, v140, v24
  v_fmac_f32 v135, v141, v24
  v_lshlrev_b32 v140, 16, v99
  v_and_b32 v141, 0xffff0000, v99
  v_fmac_f32 v136, v140, v24
  v_fmac_f32 v137, v141, v24
  s_waitcnt vmcnt(0)
  v_lshlrev_b32 v140, 16, v100
  v_and_b32 v141, 0xffff0000, v100
  v_fmac_f32 v130, v140, v25
  v_fmac_f32 v131, v141, v25
  v_lshlrev_b32 v140, 16, v101
  v_and_b32 v141, 0xffff0000, v101
  v_fmac_f32 v132, v140, v25
  v_fmac_f32 v133, v141, v25
  v_lshlrev_b32 v140, 16, v102
  v_and_b32 v141, 0xffff0000, v102
  v_fmac_f32 v134, v140, v25
  v_fmac_f32 v135, v141, v25
  v_lshlrev_b32 v140, 16, v103
  v_and_b32 v141, 0xffff0000, v103
  v_fmac_f32 v136, v140, v25
  v_fmac_f32 v137, v141, v25
  v_lshlrev_b32 v5, 5, v0
  v_add_u32 v5, 147456, v5
  ds_write_b128 v5, v[130:133]
  ds_write_b128 v5, v[134:137] offset:16
  s_waitcnt lgkmcnt(0)
  s_barrier
  v_cmp_gt_u32 vcc, 64, v0
  s_and_saveexec_b64 s[34:35], vcc
  s_cbranch_execz A2_mod_done
  v_lshlrev_b32 v5, 2, v0
  v_add_u32 v6, 147456, v5
  ds_read_b32 v32, v6 offset:0
  ds_read_b32 v33, v6 offset:256
  ds_read_b32 v34, v6 offset:512
  ds_read_b32 v35, v6 offset:768
  ds_read_b32 v36, v6 offset:1024
  ds_read_b32 v37, v6 offset:1280
  ds_read_b32 v38, v6 offset:1536
  ds_read_b32 v39, v6 offset:1792
  ds_read_b32 v40, v6 offset:2048
  ds_read_b32 v41, v6 offset:2304
  ds_read_b32 v42, v6 offset:2560
  ds_read_b32 v43, v6 offset:2816
  ds_read_b32 v44, v6 offset:3072
  ds_read_b32 v45, v6 offset:3328
  ds_read_b32 v46, v6 offset:3584
  s_waitcnt lgkmcnt(0)
  ds_read_b32 v47, v6 offset:3840
  ds_read_b32 v48, v6 offset:4096
  ds_read_b32 v49, v6 offset:4352
  ds_read_b32 v50, v6 offset:4608
  ds_read_b32 v51, v6 offset:4864
  ds_read_b32 v52, v6 offset:5120
  ds_read_b32 v53, v6 offset:5376
  ds_read_b32 v54, v6 offset:5632
  ds_read_b32 v55, v6 offset:5888
  ds_read_b32 v56, v6 offset:6144
  ds_read_b32 v57, v6 offset:6400
  ds_read_b32 v58, v6 offset:6656
  ds_read_b32 v59, v6 offset:6912
  ds_read_b32 v60, v6 offset:7168
  ds_read_b32 v61, v6 offset:7424
  s_waitcnt lgkmcnt(0)
  ds_read_b32 v62, v6 offset:7680
  ds_read_b32 v63, v6 offset:7936
  s_waitcnt lgkmcnt(0)
  v_add_f32 v32, v32, v48
  v_add_f32 v33, v33, v49
  v_add_f32 v34, v34, v50
  v_add_f32 v35, v35, v51
  v_add_f32 v36, v36, v52
  v_add_f32 v37, v37, v53
  v_add_f32 v38, v38, v54
  v_add_f32 v39, v39, v55
  v_add_f32 v40, v40, v56
  v_add_f32 v41, v41, v57
  v_add_f32 v42, v42, v58
  v_add_f32 v43, v43, v59
  v_add_f32 v44, v44, v60
  v_add_f32 v45, v45, v61
  v_add_f32 v46, v46, v62
  v_add_f32 v47, v47, v63
  v_add_f32 v32, v32, v40
  v_add_f32 v33, v33, v41
  v_add_f32 v34, v34, v42
  v_add_f32 v35, v35, v43
  v_add_f32 v36, v36, v44
  v_add_f32 v37, v37, v45
  v_add_f32 v38, v38, v46
  v_add_f32 v39, v39, v47
  v_add_f32 v32, v32, v36
  v_add_f32 v33, v33, v37
  v_add_f32 v34, v34, v38
  v_add_f32 v35, v35, v39
  v_add_f32 v32, v32, v34
  v_add_f32 v33, v33, v35
  v_add_f32 v32, v32, v33
  v_cvt_pk_bf16_f32 v32, v32, v32
  v_lshlrev_b32 v32, 16, v32
  v_add_f32 v33, 1.0, v32
  s_sub_u32 s29, s28, 9
  s_cmp_lt_u32 s29, 9
  s_cselect_b32 s30, 1, 0
  s_sub_u32 s29, s28, 36
  s_cmp_lt_u32 s29, 9
  s_cselect_b32 s30, 1, s30
  s_cmp_lg_u32 s30, 0
  s_cselect_b64 vcc, -1, 0
  v_cndmask_b32 v32, v32, v33, vcc
  v_cvt_pk_bf16_f32 v32, v32, v32
  s_lshl_b32 s29, s28, 7
  v_lshrrev_b32 v5, 1, v5
  v_add_u32 v5, s29, v5
  buffer_store_short v32, v5, s[16:19], 0 offen sc1
A2_mod_done:
  s_mov_b64 exec, -1
  v_and_b32 v1, 63, v0
  v_mov_b32 v152, 0
  s_mov_b32 s95, 200000
BGM_tag:
  buffer_load_dword v153, v152, s[48:51], 0 offen sc1
  s_waitcnt vmcnt(0)
  v_readfirstlane_b32 s100, v153
  s_cmp_lg_u32 s100, 0
  s_cbranch_scc1 BGM_tagok
  s_sub_u32 s95, s95, 1
  s_cmp_eq_u32 s95, 0
  s_cbranch_scc1 BGM_tagok
  s_sleep 1
  s_branch BGM_tag
BGM_tagok:
  s_lshl_b32 s68, s2, 7
  s_add_u32 s68, s68, 32768
  s_waitcnt vmcnt(0)
  s_barrier
  s_cmp_lg_u32 s101, 0
  s_cbranch_scc1 BGM_nopub
  v_mov_b32 v152, s68
  v_mov_b32 v153, s100
  v_cmp_eq_u32 vcc, 0, v1
  s_and_saveexec_b64 s[90:91], vcc
  buffer_store_dword v153, v152, s[44:47], 0 offen sc1
  s_mov_b64 exec, s[90:91]
BGM_nopub:
  s_mov_b32 s30, s101
  v_lshrrev_b32 v2, 3, v1
  v_bfe_u32 v3, v1, 1, 2
  v_and_b32 v4, 1, v1
  v_bfe_u32 v5, v1, 4, 1
  s_and_b32 s31, s30, 1
  s_lshl_b32 s31, s31, 1
  v_or_b32 v5, s31, v5
  v_xor_b32 v5, v5, v3
  v_mul_u32_u24 v6, 9216, v2
  v_lshl_add_u32 v6, v5, 5, v6
  v_lshl_add_u32 v6, v4, 4, v6
  v_bfe_u32 v5, v1, 4, 2
  v_xor_b32 v5, v5, v3
  v_mul_u32_u24 v7, 1152, v2
  v_lshl_add_u32 v7, v5, 5, v7
  v_lshl_add_u32 v7, v4, 4, v7
  v_lshrrev_b32 v8, 4, v1
  v_bfe_u32 v9, v1, 2, 2
  v_and_b32 v10, 3, v1
  v_lshrrev_b32 v11, 1, v9
  v_and_b32 v12, 1, v8
  v_lshl_or_b32 v11, v12, 1, v11
  v_xor_b32 v11, s30, v11
  v_lshl_add_u32 v12, v8, 3, v9
  v_lshlrev_b32 v12, 7, v12
  v_lshl_add_u32 v12, v11, 5, v12
  v_lshl_add_u32 v12, v10, 3, v12
  v_lshrrev_b32 v11, 1, v9
  v_lshl_add_u32 v11, v8, 1, v11
  v_and_b32 v11, 3, v11
  v_xor_b32 v11, s30, v11
  v_lshl_add_u32 v13, v8, 2, v9
  v_lshlrev_b32 v13, 7, v13
  v_lshl_add_u32 v13, v11, 5, v13
  v_lshl_add_u32 v13, v10, 3, v13
  v_lshlrev_b32 v14, 4, v1
  s_branch BG_conv0
BG_nomod:
  s_cmp_eq_u32 s78, 0
  s_cbranch_scc1 BG_w1
  s_waitcnt vmcnt(19)
  s_branch BG_w2
BG_w1:
  s_waitcnt vmcnt(1)
BG_w2:
  s_barrier
BG_conv0:
  s_mov_b32 s81, 0
  v_add_u32 v15, s81, v12
  v_add_u32 v64, 49152, v15
  ds_read_b64_tr_b16 v[16:17], v15 offset:0
  ds_read_b64_tr_b16 v[18:19], v15 offset:512
  ds_read_b64_tr_b16 v[20:21], v15 offset:4096
  ds_read_b64_tr_b16 v[22:23], v15 offset:4608
  ds_read_b64_tr_b16 v[24:25], v15 offset:8192
  ds_read_b64_tr_b16 v[26:27], v15 offset:8704
  ds_read_b64_tr_b16 v[28:29], v15 offset:12288
  ds_read_b64_tr_b16 v[30:31], v15 offset:12800
  ds_read_b64_tr_b16 v[32:33], v15 offset:16384
  ds_read_b64_tr_b16 v[34:35], v15 offset:16896
  ds_read_b64_tr_b16 v[36:37], v15 offset:20480
  ds_read_b64_tr_b16 v[38:39], v15 offset:20992
  s_waitcnt lgkmcnt(10)
  s_add_u32 s41, s72, 0
  buffer_store_dwordx4 v[16:19], v14, s[20:23], s41 offen sc1
  s_waitcnt lgkmcnt(8)
  s_add_u32 s41, s72, 1024
  buffer_store_dwordx4 v[20:23], v14, s[20:23], s41 offen sc1
  s_waitcnt lgkmcnt(6)
  s_add_u32 s41, s72, 36864
  buffer_store_dwordx4 v[24:27], v14, s[20:23], s41 offen sc1
  s_waitcnt lgkmcnt(4)
  s_add_u32 s41, s72, 37888
  buffer_store_dwordx4 v[28:31], v14, s[20:23], s41 offen sc1
  s_waitcnt lgkmcnt(2)
  s_add_u32 s41, s72, 73728
  buffer_store_dwordx4 v[32:35], v14, s[20:23], s41 offen sc1
  s_waitcnt lgkmcnt(0)
  s_add_u32 s41, s72, 74752
  buffer_store_dwordx4 v[36:39], v14, s[20:23], s41 offen sc1
  ds_read_b64_tr_b16 v[40:41], v15 offset:24576
  ds_read_b64_tr_b16 v[42:43], v15 offset:25088
  ds_read_b64_tr_b16 v[44:45], v15 offset:28672
  ds_read_b64_tr_b16 v[46:47], v15 offset:29184
  ds_read_b64_tr_b16 v[48:49], v15 offset:32768
  ds_read_b64_tr_b16 v[50:51], v15 offset:33280
  ds_read_b64_tr_b16 v[52:53], v15 offset:36864
  ds_read_b64_tr_b16 v[54:55], v15 offset:37376
  ds_read_b64_tr_b16 v[56:57], v15 offset:40960
  ds_read_b64_tr_b16 v[58:59], v15 offset:41472
  ds_read_b64_tr_b16 v[60:61], v15 offset:45056
  ds_read_b64_tr_b16 v[62:63], v15 offset:45568
  s_waitcnt lgkmcnt(10)
  s_add_u32 s41, s72, 110592
  buffer_store_dwordx4 v[40:43], v14, s[20:23], s41 offen sc1
  s_waitcnt lgkmcnt(8)
  s_add_u32 s41, s72, 111616
  buffer_store_dwordx4 v[44:47], v14, s[20:23], s41 offen sc1
  s_waitcnt lgkmcnt(6)
  s_add_u32 s41, s72, 147456
  buffer_store_dwordx4 v[48:51], v14, s[20:23], s41 offen sc1
  s_waitcnt lgkmcnt(4)
  s_add_u32 s41, s72, 148480
  buffer_store_dwordx4 v[52:55], v14, s[20:23], s41 offen sc1
  s_waitcnt lgkmcnt(2)
  s_add_u32 s41, s72, 184320
  buffer_store_dwordx4 v[56:59], v14, s[20:23], s41 offen sc1
  s_waitcnt lgkmcnt(0)
  s_add_u32 s41, s72, 185344
  buffer_store_dwordx4 v[60:63], v14, s[20:23], s41 offen sc1
  ds_read_b64_tr_b16 v[16:17], v64 offset:0
  ds_read_b64_tr_b16 v[18:19], v64 offset:512
  ds_read_b64_tr_b16 v[20:21], v64 offset:4096
  ds_read_b64_tr_b16 v[22:23], v64 offset:4608
  ds_read_b64_tr_b16 v[24:25], v64 offset:8192
  ds_read_b64_tr_b16 v[26:27], v64 offset:8704
  ds_read_b64_tr_b16 v[28:29], v64 offset:12288
  ds_read_b64_tr_b16 v[30:31], v64 offset:12800
  ds_read_b64_tr_b16 v[32:33], v64 offset:16384
  ds_read_b64_tr_b16 v[34:35], v64 offset:16896
  ds_read_b64_tr_b16 v[36:37], v64 offset:20480
  ds_read_b64_tr_b16 v[38:39], v64 offset:20992
  s_waitcnt lgkmcnt(10)
  s_add_u32 s41, s72, 221184
  buffer_store_dwordx4 v[16:19], v14, s[20:23], s41 offen sc1
  s_waitcnt lgkmcnt(8)
  s_add_u32 s41, s72, 222208
  buffer_store_dwordx4 v[20:23], v14, s[20:23], s41 offen sc1
  s_waitcnt lgkmcnt(6)
  s_add_u32 s41, s72, 258048
  buffer_store_dwordx4 v[24:27], v14, s[20:23], s41 offen sc1
  s_waitcnt lgkmcnt(4)
  s_add_u32 s41, s72, 259072
  buffer_store_dwordx4 v[28:31], v14, s[20:23], s41 offen sc1
  s_waitcnt lgkmcnt(2)
  s_add_u32 s41, s72, 294912
  buffer_store_dwordx4 v[32:35], v14, s[20:23], s41 offen sc1
  s_waitcnt lgkmcnt(0)
  s_add_u32 s41, s72, 295936
  buffer_store_dwordx4 v[36:39], v14, s[20:23], s41 offen sc1
  s_cmp_eq_u32 s78, 0
  s_cbranch_scc1 BG_done
  s_waitcnt vmcnt(18)
  s_barrier
  s_mov_b32 s81, 73728
  v_add_u32 v15, s81, v12
  v_add_u32 v64, 49152, v15
  ds_read_b64_tr_b16 v[16:17], v15 offset:0
  ds_read_b64_tr_b16 v[18:19], v15 offset:512
  ds_read_b64_tr_b16 v[20:21], v15 offset:4096
  ds_read_b64_tr_b16 v[22:23], v15 offset:4608
  ds_read_b64_tr_b16 v[24:25], v15 offset:8192
  ds_read_b64_tr_b16 v[26:27], v15 offset:8704
  ds_read_b64_tr_b16 v[28:29], v15 offset:12288
  ds_read_b64_tr_b16 v[30:31], v15 offset:12800
  ds_read_b64_tr_b16 v[32:33], v15 offset:16384
  ds_read_b64_tr_b16 v[34:35], v15 offset:16896
  ds_read_b64_tr_b16 v[36:37], v15 offset:20480
  ds_read_b64_tr_b16 v[38:39], v15 offset:20992
  s_waitcnt lgkmcnt(10)
  s_add_u32 s41, s74, 0
  buffer_store_dwordx4 v[16:19], v14, s[20:23], s41 offen sc1
  s_waitcnt lgkmcnt(8)
  s_add_u32 s41, s74, 1024
  buffer_store_dwordx4 v[20:23], v14, s[20:23], s41 offen sc1
  s_waitcnt lgkmcnt(6)
  s_add_u32 s41, s74, 36864
  buffer_store_dwordx4 v[24:27], v14, s[20:23], s41 offen sc1
  s_waitcnt lgkmcnt(4)
  s_add_u32 s41, s74, 37888
  buffer_store_dwordx4 v[28:31], v14, s[20:23], s41 offen sc1
  s_waitcnt lgkmcnt(2)
  s_add_u32 s41, s74, 73728
  buffer_store_dwordx4 v[32:35], v14, s[20:23], s41 offen sc1
  s_waitcnt lgkmcnt(0)
  s_add_u32 s41, s74, 74752
  buffer_store_dwordx4 v[36:39], v14, s[20:23], s41 offen sc1
  ds_read_b64_tr_b16 v[40:41], v15 offset:24576
  ds_read_b64_tr_b16 v[42:43], v15 offset:25088
  ds_read_b64_tr_b16 v[44:45], v15 offset:28672
  ds_read_b64_tr_b16 v[46:47], v15 offset:29184
  ds_read_b64_tr_b16 v[48:49], v15 offset:32768
  ds_read_b64_tr_b16 v[50:51], v15 offset:33280
  ds_read_b64_tr_b16 v[52:53], v15 offset:36864
  ds_read_b64_tr_b16 v[54:55], v15 offset:37376
  ds_read_b64_tr_b16 v[56:57], v15 offset:40960
  ds_read_b64_tr_b16 v[58:59], v15 offset:41472
  ds_read_b64_tr_b16 v[60:61], v15 offset:45056
  ds_read_b64_tr_b16 v[62:63], v15 offset:45568
  s_waitcnt lgkmcnt(10)
  s_add_u32 s41, s74, 110592
  buffer_store_dwordx4 v[40:43], v14, s[20:23], s41 offen sc1
  s_waitcnt lgkmcnt(8)
  s_add_u32 s41, s74, 111616
  buffer_store_dwordx4 v[44:47], v14, s[20:23], s41 offen sc1
  s_waitcnt lgkmcnt(6)
  s_add_u32 s41, s74, 147456
  buffer_store_dwordx4 v[48:51], v14, s[20:23], s41 offen sc1
  s_waitcnt lgkmcnt(4)
  s_add_u32 s41, s74, 148480
  buffer_store_dwordx4 v[52:55], v14, s[20:23], s41 offen sc1
  s_waitcnt lgkmcnt(2)
  s_add_u32 s41, s74, 184320
  buffer_store_dwordx4 v[56:59], v14, s[20:23], s41 offen sc1
  s_waitcnt lgkmcnt(0)
  s_add_u32 s41, s74, 185344
  buffer_store_dwordx4 v[60:63], v14, s[20:23], s41 offen sc1
  ds_read_b64_tr_b16 v[16:17], v64 offset:0
  ds_read_b64_tr_b16 v[18:19], v64 offset:512
  ds_read_b64_tr_b16 v[20:21], v64 offset:4096
  ds_read_b64_tr_b16 v[22:23], v64 offset:4608
  ds_read_b64_tr_b16 v[24:25], v64 offset:8192
  ds_read_b64_tr_b16 v[26:27], v64 offset:8704
  ds_read_b64_tr_b16 v[28:29], v64 offset:12288
  ds_read_b64_tr_b16 v[30:31], v64 offset:12800
  ds_read_b64_tr_b16 v[32:33], v64 offset:16384
  ds_read_b64_tr_b16 v[34:35], v64 offset:16896
  ds_read_b64_tr_b16 v[36:37], v64 offset:20480
  ds_read_b64_tr_b16 v[38:39], v64 offset:20992
  s_waitcnt lgkmcnt(10)
  s_add_u32 s41, s74, 221184
  buffer_store_dwordx4 v[16:19], v14, s[20:23], s41 offen sc1
  s_waitcnt lgkmcnt(8)
  s_add_u32 s41, s74, 222208
  buffer_store_dwordx4 v[20:23], v14, s[20:23], s41 offen sc1
  s_waitcnt lgkmcnt(6)
  s_add_u32 s41, s74, 258048
  buffer_store_dwordx4 v[24:27], v14, s[20:23], s41 offen sc1
  s_waitcnt lgkmcnt(4)
  s_add_u32 s41, s74, 259072
  buffer_store_dwordx4 v[28:31], v14, s[20:23], s41 offen sc1
  s_waitcnt lgkmcnt(2)
  s_add_u32 s41, s74, 294912
  buffer_store_dwordx4 v[32:35], v14, s[20:23], s41 offen sc1
  s_waitcnt lgkmcnt(0)
  s_add_u32 s41, s74, 295936
  buffer_store_dwordx4 v[36:39], v14, s[20:23], s41 offen sc1
BG_done:
  v_and_b32 v1, 63, v0
  v_mov_b32 v152, 0
  s_mov_b32 s95, 200000
BGP_tag:
  buffer_load_dword v153, v152, s[48:51], 0 offen sc1
  s_waitcnt vmcnt(0)
  v_readfirstlane_b32 s100, v153
  s_cmp_lg_u32 s100, 0
  s_cbranch_scc1 BGP_tagok
  s_sub_u32 s95, s95, 1
  s_cmp_eq_u32 s95, 0
  s_cbranch_scc1 BGP_tagok
  s_sleep 1
  s_branch BGP_tag
BGP_tagok:
  s_lshl_b32 s68, s76, 7
  s_add_u32 s68, s68, 65536
  s_waitcnt vmcnt(0)
  s_barrier
  s_cmp_lg_u32 s101, 0
  s_cbranch_scc1 BGP_nopub
  v_mov_b32 v152, s68
  v_mov_b32 v153, s100
  v_cmp_eq_u32 vcc, 0, v1
  s_and_saveexec_b64 s[90:91], vcc
  buffer_store_dword v153, v152, s[44:47], 0 offen sc1
  s_mov_b64 exec, s[90:91]
BGP_nopub:
  s_branch MG_rows
FM_chain:
  s_load_dwordx4 s[4:7], s[0:1], 8
  s_load_dwordx4 s[52:55], s[0:1], 24
  s_load_dwordx2 s[56:57], s[0:1], 40
  s_load_dwordx4 s[60:63], s[0:1], 104
  s_load_dwordx2 s[82:83], s[0:1], 0
  s_load_dwordx2 s[74:75], s[0:1], 72
  v_lshrrev_b32 v2, 6, v0
  v_and_b32 v1, 63, v0
  s_lshr_b32 s50, s2, 4
  s_and_b32 s51, s2, 15
  v_readfirstlane_b32 s44, v2
  v_and_b32 v3, 7, v0
  v_lshrrev_b32 v4, 3, v0
  s_lshl_b32 s58, s51, 7
  v_lshl_add_u32 v5, v4, 2, s58
  s_lshl_b32 s59, s50, 7
  v_lshl_add_u32 v6, v3, 4, s59
  s_movk_i32 s64, 1152
  v_mul_lo_u32 v7, v5, s64
  v_add_u32 v7, v7, v6
  s_lshl_b32 s65, s50, 9
  v_lshl_add_u32 v154, v3, 6, s65
  s_lshl_b32 s45, s2, 2
  s_add_u32 s45, s45, s44
  s_mul_i32 s46, s44, 21504
  s_lshl_b32 s47, s45, 12
  s_mov_b32 s66, 0x05040100
  s_mov_b32 s67, 0x07060302
  v_subrev_u32 v144, 3456, v7
  v_subrev_u32 v145, 2304, v7
  v_subrev_u32 v146, 1152, v7
  v_mov_b32 v147, v7
  v_add_u32 v148, 1152, v7
  v_add_u32 v149, 2304, v7
  v_add_u32 v150, 3456, v7
  s_waitcnt lgkmcnt(0)
  s_mov_b32 s8, s4
  s_mov_b32 s9, s5
  s_mov_b32 s10, 2359296
  s_mov_b32 s11, 0x20000
  s_mov_b32 s12, s6
  s_mov_b32 s13, s7
  s_mov_b32 s14, 2359296
  s_mov_b32 s15, 0x20000
  s_mov_b32 s16, s52
  s_mov_b32 s17, s53
  s_mov_b32 s18, 4608
  s_mov_b32 s19, 0x20000
  s_mov_b32 s20, s62
  s_mov_b32 s21, s63
  s_mov_b32 s22, 2359296
  s_mov_b32 s23, 0x20000
  s_add_u32 s24, s54, s47
  s_addc_u32 s25, s55, 0
  s_mov_b32 s26, 4096
  s_mov_b32 s27, 0x20000
  s_add_u32 s28, s62, 2359296
  s_addc_u32 s29, s63, 0
  s_mov_b32 s30, 2359296
  s_mov_b32 s31, 0x20000
  s_add_u32 s32, s62, 47185920
  s_addc_u32 s33, s63, 0
  s_mov_b32 s34, 491520
  s_mov_b32 s35, 0x20000
  s_mov_b32 s36, s60
  s_mov_b32 s37, s61
  s_mov_b32 s38, 256
  s_mov_b32 s39, 0x20000
  s_mov_b32 s40, s56
  s_mov_b32 s41, s57
  s_mov_b32 s42, 1152
  s_mov_b32 s43, 0x20000
  s_mov_b32 s84, s82
  s_mov_b32 s85, s83
  s_mov_b32 s86, 2359296
  s_mov_b32 s87, 0x20000
  s_mov_b32 s72, s74
  s_mov_b32 s73, s75
  s_mov_b32 s74, 5308416
  s_mov_b32 s75, 0x20000
  buffer_load_dwordx4 v[8:11], v144, s[8:11], 0 offen nt
  buffer_load_dwordx4 v[12:15], v145, s[8:11], 0 offen nt
  buffer_load_dwordx4 v[16:19], v146, s[8:11], 0 offen nt
  buffer_load_dwordx4 v[20:23], v147, s[8:11], 0 offen nt
  buffer_load_dwordx4 v[24:27], v148, s[8:11], 0 offen nt
  buffer_load_dwordx4 v[28:31], v149, s[8:11], 0 offen nt
  buffer_load_dwordx4 v[32:35], v150, s[8:11], 0 offen nt
  buffer_load_dwordx4 v[52:55], v154, s[16:19], 0 offen offset:0
  buffer_load_dwordx4 v[56:59], v154, s[16:19], 0 offen offset:16
  buffer_load_dwordx4 v[60:63], v154, s[16:19], 0 offen offset:32
  buffer_load_dwordx4 v[64:67], v154, s[16:19], 0 offen offset:48
  buffer_load_dwordx4 v[36:39], v147, s[12:15], 0 offen nt
  buffer_load_dwordx4 v[40:43], v148, s[12:15], 0 offen nt
  buffer_load_dwordx4 v[44:47], v149, s[12:15], 0 offen nt
  buffer_load_dwordx4 v[48:51], v150, s[12:15], 0 offen nt
  v_mov_b32 v152, 0
  s_or_b32 s68, s2, s44
  s_cmp_lg_u32 s68, 0
  s_cbranch_scc1 FM_notag
  s_memrealtime s[68:69]
  s_waitcnt lgkmcnt(0)
  s_or_b32 s68, s68, 1
  v_mov_b32 v153, s68
  buffer_store_dword v153, v152, s[36:39], 0 offen sc1
FM_notag:
  v_lshlrev_b32 v155, 4, v1
  v_subrev_u32 v156, 32, v155
  v_add_u32 v157, 16, v156
  buffer_load_dwordx4 v[68:71], v156, s[24:27], 0 offen nt
  buffer_load_dwordx2 v[72:73], v157, s[24:27], 0 offen nt
  v_add_u32 v157, 1024, v156
  buffer_load_dwordx4 v[74:77], v157, s[24:27], 0 offen nt
  buffer_load_dwordx2 v[78:79], v157, s[24:27], 0 offen offset:16 nt
  v_add_u32 v157, 2048, v156
  buffer_load_dwordx4 v[80:83], v157, s[24:27], 0 offen nt
  buffer_load_dwordx2 v[84:85], v157, s[24:27], 0 offen offset:16 nt
  v_add_u32 v157, 3072, v156
  buffer_load_dwordx4 v[86:89], v157, s[24:27], 0 offen nt
  buffer_load_dwordx2 v[90:91], v157, s[24:27], 0 offen offset:16 nt
  v_add_u32 v157, 4096, v156
  buffer_load_dwordx4 v[92:95], v157, s[24:27], 0 offen nt
  buffer_load_dwordx2 v[96:97], v157, s[24:27], 0 offen offset:16 nt
  s_lshl_b32 s68, s45, 1
  v_mov_b32 v158, s68
  buffer_load_ushort v98, v158, s[40:43], 0 offen
  v_sub_u32 v159, 31, v4
  v_lshrrev_b32 v99, 1, v159
  v_xor_b32 v99, v99, v3
  v_lshlrev_b32 v99, 4, v99
  v_and_b32 v159, 1, v159
  v_lshl_add_u32 v99, v159, 3, v99
  v_lshl_add_u32 v99, v3, 11, v99
  v_add_u32 v99, 86016, v99
  s_waitcnt vmcnt(15)
  v_perm_b32 v132, v8, v12, s66
  v_perm_b32 v133, v12, v16, s66
  v_perm_b32 v134, v16, v20, s66
  v_perm_b32 v135, v20, v24, s66
  v_perm_b32 v136, v24, v28, s66
  v_perm_b32 v137, v28, v32, s66
  v_dot2_f32_bf16 v100, v132, v53, 0
  v_dot2_f32_bf16 v108, v133, v53, 0
  v_dot2_f32_bf16 v116, v134, v53, 0
  v_dot2_f32_bf16 v124, v135, v53, 0
  v_dot2_f32_bf16 v100, v134, v52, v100
  v_dot2_f32_bf16 v108, v135, v52, v108
  v_dot2_f32_bf16 v116, v136, v52, v116
  v_dot2_f32_bf16 v124, v137, v52, v124
  v_perm_b32 v138, v8, v12, s67
  v_perm_b32 v139, v12, v16, s67
  v_perm_b32 v140, v16, v20, s67
  v_perm_b32 v141, v20, v24, s67
  v_perm_b32 v142, v24, v28, s67
  v_perm_b32 v143, v28, v32, s67
  v_dot2_f32_bf16 v101, v138, v55, 0
  v_dot2_f32_bf16 v109, v139, v55, 0
  v_dot2_f32_bf16 v117, v140, v55, 0
  v_dot2_f32_bf16 v125, v141, v55, 0
  v_dot2_f32_bf16 v101, v140, v54, v101
  v_dot2_f32_bf16 v109, v141, v54, v109
  v_dot2_f32_bf16 v117, v142, v54, v117
  v_dot2_f32_bf16 v125, v143, v54, v125
  v_perm_b32 v132, v9, v13, s66
  v_perm_b32 v133, v13, v17, s66
  v_perm_b32 v134, v17, v21, s66
  v_perm_b32 v135, v21, v25, s66
  v_perm_b32 v136, v25, v29, s66
  v_perm_b32 v137, v29, v33, s66
  v_dot2_f32_bf16 v102, v132, v57, 0
  v_dot2_f32_bf16 v110, v133, v57, 0
  v_dot2_f32_bf16 v118, v134, v57, 0
  v_dot2_f32_bf16 v126, v135, v57, 0
  v_dot2_f32_bf16 v102, v134, v56, v102
  v_dot2_f32_bf16 v110, v135, v56, v110
  v_dot2_f32_bf16 v118, v136, v56, v118
  v_dot2_f32_bf16 v126, v137, v56, v126
  v_perm_b32 v138, v9, v13, s67
  v_perm_b32 v139, v13, v17, s67
  v_perm_b32 v140, v17, v21, s67
  v_perm_b32 v141, v21, v25, s67
  v_perm_b32 v142, v25, v29, s67
  v_perm_b32 v143, v29, v33, s67
  v_dot2_f32_bf16 v103, v138, v59, 0
  v_dot2_f32_bf16 v111, v139, v59, 0
  v_dot2_f32_bf16 v119, v140, v59, 0
  v_dot2_f32_bf16 v127, v141, v59, 0
  v_dot2_f32_bf16 v103, v140, v58, v103
  v_dot2_f32_bf16 v111, v141, v58, v111
  v_dot2_f32_bf16 v119, v142, v58, v119
  v_dot2_f32_bf16 v127, v143, v58, v127
  v_perm_b32 v132, v10, v14, s66
  v_perm_b32 v133, v14, v18, s66
  v_perm_b32 v134, v18, v22, s66
  v_perm_b32 v135, v22, v26, s66
  v_perm_b32 v136, v26, v30, s66
  v_perm_b32 v137, v30, v34, s66
  v_dot2_f32_bf16 v104, v132, v61, 0
  v_dot2_f32_bf16 v112, v133, v61, 0
  v_dot2_f32_bf16 v120, v134, v61, 0
  v_dot2_f32_bf16 v128, v135, v61, 0
  v_dot2_f32_bf16 v104, v134, v60, v104
  v_dot2_f32_bf16 v112, v135, v60, v112
  v_dot2_f32_bf16 v120, v136, v60, v120
  v_dot2_f32_bf16 v128, v137, v60, v128
  v_perm_b32 v138, v10, v14, s67
  v_perm_b32 v139, v14, v18, s67
  v_perm_b32 v140, v18, v22, s67
  v_perm_b32 v141, v22, v26, s67
  v_perm_b32 v142, v26, v30, s67
  v_perm_b32 v143, v30, v34, s67
  v_dot2_f32_bf16 v105, v138, v63, 0
  v_dot2_f32_bf16 v113, v139, v63, 0
  v_dot2_f32_bf16 v121, v140, v63, 0
  v_dot2_f32_bf16 v129, v141, v63, 0
  v_dot2_f32_bf16 v105, v140, v62, v105
  v_dot2_f32_bf16 v113, v141, v62, v113
  v_dot2_f32_bf16 v121, v142, v62, v121
  v_dot2_f32_bf16 v129, v143, v62, v129
  v_perm_b32 v132, v11, v15, s66
  v_perm_b32 v133, v15, v19, s66
  v_perm_b32 v134, v19, v23, s66
  v_perm_b32 v135, v23, v27, s66
  v_perm_b32 v136, v27, v31, s66
  v_perm_b32 v137, v31, v35, s66
  v_dot2_f32_bf16 v106, v132, v65, 0
  v_dot2_f32_bf16 v114, v133, v65, 0
  v_dot2_f32_bf16 v122, v134, v65, 0
  v_dot2_f32_bf16 v130, v135, v65, 0
  v_dot2_f32_bf16 v106, v134, v64, v106
  v_dot2_f32_bf16 v114, v135, v64, v114
  v_dot2_f32_bf16 v122, v136, v64, v122
  v_dot2_f32_bf16 v130, v137, v64, v130
  v_perm_b32 v138, v11, v15, s67
  v_perm_b32 v139, v15, v19, s67
  v_perm_b32 v140, v19, v23, s67
  v_perm_b32 v141, v23, v27, s67
  v_perm_b32 v142, v27, v31, s67
  v_perm_b32 v143, v31, v35, s67
  v_dot2_f32_bf16 v107, v138, v67, 0
  v_dot2_f32_bf16 v115, v139, v67, 0
  v_dot2_f32_bf16 v123, v140, v67, 0
  v_dot2_f32_bf16 v131, v141, v67, 0
  v_dot2_f32_bf16 v107, v140, v66, v107
  v_dot2_f32_bf16 v115, v141, v66, v115
  v_dot2_f32_bf16 v123, v142, v66, v123
  v_dot2_f32_bf16 v131, v143, v66, v131
  s_waitcnt vmcnt(11)
  v_lshlrev_b32 v132, 16, v36
  v_lshlrev_b32 v133, 16, v40
  v_lshlrev_b32 v134, 16, v44
  v_lshlrev_b32 v135, 16, v48
  v_mul_f32 v100, v100, v132
  v_mul_f32 v108, v108, v133
  v_mul_f32 v116, v116, v134
  v_mul_f32 v124, v124, v135
  v_cvt_pk_bf16_f32 v140, v124, v116
  v_cvt_pk_bf16_f32 v141, v108, v100
  ds_write_b64 v99, v[140:141] offset:0
  v_and_b32 v136, 0xffff0000, v36
  v_and_b32 v137, 0xffff0000, v40
  v_and_b32 v138, 0xffff0000, v44
  v_and_b32 v139, 0xffff0000, v48
  v_mul_f32 v101, v101, v136
  v_mul_f32 v109, v109, v137
  v_mul_f32 v117, v117, v138
  v_mul_f32 v125, v125, v139
  v_cvt_pk_bf16_f32 v142, v125, v117
  v_cvt_pk_bf16_f32 v143, v109, v101
  ds_write_b64 v99, v[142:143] offset:256
  v_lshlrev_b32 v132, 16, v37
  v_lshlrev_b32 v133, 16, v41
  v_lshlrev_b32 v134, 16, v45
  v_lshlrev_b32 v135, 16, v49
  v_mul_f32 v102, v102, v132
  v_mul_f32 v110, v110, v133
  v_mul_f32 v118, v118, v134
  v_mul_f32 v126, v126, v135
  v_cvt_pk_bf16_f32 v140, v126, v118
  v_cvt_pk_bf16_f32 v141, v110, v102
  ds_write_b64 v99, v[140:141] offset:512
  v_and_b32 v136, 0xffff0000, v37
  v_and_b32 v137, 0xffff0000, v41
  v_and_b32 v138, 0xffff0000, v45
  v_and_b32 v139, 0xffff0000, v49
  v_mul_f32 v103, v103, v136
  v_mul_f32 v111, v111, v137
  v_mul_f32 v119, v119, v138
  v_mul_f32 v127, v127, v139
  v_cvt_pk_bf16_f32 v142, v127, v119
  v_cvt_pk_bf16_f32 v143, v111, v103
  ds_write_b64 v99, v[142:143] offset:768
  v_lshlrev_b32 v132, 16, v38
  v_lshlrev_b32 v133, 16, v42
  v_lshlrev_b32 v134, 16, v46
  v_lshlrev_b32 v135, 16, v50
  v_mul_f32 v104, v104, v132
  v_mul_f32 v112, v112, v133
  v_mul_f32 v120, v120, v134
  v_mul_f32 v128, v128, v135
  v_cvt_pk_bf16_f32 v140, v128, v120
  v_cvt_pk_bf16_f32 v141, v112, v104
  ds_write_b64 v99, v[140:141] offset:1024
  v_and_b32 v136, 0xffff0000, v38
  v_and_b32 v137, 0xffff0000, v42
  v_and_b32 v138, 0xffff0000, v46
  v_and_b32 v139, 0xffff0000, v50
  v_mul_f32 v105, v105, v136
  v_mul_f32 v113, v113, v137
  v_mul_f32 v121, v121, v138
  v_mul_f32 v129, v129, v139
  v_cvt_pk_bf16_f32 v142, v129, v121
  v_cvt_pk_bf16_f32 v143, v113, v105
  ds_write_b64 v99, v[142:143] offset:1280
  v_lshlrev_b32 v132, 16, v39
  v_lshlrev_b32 v133, 16, v43
  v_lshlrev_b32 v134, 16, v47
  v_lshlrev_b32 v135, 16, v51
  v_mul_f32 v106, v106, v132
  v_mul_f32 v114, v114, v133
  v_mul_f32 v122, v122, v134
  v_mul_f32 v130, v130, v135
  v_cvt_pk_bf16_f32 v140, v130, v122
  v_cvt_pk_bf16_f32 v141, v114, v106
  ds_write_b64 v99, v[140:141] offset:1536
  v_and_b32 v136, 0xffff0000, v39
  v_and_b32 v137, 0xffff0000, v43
  v_and_b32 v138, 0xffff0000, v47
  v_and_b32 v139, 0xffff0000, v51
  v_mul_f32 v107, v107, v136
  v_mul_f32 v115, v115, v137
  v_mul_f32 v123, v123, v138
  v_mul_f32 v131, v131, v139
  v_cvt_pk_bf16_f32 v142, v131, v123
  v_cvt_pk_bf16_f32 v143, v115, v107
  ds_write_b64 v99, v[142:143] offset:1792
  v_lshrrev_b32 v100, 4, v0
  v_and_b32 v101, 15, v0
  v_lshrrev_b32 v102, 3, v100
  v_xor_b32 v103, v101, v102
  v_lshlrev_b32 v103, 4, v103
  v_lshl_add_u32 v103, v100, 8, v103
  v_add_u32 v103, 86016, v103
  s_lshl_b32 s68, s50, 18
  s_lshl_b32 s69, s51, 8
  s_sub_u32 s68, s68, s69
  s_add_u32 s68, s68, 3840
  v_lshlrev_b32 v104, 12, v100
  v_lshl_add_u32 v104, v101, 4, v104
  v_add_u32 v104, s68, v104
  s_waitcnt lgkmcnt(0)
  s_barrier
  v_mov_b32 v105, v103
  ds_read_b128 v[108:111], v105 offset:0
  v_xor_b32 v105, 32, v103
  ds_read_b128 v[112:115], v105 offset:4096
  v_xor_b32 v105, 64, v103
  ds_read_b128 v[116:119], v105 offset:8192
  v_xor_b32 v105, 96, v103
  ds_read_b128 v[120:123], v105 offset:12288
  s_waitcnt lgkmcnt(3)
  s_mov_b32 s69, 0
  buffer_store_dwordx4 v[108:111], v104, s[20:23], s69 offen sc1
  s_waitcnt lgkmcnt(2)
  s_mov_b32 s69, 65536
  buffer_store_dwordx4 v[112:115], v104, s[20:23], s69 offen sc1
  s_waitcnt lgkmcnt(1)
  s_mov_b32 s69, 131072
  buffer_store_dwordx4 v[116:119], v104, s[20:23], s69 offen sc1
  s_waitcnt lgkmcnt(0)
  s_mov_b32 s69, 196608
  buffer_store_dwordx4 v[120:123], v104, s[20:23], s69 offen sc1
  buffer_load_dword v153, v152, s[36:39], 0 offen sc1
  s_waitcnt vmcnt(0)
  s_barrier
  s_mov_b32 s49, 200000
FMC_tag:
  v_readfirstlane_b32 s48, v153
  s_cmp_lg_u32 s48, 0
  s_cbranch_scc1 FMC_tagok
  s_sub_u32 s49, s49, 1
  s_cmp_eq_u32 s49, 0
  s_cbranch_scc1 FMC_tagok
  s_sleep 1
  buffer_load_dword v153, v152, s[36:39], 0 offen sc1
  s_waitcnt vmcnt(0)
  s_branch FMC_tag
FMC_tagok:
  s_mov_b32 s100, s48
  s_mov_b32 s101, s44
  s_cmp_lg_u32 s44, 0
  s_cbranch_scc1 FM_noflag
  s_lshl_b32 s68, s2, 7
  v_mov_b32 v160, s68
  v_mov_b32 v153, s48
  v_cmp_eq_u32 vcc, 0, v1
  s_and_saveexec_b64 s[70:71], vcc
  buffer_store_dword v153, v160, s[32:35], 0 offen sc1
  s_mov_b64 exec, s[70:71]
FM_noflag:

  v_mov_b32 v124, 0
  v_mov_b32 v125, 0
  v_mov_b32 v126, 0
  v_mov_b32 v127, 0
  v_add_u32 v159, s46, v155
  v_cmp_gt_u32 vcc, 32, v1
  s_and_saveexec_b64 s[70:71], vcc
  ds_write_b128 v159, v[124:127] offset:20736
  s_mov_b64 exec, s[70:71]

  v_alignbit_b32 v128, v69, v68, 16
  v_alignbit_b32 v129, v70, v69, 16
  v_alignbit_b32 v130, v71, v70, 16
  v_alignbit_b32 v131, v72, v71, 16
  v_mov_b32 v132, v69
  v_mov_b32 v133, v70
  v_mov_b32 v134, v71
  v_mov_b32 v135, v72
  v_alignbit_b32 v136, v70, v69, 16
  v_alignbit_b32 v137, v71, v70, 16
  v_alignbit_b32 v138, v72, v71, 16
  v_alignbit_b32 v139, v73, v72, 16
  ds_write_b128 v159, v[68:71] offset:0
  ds_write_b128 v159, v[128:131] offset:4160
  ds_write_b128 v159, v[132:135] offset:8320
  ds_write_b128 v159, v[136:139] offset:12480
  s_waitcnt lgkmcnt(4)
  v_alignbit_b32 v128, v75, v74, 16
  v_alignbit_b32 v129, v76, v75, 16
  v_alignbit_b32 v130, v77, v76, 16
  v_alignbit_b32 v131, v78, v77, 16
  v_mov_b32 v132, v75
  v_mov_b32 v133, v76
  v_mov_b32 v134, v77
  v_mov_b32 v135, v78
  v_alignbit_b32 v136, v76, v75, 16
  v_alignbit_b32 v137, v77, v76, 16
  v_alignbit_b32 v138, v78, v77, 16
  v_alignbit_b32 v139, v79, v78, 16
  ds_write_b128 v159, v[74:77] offset:1024
  ds_write_b128 v159, v[128:131] offset:5184
  ds_write_b128 v159, v[132:135] offset:9344
  ds_write_b128 v159, v[136:139] offset:13504
  s_waitcnt lgkmcnt(4)
  v_alignbit_b32 v128, v81, v80, 16
  v_alignbit_b32 v129, v82, v81, 16
  v_alignbit_b32 v130, v83, v82, 16
  v_alignbit_b32 v131, v84, v83, 16
  v_mov_b32 v132, v81
  v_mov_b32 v133, v82
  v_mov_b32 v134, v83
  v_mov_b32 v135, v84
  v_alignbit_b32 v136, v82, v81, 16
  v_alignbit_b32 v137, v83, v82, 16
  v_alignbit_b32 v138, v84, v83, 16
  v_alignbit_b32 v139, v85, v84, 16
  ds_write_b128 v159, v[80:83] offset:2048
  ds_write_b128 v159, v[128:131] offset:6208
  ds_write_b128 v159, v[132:135] offset:10368
  ds_write_b128 v159, v[136:139] offset:14528
  s_waitcnt lgkmcnt(4)
  v_alignbit_b32 v128, v87, v86, 16
  v_alignbit_b32 v129, v88, v87, 16
  v_alignbit_b32 v130, v89, v88, 16
  v_alignbit_b32 v131, v90, v89, 16
  v_mov_b32 v132, v87
  v_mov_b32 v133, v88
  v_mov_b32 v134, v89
  v_mov_b32 v135, v90
  v_alignbit_b32 v136, v88, v87, 16
  v_alignbit_b32 v137, v89, v88, 16
  v_alignbit_b32 v138, v90, v89, 16
  v_alignbit_b32 v139, v91, v90, 16
  ds_write_b128 v159, v[86:89] offset:3072
  ds_write_b128 v159, v[128:131] offset:7232
  ds_write_b128 v159, v[132:135] offset:11392
  ds_write_b128 v159, v[136:139] offset:15552
  s_waitcnt lgkmcnt(4)
  v_alignbit_b32 v128, v93, v92, 16
  v_alignbit_b32 v129, v94, v93, 16
  v_alignbit_b32 v130, v95, v94, 16
  v_alignbit_b32 v131, v96, v95, 16
  v_mov_b32 v132, v93
  v_mov_b32 v133, v94
  v_mov_b32 v134, v95
  v_mov_b32 v135, v96
  v_alignbit_b32 v136, v94, v93, 16
  v_alignbit_b32 v137, v95, v94, 16
  v_alignbit_b32 v138, v96, v95, 16
  v_alignbit_b32 v139, v97, v96, 16
  v_cmp_gt_u32 vcc, 2, v1
  s_and_saveexec_b64 s[70:71], vcc
  ds_write_b128 v159, v[92:95] offset:4096
  ds_write_b128 v159, v[128:131] offset:8256
  ds_write_b128 v159, v[132:135] offset:12416
  ds_write_b128 v159, v[136:139] offset:16576
  s_mov_b64 exec, s[70:71]
  v_and_b32 v50, 15, v1
  v_lshrrev_b32 v51, 4, v1
  v_add_u32 v52, 1, v50
  v_and_b32 v53, 3, v52
  v_mul_u32_u24 v54, 4160, v53
  v_sub_u32 v52, v52, v53
  v_lshl_add_u32 v54, v52, 1, v54
  v_lshl_add_u32 v54, v51, 4, v54
  v_add_u32 v54, s46, v54
  v_lshlrev_b32 v55, 5, v50
  v_lshlrev_b32 v56, 4, v51
  v_sub_u32 v56, v56, v55
  v_add_u32 v56, 17120, v56
  v_add_u32 v56, s46, v56
  v_lshlrev_b32 v57, 3, v51
  v_add_u32 v57, v57, v55
  v_sub_u32 v58, 17144, v57
  v_add_u32 v58, s46, v58
  v_add_u32 v57, s47, v57
  v_lshlrev_b32 v48, 16, v98

  v_and_b32 v160, 15, v1
  s_lshl_b32 s68, s50, 4
  v_add_u32 v160, s68, v160
  v_lshlrev_b32 v160, 7, v160
  s_mov_b32 s49, 200000
FM_poll:
  buffer_load_dword v153, v160, s[32:35], 0 offen sc1
  s_waitcnt vmcnt(0)
  v_cmp_ne_u32 vcc, s48, v153
  s_cbranch_vccz FM_go
  s_sub_u32 s49, s49, 1
  s_cmp_eq_u32 s49, 0
  s_cbranch_scc1 FM_go
  s_sleep 1
  s_branch FM_poll
FM_go:
  s_add_u32 m0, s46, 16640
  s_nop 0
  buffer_load_dwordx4 v155, s[20:23], s47 offen sc1 lds
  buffer_load_dwordx4 v155, s[20:23], s47 offen offset:1024 sc1 lds
  buffer_load_dwordx4 v155, s[20:23], s47 offen offset:2048 sc1 lds
  buffer_load_dwordx4 v155, s[20:23], s47 offen offset:3072 sc1 lds
  s_waitcnt vmcnt(0) lgkmcnt(0)
  s_mul_hi_u32 s76, s2, 238609295
  s_mul_i32 s77, s76, 18
  s_sub_u32 s77, s2, s77
  v_lshrrev_b32 v164, 3, v1
  v_bfe_u32 v165, v1, 1, 2
  v_bfe_u32 v166, v1, 4, 2
  v_xor_b32 v166, v166, v165
  v_mul_u32_u24 v164, 1152, v164
  v_lshl_add_u32 v164, v166, 5, v164
  v_and_b32 v165, 1, v1
  v_lshl_add_u32 v164, v165, 4, v164
  s_mul_i32 s78, s76, 576
  s_lshl_b32 s79, s77, 5
  s_add_u32 s78, s78, s79
  s_lshl_b32 s79, s44, 3
  s_add_u32 s78, s78, s79
  s_mul_i32 s78, s78, 1152
  s_lshl_b32 s79, s44, 10
  s_add_u32 s79, s79, 102400
  s_add_u32 m0, s79, 0
  s_add_u32 s80, s78, 0
  buffer_load_dwordx4 v164, s[72:75], s80 offen nt lds
  s_add_u32 m0, s79, 4096
  s_add_u32 s80, s78, 128
  buffer_load_dwordx4 v164, s[72:75], s80 offen nt lds
  s_add_u32 m0, s79, 8192
  s_add_u32 s80, s78, 256
  buffer_load_dwordx4 v164, s[72:75], s80 offen nt lds
  s_add_u32 m0, s79, 12288
  s_add_u32 s80, s78, 384
  buffer_load_dwordx4 v164, s[72:75], s80 offen nt lds
  s_add_u32 m0, s79, 16384
  s_add_u32 s80, s78, 512
  buffer_load_dwordx4 v164, s[72:75], s80 offen nt lds
  s_add_u32 m0, s79, 20480
  s_add_u32 s80, s78, 640
  buffer_load_dwordx4 v164, s[72:75], s80 offen nt lds
  s_add_u32 m0, s79, 24576
  s_add_u32 s80, s78, 768
  buffer_load_dwordx4 v164, s[72:75], s80 offen nt lds
  s_add_u32 m0, s79, 28672
  s_add_u32 s80, s78, 896
  buffer_load_dwordx4 v164, s[72:75], s80 offen nt lds
  s_add_u32 m0, s79, 32768
  s_add_u32 s80, s78, 1024
  buffer_load_dwordx4 v164, s[72:75], s80 offen nt lds
  s_lshr_b32 s90, s2, 6
  s_lshl_b32 s90, s90, 3
  s_and_b32 s91, s2, 7
  s_add_u32 s90, s90, s91
  s_lshl_b32 s90, s90, 6
  s_bfe_u32 s91, s2, 0x30003
  s_lshl_b32 s91, s91, 3
  s_add_u32 s90, s90, s91
  s_mul_i32 s90, s90, 1152
  v_lshlrev_b32 v161, 7, v0
  v_cmp_gt_u32 vcc, 72, v0
  v_add_u32 v161, s90, v161
  s_nop 0
  v_cndmask_b32 v161, -1, v161, vcc
  buffer_load_dword v162, v161, s[84:87], 0 offen
  ds_read_b64 v[32:33], v54 offset:0
  ds_read_b64 v[34:35], v54 offset:8
  ds_read_b128 a[224:227], v56 offset:3584
  ds_read_b128 a[192:195], v56 offset:3072
  ds_read_b128 a[160:163], v56 offset:2560
  ds_read_b128 a[128:131], v56 offset:2048
  ds_read_b128 a[96:99], v56 offset:1536
  ds_read_b128 a[64:67], v56 offset:1024
  ds_read_b128 a[32:35], v56 offset:512
  ds_read_b128 a[0:3], v56 offset:0
  ds_read_b64 v[36:37], v54 offset:64
  ds_read_b64 v[38:39], v54 offset:72
  s_waitcnt lgkmcnt(9)
  v_mfma_f32_16x16x32_bf16 v[64:67], v[32:35], a[224:227], 0
  ds_read_b128 a[228:231], v56 offset:3648
  ds_read_b64 v[40:41], v54 offset:128
  ds_read_b64 v[42:43], v54 offset:136
  s_waitcnt lgkmcnt(11)
  v_mfma_f32_16x16x32_bf16 v[68:71], v[32:35], a[192:195], 0
  ds_read_b128 a[196:199], v56 offset:3136
  s_waitcnt lgkmcnt(11)
  v_mfma_f32_16x16x32_bf16 v[72:75], v[32:35], a[160:163], 0
  ds_read_b128 a[164:167], v56 offset:2624
  s_waitcnt lgkmcnt(11)
  v_mfma_f32_16x16x32_bf16 v[76:79], v[32:35], a[128:131], 0
  ds_read_b128 a[132:135], v56 offset:2112
  s_waitcnt lgkmcnt(11)
  v_mfma_f32_16x16x32_bf16 v[80:83], v[32:35], a[96:99], 0
  ds_read_b128 a[100:103], v56 offset:1600
  s_waitcnt lgkmcnt(11)
  v_mfma_f32_16x16x32_bf16 v[84:87], v[32:35], a[64:67], 0
  ds_read_b128 a[68:71], v56 offset:1088
  s_waitcnt lgkmcnt(11)
  v_mfma_f32_16x16x32_bf16 v[88:91], v[32:35], a[32:35], 0
  ds_read_b128 a[36:39], v56 offset:576
  s_waitcnt lgkmcnt(11)
  v_mfma_f32_16x16x32_bf16 v[92:95], v[32:35], a[0:3], 0
  ds_read_b128 a[4:7], v56 offset:64
  ds_read_b64 v[8:9], v58 offset:3584
  s_waitcnt lgkmcnt(10)
  v_mfma_f32_16x16x32_bf16 v[64:67], v[36:39], a[228:231], v[64:67]
  ds_read_b128 a[232:235], v56 offset:3712
  ds_read_b64 v[44:45], v54 offset:192
  ds_read_b64 v[46:47], v54 offset:200
  s_waitcnt lgkmcnt(10)
  v_mfma_f32_16x16x32_bf16 v[68:71], v[36:39], a[196:199], v[68:71]
  ds_read_b128 a[200:203], v56 offset:3200
  s_waitcnt lgkmcnt(10)
  v_mfma_f32_16x16x32_bf16 v[72:75], v[36:39], a[164:167], v[72:75]
  ds_read_b128 a[168:171], v56 offset:2688
  s_waitcnt lgkmcnt(10)
  v_mfma_f32_16x16x32_bf16 v[76:79], v[36:39], a[132:135], v[76:79]
  ds_read_b128 a[136:139], v56 offset:2176
  s_waitcnt lgkmcnt(10)
  v_mfma_f32_16x16x32_bf16 v[80:83], v[36:39], a[100:103], v[80:83]
  ds_read_b128 a[104:107], v56 offset:1664
  s_waitcnt lgkmcnt(10)
  v_mfma_f32_16x16x32_bf16 v[84:87], v[36:39], a[68:71], v[84:87]
  ds_read_b128 a[72:75], v56 offset:1152
  s_waitcnt lgkmcnt(10)
  v_mfma_f32_16x16x32_bf16 v[88:91], v[36:39], a[36:39], v[88:91]
  ds_read_b128 a[40:43], v56 offset:640
  s_waitcnt lgkmcnt(10)
  v_mfma_f32_16x16x32_bf16 v[92:95], v[36:39], a[4:7], v[92:95]
  ds_read_b128 a[8:11], v56 offset:128
  s_waitcnt lgkmcnt(9)
  v_mfma_f32_16x16x32_bf16 v[64:67], v[40:43], a[232:235], v[64:67]
  ds_read_b128 a[236:239], v56 offset:3776
  ds_read_b64 v[32:33], v54 offset:256
  ds_read_b64 v[34:35], v54 offset:264
  s_waitcnt lgkmcnt(9)
  v_mfma_f32_16x16x32_bf16 v[68:71], v[40:43], a[200:203], v[68:71]
  ds_read_b128 a[204:207], v56 offset:3264
  s_waitcnt lgkmcnt(9)
  v_mfma_f32_16x16x32_bf16 v[72:75], v[40:43], a[168:171], v[72:75]
  ds_read_b128 a[172:175], v56 offset:2752
  s_waitcnt lgkmcnt(9)
  v_mfma_f32_16x16x32_bf16 v[76:79], v[40:43], a[136:139], v[76:79]
  ds_read_b128 a[140:143], v56 offset:2240
  s_waitcnt lgkmcnt(9)
  v_mfma_f32_16x16x32_bf16 v[80:83], v[40:43], a[104:107], v[80:83]
  ds_read_b128 a[108:111], v56 offset:1728
  s_waitcnt lgkmcnt(9)
  v_mfma_f32_16x16x32_bf16 v[84:87], v[40:43], a[72:75], v[84:87]
  ds_read_b128 a[76:79], v56 offset:1216
  s_waitcnt lgkmcnt(9)
  v_mfma_f32_16x16x32_bf16 v[88:91], v[40:43], a[40:43], v[88:91]
  ds_read_b128 a[44:47], v56 offset:704
  s_waitcnt lgkmcnt(9)
  v_mfma_f32_16x16x32_bf16 v[92:95], v[40:43], a[8:11], v[92:95]
  ds_read_b128 a[12:15], v56 offset:192
  s_waitcnt lgkmcnt(9)
  v_mfma_f32_16x16x32_bf16 v[64:67], v[44:47], a[236:239], v[64:67]
  ds_read_b128 a[240:243], v56 offset:3840
  ds_read_b64 v[36:37], v54 offset:320
  ds_read_b64 v[38:39], v54 offset:328
  s_waitcnt lgkmcnt(9)
  v_mfma_f32_16x16x32_bf16 v[68:71], v[44:47], a[204:207], v[68:71]
  ds_read_b128 a[208:211], v56 offset:3328
  s_waitcnt lgkmcnt(9)
  v_mfma_f32_16x16x32_bf16 v[72:75], v[44:47], a[172:175], v[72:75]
  ds_read_b128 a[176:179], v56 offset:2816
  s_waitcnt lgkmcnt(9)
  v_mfma_f32_16x16x32_bf16 v[76:79], v[44:47], a[140:143], v[76:79]
  ds_read_b128 a[144:147], v56 offset:2304
  s_waitcnt lgkmcnt(9)
  v_mfma_f32_16x16x32_bf16 v[80:83], v[44:47], a[108:111], v[80:83]
  ds_read_b128 a[112:115], v56 offset:1792
  s_waitcnt lgkmcnt(9)
  v_mfma_f32_16x16x32_bf16 v[84:87], v[44:47], a[76:79], v[84:87]
  ds_read_b128 a[80:83], v56 offset:1280
  s_waitcnt lgkmcnt(9)
  v_mfma_f32_16x16x32_bf16 v[88:91], v[44:47], a[44:47], v[88:91]
  ds_read_b128 a[48:51], v56 offset:768
  s_waitcnt lgkmcnt(9)
  v_mfma_f32_16x16x32_bf16 v[92:95], v[44:47], a[12:15], v[92:95]
  ds_read_b128 a[16:19], v56 offset:256
  s_waitcnt lgkmcnt(9)
  v_mfma_f32_16x16x32_bf16 v[64:67], v[32:35], a[240:243], v[64:67]
  ds_read_b128 a[244:247], v56 offset:3904
  ds_read_b64 v[40:41], v54 offset:384
  ds_read_b64 v[42:43], v54 offset:392
  s_waitcnt lgkmcnt(9)
  v_mfma_f32_16x16x32_bf16 v[68:71], v[32:35], a[208:211], v[68:71]
  ds_read_b128 a[212:215], v56 offset:3392
  s_waitcnt lgkmcnt(9)
  v_mfma_f32_16x16x32_bf16 v[72:75], v[32:35], a[176:179], v[72:75]
  ds_read_b128 a[180:183], v56 offset:2880
  s_waitcnt lgkmcnt(9)
  v_mfma_f32_16x16x32_bf16 v[76:79], v[32:35], a[144:147], v[76:79]
  ds_read_b128 a[148:151], v56 offset:2368
  s_waitcnt lgkmcnt(9)
  v_mfma_f32_16x16x32_bf16 v[80:83], v[32:35], a[112:115], v[80:83]
  ds_read_b128 a[116:119], v56 offset:1856
  s_waitcnt lgkmcnt(9)
  v_mfma_f32_16x16x32_bf16 v[84:87], v[32:35], a[80:83], v[84:87]
  ds_read_b128 a[84:87], v56 offset:1344
  s_waitcnt lgkmcnt(9)
  v_mfma_f32_16x16x32_bf16 v[88:91], v[32:35], a[48:51], v[88:91]
  ds_read_b128 a[52:55], v56 offset:832
  s_waitcnt lgkmcnt(9)
  v_mfma_f32_16x16x32_bf16 v[92:95], v[32:35], a[16:19], v[92:95]
  ds_read_b128 a[20:23], v56 offset:320
  s_waitcnt lgkmcnt(9)
  v_mfma_f32_16x16x32_bf16 v[64:67], v[36:39], a[244:247], v[64:67]
  ds_read_b128 a[248:251], v56 offset:3968
  ds_read_b64 v[44:45], v54 offset:448
  ds_read_b64 v[46:47], v54 offset:456
  s_waitcnt lgkmcnt(9)
  v_mfma_f32_16x16x32_bf16 v[68:71], v[36:39], a[212:215], v[68:71]
  ds_read_b128 a[216:219], v56 offset:3456
  s_waitcnt lgkmcnt(9)
  v_mfma_f32_16x16x32_bf16 v[72:75], v[36:39], a[180:183], v[72:75]
  ds_read_b128 a[184:187], v56 offset:2944
  s_waitcnt lgkmcnt(9)
  v_mfma_f32_16x16x32_bf16 v[76:79], v[36:39], a[148:151], v[76:79]
  ds_read_b128 a[152:155], v56 offset:2432
  s_waitcnt lgkmcnt(9)
  v_mfma_f32_16x16x32_bf16 v[80:83], v[36:39], a[116:119], v[80:83]
  ds_read_b128 a[120:123], v56 offset:1920
  s_waitcnt lgkmcnt(9)
  v_mfma_f32_16x16x32_bf16 v[84:87], v[36:39], a[84:87], v[84:87]
  ds_read_b128 a[88:91], v56 offset:1408
  s_waitcnt lgkmcnt(9)
  v_mfma_f32_16x16x32_bf16 v[88:91], v[36:39], a[52:55], v[88:91]
  ds_read_b128 a[56:59], v56 offset:896
  s_waitcnt lgkmcnt(9)
  v_mfma_f32_16x16x32_bf16 v[92:95], v[36:39], a[20:23], v[92:95]
  ds_read_b128 a[24:27], v56 offset:384
  s_waitcnt lgkmcnt(9)
  v_mfma_f32_16x16x32_bf16 v[64:67], v[40:43], a[248:251], v[64:67]
  ds_read_b128 a[252:255], v56 offset:4032
  ds_read_b64 v[32:33], v54 offset:512
  ds_read_b64 v[34:35], v54 offset:520
  s_waitcnt lgkmcnt(9)
  v_mfma_f32_16x16x32_bf16 v[68:71], v[40:43], a[216:219], v[68:71]
  ds_read_b128 a[220:223], v56 offset:3520
  s_waitcnt lgkmcnt(9)
  v_mfma_f32_16x16x32_bf16 v[72:75], v[40:43], a[184:187], v[72:75]
  ds_read_b128 a[188:191], v56 offset:3008
  s_waitcnt lgkmcnt(9)
  v_mfma_f32_16x16x32_bf16 v[76:79], v[40:43], a[152:155], v[76:79]
  ds_read_b128 a[156:159], v56 offset:2496
  s_waitcnt lgkmcnt(9)
  v_mfma_f32_16x16x32_bf16 v[80:83], v[40:43], a[120:123], v[80:83]
  ds_read_b128 a[124:127], v56 offset:1984
  s_waitcnt lgkmcnt(9)
  v_mfma_f32_16x16x32_bf16 v[84:87], v[40:43], a[88:91], v[84:87]
  ds_read_b128 a[92:95], v56 offset:1472
  s_waitcnt lgkmcnt(9)
  v_mfma_f32_16x16x32_bf16 v[88:91], v[40:43], a[56:59], v[88:91]
  ds_read_b128 a[60:63], v56 offset:960
  s_waitcnt lgkmcnt(9)
  v_mfma_f32_16x16x32_bf16 v[92:95], v[40:43], a[24:27], v[92:95]
  ds_read_b128 a[28:31], v56 offset:448
  s_waitcnt lgkmcnt(9)
  v_mfma_f32_16x16x32_bf16 v[64:67], v[44:47], a[252:255], v[64:67]
  ds_read_b64 v[36:37], v54 offset:576
  ds_read_b64 v[38:39], v54 offset:584
  s_waitcnt lgkmcnt(8)
  v_mfma_f32_16x16x32_bf16 v[68:71], v[44:47], a[220:223], v[68:71]
  s_waitcnt lgkmcnt(7)
  v_mfma_f32_16x16x32_bf16 v[72:75], v[44:47], a[188:191], v[72:75]
  s_waitcnt lgkmcnt(6)
  v_mfma_f32_16x16x32_bf16 v[76:79], v[44:47], a[156:159], v[76:79]
  s_waitcnt lgkmcnt(5)
  v_mfma_f32_16x16x32_bf16 v[80:83], v[44:47], a[124:127], v[80:83]
  s_waitcnt lgkmcnt(4)
  v_mfma_f32_16x16x32_bf16 v[84:87], v[44:47], a[92:95], v[84:87]
  v_and_b32 v100, 0xffff0000, v9
  v_lshlrev_b32 v101, 16, v9
  s_waitcnt lgkmcnt(3)
  v_mfma_f32_16x16x32_bf16 v[88:91], v[44:47], a[60:63], v[88:91]
  v_and_b32 v102, 0xffff0000, v8
  v_lshlrev_b32 v103, 16, v8
  s_waitcnt lgkmcnt(2)
  v_mfma_f32_16x16x32_bf16 v[92:95], v[44:47], a[28:31], v[92:95]
  v_fma_f32 v100, v100, v48, v64
  v_fma_f32 v101, v101, v48, v65
  v_mfma_f32_16x16x32_bf16 v[68:71], v[32:35], a[224:227], v[68:71]
  ds_read_b64 v[40:41], v54 offset:640
  ds_read_b64 v[42:43], v54 offset:648
  ds_read_b64 v[10:11], v58 offset:3072
  v_mfma_f32_16x16x32_bf16 v[72:75], v[32:35], a[192:195], v[72:75]
  v_fma_f32 v102, v102, v48, v66
  v_fma_f32 v103, v103, v48, v67
  v_mfma_f32_16x16x32_bf16 v[76:79], v[32:35], a[160:163], v[76:79]
  v_cvt_pk_bf16_f32 v108, v100, v101
  v_cvt_pk_bf16_f32 v109, v102, v103
  v_mfma_f32_16x16x32_bf16 v[80:83], v[32:35], a[128:131], v[80:83]
  buffer_store_dwordx2 v[108:109], v57, s[28:31], 0 offen offset:0 sc1
  v_mfma_f32_16x16x32_bf16 v[84:87], v[32:35], a[96:99], v[84:87]
  v_mfma_f32_16x16x32_bf16 v[88:91], v[32:35], a[64:67], v[88:91]
  v_mfma_f32_16x16x32_bf16 v[92:95], v[32:35], a[32:35], v[92:95]
  s_waitcnt lgkmcnt(3)
  v_mfma_f32_16x16x32_bf16 v[68:71], v[36:39], a[228:231], v[68:71]
  ds_read_b64 v[44:45], v54 offset:704
  ds_read_b64 v[46:47], v54 offset:712
  v_mfma_f32_16x16x32_bf16 v[72:75], v[36:39], a[196:199], v[72:75]
  v_mfma_f32_16x16x32_bf16 v[76:79], v[36:39], a[164:167], v[76:79]
  v_mfma_f32_16x16x32_bf16 v[80:83], v[36:39], a[132:135], v[80:83]
  v_mfma_f32_16x16x32_bf16 v[84:87], v[36:39], a[100:103], v[84:87]
  v_mfma_f32_16x16x32_bf16 v[88:91], v[36:39], a[68:71], v[88:91]
  v_mfma_f32_16x16x32_bf16 v[92:95], v[36:39], a[36:39], v[92:95]
  s_waitcnt lgkmcnt(3)
  v_mfma_f32_16x16x32_bf16 v[68:71], v[40:43], a[232:235], v[68:71]
  ds_read_b64 v[32:33], v54 offset:768
  ds_read_b64 v[34:35], v54 offset:776
  v_mfma_f32_16x16x32_bf16 v[72:75], v[40:43], a[200:203], v[72:75]
  v_mfma_f32_16x16x32_bf16 v[76:79], v[40:43], a[168:171], v[76:79]
  v_mfma_f32_16x16x32_bf16 v[80:83], v[40:43], a[136:139], v[80:83]
  v_mfma_f32_16x16x32_bf16 v[84:87], v[40:43], a[104:107], v[84:87]
  v_mfma_f32_16x16x32_bf16 v[88:91], v[40:43], a[72:75], v[88:91]
  v_mfma_f32_16x16x32_bf16 v[92:95], v[40:43], a[40:43], v[92:95]
  s_waitcnt lgkmcnt(2)
  v_mfma_f32_16x16x32_bf16 v[68:71], v[44:47], a[236:239], v[68:71]
  ds_read_b64 v[36:37], v54 offset:832
  ds_read_b64 v[38:39], v54 offset:840
  v_mfma_f32_16x16x32_bf16 v[72:75], v[44:47], a[204:207], v[72:75]
  v_mfma_f32_16x16x32_bf16 v[76:79], v[44:47], a[172:175], v[76:79]
  v_mfma_f32_16x16x32_bf16 v[80:83], v[44:47], a[140:143], v[80:83]
  v_mfma_f32_16x16x32_bf16 v[84:87], v[44:47], a[108:111], v[84:87]
  v_mfma_f32_16x16x32_bf16 v[88:91], v[44:47], a[76:79], v[88:91]
  v_mfma_f32_16x16x32_bf16 v[92:95], v[44:47], a[44:47], v[92:95]
  s_waitcnt lgkmcnt(2)
  v_mfma_f32_16x16x32_bf16 v[68:71], v[32:35], a[240:243], v[68:71]
  ds_read_b64 v[40:41], v54 offset:896
  ds_read_b64 v[42:43], v54 offset:904
  v_mfma_f32_16x16x32_bf16 v[72:75], v[32:35], a[208:211], v[72:75]
  v_mfma_f32_16x16x32_bf16 v[76:79], v[32:35], a[176:179], v[76:79]
  v_mfma_f32_16x16x32_bf16 v[80:83], v[32:35], a[144:147], v[80:83]
  v_mfma_f32_16x16x32_bf16 v[84:87], v[32:35], a[112:115], v[84:87]
  v_mfma_f32_16x16x32_bf16 v[88:91], v[32:35], a[80:83], v[88:91]
  v_mfma_f32_16x16x32_bf16 v[92:95], v[32:35], a[48:51], v[92:95]
  s_waitcnt lgkmcnt(2)
  v_mfma_f32_16x16x32_bf16 v[68:71], v[36:39], a[244:247], v[68:71]
  ds_read_b64 v[44:45], v54 offset:960
  ds_read_b64 v[46:47], v54 offset:968
  v_mfma_f32_16x16x32_bf16 v[72:75], v[36:39], a[212:215], v[72:75]
  v_mfma_f32_16x16x32_bf16 v[76:79], v[36:39], a[180:183], v[76:79]
  v_mfma_f32_16x16x32_bf16 v[80:83], v[36:39], a[148:151], v[80:83]
  v_mfma_f32_16x16x32_bf16 v[84:87], v[36:39], a[116:119], v[84:87]
  v_mfma_f32_16x16x32_bf16 v[88:91], v[36:39], a[84:87], v[88:91]
  v_mfma_f32_16x16x32_bf16 v[92:95], v[36:39], a[52:55], v[92:95]
  s_waitcnt lgkmcnt(2)
  v_mfma_f32_16x16x32_bf16 v[68:71], v[40:43], a[248:251], v[68:71]
  ds_read_b64 v[32:33], v54 offset:1024
  ds_read_b64 v[34:35], v54 offset:1032
  v_mfma_f32_16x16x32_bf16 v[72:75], v[40:43], a[216:219], v[72:75]
  v_mfma_f32_16x16x32_bf16 v[76:79], v[40:43], a[184:187], v[76:79]
  v_mfma_f32_16x16x32_bf16 v[80:83], v[40:43], a[152:155], v[80:83]
  v_mfma_f32_16x16x32_bf16 v[84:87], v[40:43], a[120:123], v[84:87]
  v_mfma_f32_16x16x32_bf16 v[88:91], v[40:43], a[88:91], v[88:91]
  v_mfma_f32_16x16x32_bf16 v[92:95], v[40:43], a[56:59], v[92:95]
  s_waitcnt lgkmcnt(2)
  v_mfma_f32_16x16x32_bf16 v[68:71], v[44:47], a[252:255], v[68:71]
  ds_read_b64 v[36:37], v54 offset:1088
  ds_read_b64 v[38:39], v54 offset:1096
  v_mfma_f32_16x16x32_bf16 v[72:75], v[44:47], a[220:223], v[72:75]
  v_mfma_f32_16x16x32_bf16 v[76:79], v[44:47], a[188:191], v[76:79]
  v_mfma_f32_16x16x32_bf16 v[80:83], v[44:47], a[156:159], v[80:83]
  v_mfma_f32_16x16x32_bf16 v[84:87], v[44:47], a[124:127], v[84:87]
  v_mfma_f32_16x16x32_bf16 v[88:91], v[44:47], a[92:95], v[88:91]
  v_and_b32 v104, 0xffff0000, v11
  v_lshlrev_b32 v105, 16, v11
  v_mfma_f32_16x16x32_bf16 v[92:95], v[44:47], a[60:63], v[92:95]
  v_and_b32 v106, 0xffff0000, v10
  v_lshlrev_b32 v107, 16, v10
  s_waitcnt lgkmcnt(2)
  v_mfma_f32_16x16x32_bf16 v[72:75], v[32:35], a[224:227], v[72:75]
  ds_read_b64 v[40:41], v54 offset:1152
  ds_read_b64 v[42:43], v54 offset:1160
  ds_read_b64 v[12:13], v58 offset:2560
  v_mfma_f32_16x16x32_bf16 v[76:79], v[32:35], a[192:195], v[76:79]
  v_fma_f32 v104, v104, v48, v68
  v_fma_f32 v105, v105, v48, v69
  v_mfma_f32_16x16x32_bf16 v[80:83], v[32:35], a[160:163], v[80:83]
  v_fma_f32 v106, v106, v48, v70
  v_fma_f32 v107, v107, v48, v71
  v_mfma_f32_16x16x32_bf16 v[84:87], v[32:35], a[128:131], v[84:87]
  v_cvt_pk_bf16_f32 v110, v104, v105
  v_cvt_pk_bf16_f32 v111, v106, v107
  v_mfma_f32_16x16x32_bf16 v[88:91], v[32:35], a[96:99], v[88:91]
  buffer_store_dwordx2 v[110:111], v57, s[28:31], 0 offen offset:512 sc1
  v_mfma_f32_16x16x32_bf16 v[92:95], v[32:35], a[64:67], v[92:95]
  s_waitcnt lgkmcnt(3)
  v_mfma_f32_16x16x32_bf16 v[72:75], v[36:39], a[228:231], v[72:75]
  ds_read_b64 v[44:45], v54 offset:1216
  ds_read_b64 v[46:47], v54 offset:1224
  v_mfma_f32_16x16x32_bf16 v[76:79], v[36:39], a[196:199], v[76:79]
  v_mfma_f32_16x16x32_bf16 v[80:83], v[36:39], a[164:167], v[80:83]
  v_mfma_f32_16x16x32_bf16 v[84:87], v[36:39], a[132:135], v[84:87]
  v_mfma_f32_16x16x32_bf16 v[88:91], v[36:39], a[100:103], v[88:91]
  v_mfma_f32_16x16x32_bf16 v[92:95], v[36:39], a[68:71], v[92:95]
  s_waitcnt lgkmcnt(3)
  v_mfma_f32_16x16x32_bf16 v[72:75], v[40:43], a[232:235], v[72:75]
  ds_read_b64 v[32:33], v54 offset:1280
  ds_read_b64 v[34:35], v54 offset:1288
  v_mfma_f32_16x16x32_bf16 v[76:79], v[40:43], a[200:203], v[76:79]
  v_mfma_f32_16x16x32_bf16 v[80:83], v[40:43], a[168:171], v[80:83]
  v_mfma_f32_16x16x32_bf16 v[84:87], v[40:43], a[136:139], v[84:87]
  v_mfma_f32_16x16x32_bf16 v[88:91], v[40:43], a[104:107], v[88:91]
  v_mfma_f32_16x16x32_bf16 v[92:95], v[40:43], a[72:75], v[92:95]
  s_waitcnt lgkmcnt(2)
  v_mfma_f32_16x16x32_bf16 v[72:75], v[44:47], a[236:239], v[72:75]
  ds_read_b64 v[36:37], v54 offset:1344
  ds_read_b64 v[38:39], v54 offset:1352
  v_mfma_f32_16x16x32_bf16 v[76:79], v[44:47], a[204:207], v[76:79]
  v_mfma_f32_16x16x32_bf16 v[80:83], v[44:47], a[172:175], v[80:83]
  v_mfma_f32_16x16x32_bf16 v[84:87], v[44:47], a[140:143], v[84:87]
  v_mfma_f32_16x16x32_bf16 v[88:91], v[44:47], a[108:111], v[88:91]
  v_mfma_f32_16x16x32_bf16 v[92:95], v[44:47], a[76:79], v[92:95]
  s_waitcnt lgkmcnt(2)
  v_mfma_f32_16x16x32_bf16 v[72:75], v[32:35], a[240:243], v[72:75]
  ds_read_b64 v[40:41], v54 offset:1408
  ds_read_b64 v[42:43], v54 offset:1416
  v_mfma_f32_16x16x32_bf16 v[76:79], v[32:35], a[208:211], v[76:79]
  v_mfma_f32_16x16x32_bf16 v[80:83], v[32:35], a[176:179], v[80:83]
  v_mfma_f32_16x16x32_bf16 v[84:87], v[32:35], a[144:147], v[84:87]
  v_mfma_f32_16x16x32_bf16 v[88:91], v[32:35], a[112:115], v[88:91]
  v_mfma_f32_16x16x32_bf16 v[92:95], v[32:35], a[80:83], v[92:95]
  s_waitcnt lgkmcnt(2)
  v_mfma_f32_16x16x32_bf16 v[72:75], v[36:39], a[244:247], v[72:75]
  ds_read_b64 v[44:45], v54 offset:1472
  ds_read_b64 v[46:47], v54 offset:1480
  v_mfma_f32_16x16x32_bf16 v[76:79], v[36:39], a[212:215], v[76:79]
  v_mfma_f32_16x16x32_bf16 v[80:83], v[36:39], a[180:183], v[80:83]
  v_mfma_f32_16x16x32_bf16 v[84:87], v[36:39], a[148:151], v[84:87]
  v_mfma_f32_16x16x32_bf16 v[88:91], v[36:39], a[116:119], v[88:91]
  v_mfma_f32_16x16x32_bf16 v[92:95], v[36:39], a[84:87], v[92:95]
  s_waitcnt lgkmcnt(2)
  v_mfma_f32_16x16x32_bf16 v[72:75], v[40:43], a[248:251], v[72:75]
  ds_read_b64 v[32:33], v54 offset:1536
  ds_read_b64 v[34:35], v54 offset:1544
  v_mfma_f32_16x16x32_bf16 v[76:79], v[40:43], a[216:219], v[76:79]
  v_mfma_f32_16x16x32_bf16 v[80:83], v[40:43], a[184:187], v[80:83]
  v_mfma_f32_16x16x32_bf16 v[84:87], v[40:43], a[152:155], v[84:87]
  v_mfma_f32_16x16x32_bf16 v[88:91], v[40:43], a[120:123], v[88:91]
  v_mfma_f32_16x16x32_bf16 v[92:95], v[40:43], a[88:91], v[92:95]
  s_waitcnt lgkmcnt(2)
  v_mfma_f32_16x16x32_bf16 v[72:75], v[44:47], a[252:255], v[72:75]
  ds_read_b64 v[36:37], v54 offset:1600
  ds_read_b64 v[38:39], v54 offset:1608
  v_mfma_f32_16x16x32_bf16 v[76:79], v[44:47], a[220:223], v[76:79]
  v_mfma_f32_16x16x32_bf16 v[80:83], v[44:47], a[188:191], v[80:83]
  v_mfma_f32_16x16x32_bf16 v[84:87], v[44:47], a[156:159], v[84:87]
  v_mfma_f32_16x16x32_bf16 v[88:91], v[44:47], a[124:127], v[88:91]
  v_mfma_f32_16x16x32_bf16 v[92:95], v[44:47], a[92:95], v[92:95]
  v_and_b32 v100, 0xffff0000, v13
  v_lshlrev_b32 v101, 16, v13
  s_waitcnt lgkmcnt(2)
  v_mfma_f32_16x16x32_bf16 v[76:79], v[32:35], a[224:227], v[76:79]
  ds_read_b64 v[40:41], v54 offset:1664
  ds_read_b64 v[42:43], v54 offset:1672
  ds_read_b64 v[14:15], v58 offset:2048
  v_mfma_f32_16x16x32_bf16 v[80:83], v[32:35], a[192:195], v[80:83]
  v_and_b32 v102, 0xffff0000, v12
  v_lshlrev_b32 v103, 16, v12
  v_mfma_f32_16x16x32_bf16 v[84:87], v[32:35], a[160:163], v[84:87]
  v_fma_f32 v100, v100, v48, v72
  v_fma_f32 v101, v101, v48, v73
  v_mfma_f32_16x16x32_bf16 v[88:91], v[32:35], a[128:131], v[88:91]
  v_fma_f32 v102, v102, v48, v74
  v_fma_f32 v103, v103, v48, v75
  v_mfma_f32_16x16x32_bf16 v[92:95], v[32:35], a[96:99], v[92:95]
  v_cvt_pk_bf16_f32 v108, v100, v101
  v_cvt_pk_bf16_f32 v109, v102, v103
  s_waitcnt lgkmcnt(3)
  v_mfma_f32_16x16x32_bf16 v[76:79], v[36:39], a[228:231], v[76:79]
  ds_read_b64 v[44:45], v54 offset:1728
  ds_read_b64 v[46:47], v54 offset:1736
  v_mfma_f32_16x16x32_bf16 v[80:83], v[36:39], a[196:199], v[80:83]
  buffer_store_dwordx2 v[108:109], v57, s[28:31], 0 offen offset:1024 sc1
  v_mfma_f32_16x16x32_bf16 v[84:87], v[36:39], a[164:167], v[84:87]
  v_mfma_f32_16x16x32_bf16 v[88:91], v[36:39], a[132:135], v[88:91]
  v_mfma_f32_16x16x32_bf16 v[92:95], v[36:39], a[100:103], v[92:95]
  s_waitcnt lgkmcnt(3)
  v_mfma_f32_16x16x32_bf16 v[76:79], v[40:43], a[232:235], v[76:79]
  ds_read_b64 v[32:33], v54 offset:1792
  ds_read_b64 v[34:35], v54 offset:1800
  v_mfma_f32_16x16x32_bf16 v[80:83], v[40:43], a[200:203], v[80:83]
  v_mfma_f32_16x16x32_bf16 v[84:87], v[40:43], a[168:171], v[84:87]
  v_mfma_f32_16x16x32_bf16 v[88:91], v[40:43], a[136:139], v[88:91]
  v_mfma_f32_16x16x32_bf16 v[92:95], v[40:43], a[104:107], v[92:95]
  s_waitcnt lgkmcnt(2)
  v_mfma_f32_16x16x32_bf16 v[76:79], v[44:47], a[236:239], v[76:79]
  ds_read_b64 v[36:37], v54 offset:1856
  ds_read_b64 v[38:39], v54 offset:1864
  v_mfma_f32_16x16x32_bf16 v[80:83], v[44:47], a[204:207], v[80:83]
  v_mfma_f32_16x16x32_bf16 v[84:87], v[44:47], a[172:175], v[84:87]
  v_mfma_f32_16x16x32_bf16 v[88:91], v[44:47], a[140:143], v[88:91]
  v_mfma_f32_16x16x32_bf16 v[92:95], v[44:47], a[108:111], v[92:95]
  s_waitcnt lgkmcnt(2)
  v_mfma_f32_16x16x32_bf16 v[76:79], v[32:35], a[240:243], v[76:79]
  ds_read_b64 v[40:41], v54 offset:1920
  ds_read_b64 v[42:43], v54 offset:1928
  v_mfma_f32_16x16x32_bf16 v[80:83], v[32:35], a[208:211], v[80:83]
  v_mfma_f32_16x16x32_bf16 v[84:87], v[32:35], a[176:179], v[84:87]
  v_mfma_f32_16x16x32_bf16 v[88:91], v[32:35], a[144:147], v[88:91]
  v_mfma_f32_16x16x32_bf16 v[92:95], v[32:35], a[112:115], v[92:95]
  s_waitcnt lgkmcnt(2)
  v_mfma_f32_16x16x32_bf16 v[76:79], v[36:39], a[244:247], v[76:79]
  ds_read_b64 v[44:45], v54 offset:1984
  ds_read_b64 v[46:47], v54 offset:1992
  v_mfma_f32_16x16x32_bf16 v[80:83], v[36:39], a[212:215], v[80:83]
  v_mfma_f32_16x16x32_bf16 v[84:87], v[36:39], a[180:183], v[84:87]
  v_mfma_f32_16x16x32_bf16 v[88:91], v[36:39], a[148:151], v[88:91]
  v_mfma_f32_16x16x32_bf16 v[92:95], v[36:39], a[116:119], v[92:95]
  s_waitcnt lgkmcnt(2)
  v_mfma_f32_16x16x32_bf16 v[76:79], v[40:43], a[248:251], v[76:79]
  ds_read_b64 v[32:33], v54 offset:2048
  ds_read_b64 v[34:35], v54 offset:2056
  v_mfma_f32_16x16x32_bf16 v[80:83], v[40:43], a[216:219], v[80:83]
  v_mfma_f32_16x16x32_bf16 v[84:87], v[40:43], a[184:187], v[84:87]
  v_mfma_f32_16x16x32_bf16 v[88:91], v[40:43], a[152:155], v[88:91]
  v_mfma_f32_16x16x32_bf16 v[92:95], v[40:43], a[120:123], v[92:95]
  s_waitcnt lgkmcnt(2)
  v_mfma_f32_16x16x32_bf16 v[76:79], v[44:47], a[252:255], v[76:79]
  ds_read_b64 v[36:37], v54 offset:2112
  ds_read_b64 v[38:39], v54 offset:2120
  v_mfma_f32_16x16x32_bf16 v[80:83], v[44:47], a[220:223], v[80:83]
  v_mfma_f32_16x16x32_bf16 v[84:87], v[44:47], a[188:191], v[84:87]
  v_mfma_f32_16x16x32_bf16 v[88:91], v[44:47], a[156:159], v[88:91]
  v_mfma_f32_16x16x32_bf16 v[92:95], v[44:47], a[124:127], v[92:95]
  s_waitcnt lgkmcnt(2)
  v_mfma_f32_16x16x32_bf16 v[80:83], v[32:35], a[224:227], v[80:83]
  ds_read_b64 v[40:41], v54 offset:2176
  ds_read_b64 v[42:43], v54 offset:2184
  ds_read_b64 v[16:17], v58 offset:1536
  v_mfma_f32_16x16x32_bf16 v[84:87], v[32:35], a[192:195], v[84:87]
  v_and_b32 v104, 0xffff0000, v15
  v_lshlrev_b32 v105, 16, v15
  v_mfma_f32_16x16x32_bf16 v[88:91], v[32:35], a[160:163], v[88:91]
  v_and_b32 v106, 0xffff0000, v14
  v_lshlrev_b32 v107, 16, v14
  v_mfma_f32_16x16x32_bf16 v[92:95], v[32:35], a[128:131], v[92:95]
  v_fma_f32 v104, v104, v48, v76
  v_fma_f32 v105, v105, v48, v77
  s_waitcnt lgkmcnt(3)
  v_mfma_f32_16x16x32_bf16 v[80:83], v[36:39], a[228:231], v[80:83]
  ds_read_b64 v[44:45], v54 offset:2240
  ds_read_b64 v[46:47], v54 offset:2248
  v_mfma_f32_16x16x32_bf16 v[84:87], v[36:39], a[196:199], v[84:87]
  v_fma_f32 v106, v106, v48, v78
  v_fma_f32 v107, v107, v48, v79
  v_mfma_f32_16x16x32_bf16 v[88:91], v[36:39], a[164:167], v[88:91]
  v_cvt_pk_bf16_f32 v110, v104, v105
  v_cvt_pk_bf16_f32 v111, v106, v107
  v_mfma_f32_16x16x32_bf16 v[92:95], v[36:39], a[132:135], v[92:95]
  buffer_store_dwordx2 v[110:111], v57, s[28:31], 0 offen offset:1536 sc1
  s_waitcnt lgkmcnt(3)
  v_mfma_f32_16x16x32_bf16 v[80:83], v[40:43], a[232:235], v[80:83]
  ds_read_b64 v[32:33], v54 offset:2304
  ds_read_b64 v[34:35], v54 offset:2312
  v_mfma_f32_16x16x32_bf16 v[84:87], v[40:43], a[200:203], v[84:87]
  v_mfma_f32_16x16x32_bf16 v[88:91], v[40:43], a[168:171], v[88:91]
  v_mfma_f32_16x16x32_bf16 v[92:95], v[40:43], a[136:139], v[92:95]
  s_waitcnt lgkmcnt(2)
  v_mfma_f32_16x16x32_bf16 v[80:83], v[44:47], a[236:239], v[80:83]
  ds_read_b64 v[36:37], v54 offset:2368
  ds_read_b64 v[38:39], v54 offset:2376
  v_mfma_f32_16x16x32_bf16 v[84:87], v[44:47], a[204:207], v[84:87]
  v_mfma_f32_16x16x32_bf16 v[88:91], v[44:47], a[172:175], v[88:91]
  v_mfma_f32_16x16x32_bf16 v[92:95], v[44:47], a[140:143], v[92:95]
  s_waitcnt lgkmcnt(2)
  v_mfma_f32_16x16x32_bf16 v[80:83], v[32:35], a[240:243], v[80:83]
  ds_read_b64 v[40:41], v54 offset:2432
  ds_read_b64 v[42:43], v54 offset:2440
  v_mfma_f32_16x16x32_bf16 v[84:87], v[32:35], a[208:211], v[84:87]
  v_mfma_f32_16x16x32_bf16 v[88:91], v[32:35], a[176:179], v[88:91]
  v_mfma_f32_16x16x32_bf16 v[92:95], v[32:35], a[144:147], v[92:95]
  s_waitcnt lgkmcnt(2)
  v_mfma_f32_16x16x32_bf16 v[80:83], v[36:39], a[244:247], v[80:83]
  ds_read_b64 v[44:45], v54 offset:2496
  ds_read_b64 v[46:47], v54 offset:2504
  v_mfma_f32_16x16x32_bf16 v[84:87], v[36:39], a[212:215], v[84:87]
  v_mfma_f32_16x16x32_bf16 v[88:91], v[36:39], a[180:183], v[88:91]
  v_mfma_f32_16x16x32_bf16 v[92:95], v[36:39], a[148:151], v[92:95]
  s_waitcnt lgkmcnt(2)
  v_mfma_f32_16x16x32_bf16 v[80:83], v[40:43], a[248:251], v[80:83]
  ds_read_b64 v[32:33], v54 offset:2560
  ds_read_b64 v[34:35], v54 offset:2568
  v_mfma_f32_16x16x32_bf16 v[84:87], v[40:43], a[216:219], v[84:87]
  v_mfma_f32_16x16x32_bf16 v[88:91], v[40:43], a[184:187], v[88:91]
  v_mfma_f32_16x16x32_bf16 v[92:95], v[40:43], a[152:155], v[92:95]
  s_waitcnt lgkmcnt(2)
  v_mfma_f32_16x16x32_bf16 v[80:83], v[44:47], a[252:255], v[80:83]
  ds_read_b64 v[36:37], v54 offset:2624
  ds_read_b64 v[38:39], v54 offset:2632
  v_mfma_f32_16x16x32_bf16 v[84:87], v[44:47], a[220:223], v[84:87]
  v_mfma_f32_16x16x32_bf16 v[88:91], v[44:47], a[188:191], v[88:91]
  v_mfma_f32_16x16x32_bf16 v[92:95], v[44:47], a[156:159], v[92:95]
  s_waitcnt lgkmcnt(2)
  v_mfma_f32_16x16x32_bf16 v[84:87], v[32:35], a[224:227], v[84:87]
  ds_read_b64 v[40:41], v54 offset:2688
  ds_read_b64 v[42:43], v54 offset:2696
  ds_read_b64 v[18:19], v58 offset:1024
  v_mfma_f32_16x16x32_bf16 v[88:91], v[32:35], a[192:195], v[88:91]
  v_and_b32 v100, 0xffff0000, v17
  v_lshlrev_b32 v101, 16, v17
  v_mfma_f32_16x16x32_bf16 v[92:95], v[32:35], a[160:163], v[92:95]
  v_and_b32 v102, 0xffff0000, v16
  v_lshlrev_b32 v103, 16, v16
  s_waitcnt lgkmcnt(3)
  v_mfma_f32_16x16x32_bf16 v[84:87], v[36:39], a[228:231], v[84:87]
  ds_read_b64 v[44:45], v54 offset:2752
  ds_read_b64 v[46:47], v54 offset:2760
  v_mfma_f32_16x16x32_bf16 v[88:91], v[36:39], a[196:199], v[88:91]
  v_fma_f32 v100, v100, v48, v80
  v_fma_f32 v101, v101, v48, v81
  v_mfma_f32_16x16x32_bf16 v[92:95], v[36:39], a[164:167], v[92:95]
  v_fma_f32 v102, v102, v48, v82
  v_fma_f32 v103, v103, v48, v83
  s_waitcnt lgkmcnt(3)
  v_mfma_f32_16x16x32_bf16 v[84:87], v[40:43], a[232:235], v[84:87]
  ds_read_b64 v[32:33], v54 offset:2816
  ds_read_b64 v[34:35], v54 offset:2824
  v_mfma_f32_16x16x32_bf16 v[88:91], v[40:43], a[200:203], v[88:91]
  v_cvt_pk_bf16_f32 v108, v100, v101
  v_cvt_pk_bf16_f32 v109, v102, v103
  v_mfma_f32_16x16x32_bf16 v[92:95], v[40:43], a[168:171], v[92:95]
  buffer_store_dwordx2 v[108:109], v57, s[28:31], 0 offen offset:2048 sc1
  s_waitcnt lgkmcnt(2)
  v_mfma_f32_16x16x32_bf16 v[84:87], v[44:47], a[236:239], v[84:87]
  ds_read_b64 v[36:37], v54 offset:2880
  ds_read_b64 v[38:39], v54 offset:2888
  v_mfma_f32_16x16x32_bf16 v[88:91], v[44:47], a[204:207], v[88:91]
  v_mfma_f32_16x16x32_bf16 v[92:95], v[44:47], a[172:175], v[92:95]
  s_waitcnt lgkmcnt(2)
  v_mfma_f32_16x16x32_bf16 v[84:87], v[32:35], a[240:243], v[84:87]
  ds_read_b64 v[40:41], v54 offset:2944
  ds_read_b64 v[42:43], v54 offset:2952
  v_mfma_f32_16x16x32_bf16 v[88:91], v[32:35], a[208:211], v[88:91]
  v_mfma_f32_16x16x32_bf16 v[92:95], v[32:35], a[176:179], v[92:95]
  s_waitcnt lgkmcnt(2)
  v_mfma_f32_16x16x32_bf16 v[84:87], v[36:39], a[244:247], v[84:87]
  ds_read_b64 v[44:45], v54 offset:3008
  ds_read_b64 v[46:47], v54 offset:3016
  v_mfma_f32_16x16x32_bf16 v[88:91], v[36:39], a[212:215], v[88:91]
  v_mfma_f32_16x16x32_bf16 v[92:95], v[36:39], a[180:183], v[92:95]
  s_waitcnt lgkmcnt(2)
  v_mfma_f32_16x16x32_bf16 v[84:87], v[40:43], a[248:251], v[84:87]
  ds_read_b64 v[32:33], v54 offset:3072
  ds_read_b64 v[34:35], v54 offset:3080
  v_mfma_f32_16x16x32_bf16 v[88:91], v[40:43], a[216:219], v[88:91]
  v_mfma_f32_16x16x32_bf16 v[92:95], v[40:43], a[184:187], v[92:95]
  s_waitcnt lgkmcnt(2)
  v_mfma_f32_16x16x32_bf16 v[84:87], v[44:47], a[252:255], v[84:87]
  ds_read_b64 v[36:37], v54 offset:3136
  ds_read_b64 v[38:39], v54 offset:3144
  v_mfma_f32_16x16x32_bf16 v[88:91], v[44:47], a[220:223], v[88:91]
  v_mfma_f32_16x16x32_bf16 v[92:95], v[44:47], a[188:191], v[92:95]
  s_waitcnt lgkmcnt(2)
  v_mfma_f32_16x16x32_bf16 v[88:91], v[32:35], a[224:227], v[88:91]
  ds_read_b64 v[40:41], v54 offset:3200
  ds_read_b64 v[42:43], v54 offset:3208
  ds_read_b64 v[20:21], v58 offset:512
  v_mfma_f32_16x16x32_bf16 v[92:95], v[32:35], a[192:195], v[92:95]
  s_waitcnt lgkmcnt(3)
  v_mfma_f32_16x16x32_bf16 v[88:91], v[36:39], a[228:231], v[88:91]
  ds_read_b64 v[44:45], v54 offset:3264
  ds_read_b64 v[46:47], v54 offset:3272
  v_mfma_f32_16x16x32_bf16 v[92:95], v[36:39], a[196:199], v[92:95]
  v_and_b32 v104, 0xffff0000, v19
  v_lshlrev_b32 v105, 16, v19
  s_waitcnt lgkmcnt(3)
  v_mfma_f32_16x16x32_bf16 v[88:91], v[40:43], a[232:235], v[88:91]
  ds_read_b64 v[32:33], v54 offset:3328
  ds_read_b64 v[34:35], v54 offset:3336
  v_mfma_f32_16x16x32_bf16 v[92:95], v[40:43], a[200:203], v[92:95]
  v_and_b32 v106, 0xffff0000, v18
  v_lshlrev_b32 v107, 16, v18
  s_waitcnt lgkmcnt(2)
  v_mfma_f32_16x16x32_bf16 v[88:91], v[44:47], a[236:239], v[88:91]
  ds_read_b64 v[36:37], v54 offset:3392
  ds_read_b64 v[38:39], v54 offset:3400
  v_mfma_f32_16x16x32_bf16 v[92:95], v[44:47], a[204:207], v[92:95]
  v_fma_f32 v104, v104, v48, v84
  v_fma_f32 v105, v105, v48, v85
  s_waitcnt lgkmcnt(2)
  v_mfma_f32_16x16x32_bf16 v[88:91], v[32:35], a[240:243], v[88:91]
  ds_read_b64 v[40:41], v54 offset:3456
  ds_read_b64 v[42:43], v54 offset:3464
  v_mfma_f32_16x16x32_bf16 v[92:95], v[32:35], a[208:211], v[92:95]
  v_fma_f32 v106, v106, v48, v86
  v_fma_f32 v107, v107, v48, v87
  s_waitcnt lgkmcnt(2)
  v_mfma_f32_16x16x32_bf16 v[88:91], v[36:39], a[244:247], v[88:91]
  ds_read_b64 v[44:45], v54 offset:3520
  ds_read_b64 v[46:47], v54 offset:3528
  v_mfma_f32_16x16x32_bf16 v[92:95], v[36:39], a[212:215], v[92:95]
  v_cvt_pk_bf16_f32 v110, v104, v105
  v_cvt_pk_bf16_f32 v111, v106, v107
  s_waitcnt lgkmcnt(2)
  v_mfma_f32_16x16x32_bf16 v[88:91], v[40:43], a[248:251], v[88:91]
  ds_read_b64 v[32:33], v54 offset:3584
  ds_read_b64 v[34:35], v54 offset:3592
  v_mfma_f32_16x16x32_bf16 v[92:95], v[40:43], a[216:219], v[92:95]
  buffer_store_dwordx2 v[110:111], v57, s[28:31], 0 offen offset:2560 sc1
  s_waitcnt lgkmcnt(2)
  v_mfma_f32_16x16x32_bf16 v[88:91], v[44:47], a[252:255], v[88:91]
  ds_read_b64 v[36:37], v54 offset:3648
  ds_read_b64 v[38:39], v54 offset:3656
  v_mfma_f32_16x16x32_bf16 v[92:95], v[44:47], a[220:223], v[92:95]
  s_waitcnt lgkmcnt(2)
  v_mfma_f32_16x16x32_bf16 v[92:95], v[32:35], a[224:227], v[92:95]
  ds_read_b64 v[40:41], v54 offset:3712
  ds_read_b64 v[42:43], v54 offset:3720
  ds_read_b64 v[22:23], v58 offset:0
  s_waitcnt lgkmcnt(3)
  v_mfma_f32_16x16x32_bf16 v[92:95], v[36:39], a[228:231], v[92:95]
  ds_read_b64 v[44:45], v54 offset:3776
  ds_read_b64 v[46:47], v54 offset:3784
  s_waitcnt lgkmcnt(3)
  v_mfma_f32_16x16x32_bf16 v[92:95], v[40:43], a[232:235], v[92:95]
  ds_read_b64 v[32:33], v54 offset:3840
  ds_read_b64 v[34:35], v54 offset:3848
  s_waitcnt lgkmcnt(2)
  v_mfma_f32_16x16x32_bf16 v[92:95], v[44:47], a[236:239], v[92:95]
  ds_read_b64 v[36:37], v54 offset:3904
  ds_read_b64 v[38:39], v54 offset:3912
  s_waitcnt lgkmcnt(2)
  v_mfma_f32_16x16x32_bf16 v[92:95], v[32:35], a[240:243], v[92:95]
  ds_read_b64 v[40:41], v54 offset:3968
  ds_read_b64 v[42:43], v54 offset:3976
  s_waitcnt lgkmcnt(2)
  v_mfma_f32_16x16x32_bf16 v[92:95], v[36:39], a[244:247], v[92:95]
  ds_read_b64 v[44:45], v54 offset:4032
  ds_read_b64 v[46:47], v54 offset:4040
  s_waitcnt lgkmcnt(2)
  v_mfma_f32_16x16x32_bf16 v[92:95], v[40:43], a[248:251], v[92:95]
  v_and_b32 v100, 0xffff0000, v21
  v_lshlrev_b32 v101, 16, v21
  s_waitcnt lgkmcnt(0)
  v_mfma_f32_16x16x32_bf16 v[92:95], v[44:47], a[252:255], v[92:95]
  v_and_b32 v102, 0xffff0000, v20
  v_lshlrev_b32 v103, 16, v20
  s_nop 7
  v_fma_f32 v100, v100, v48, v88
  v_fma_f32 v101, v101, v48, v89
  v_fma_f32 v102, v102, v48, v90
  v_fma_f32 v103, v103, v48, v91
  v_cvt_pk_bf16_f32 v108, v100, v101
  v_cvt_pk_bf16_f32 v109, v102, v103
  buffer_store_dwordx2 v[108:109], v57, s[28:31], 0 offen offset:3072 sc1
  v_and_b32 v104, 0xffff0000, v23
  v_lshlrev_b32 v105, 16, v23
  v_and_b32 v106, 0xffff0000, v22
  v_lshlrev_b32 v107, 16, v22
  v_fma_f32 v104, v104, v48, v92
  v_fma_f32 v105, v105, v48, v93
  v_fma_f32 v106, v106, v48, v94
  v_fma_f32 v107, v107, v48, v95
  v_cvt_pk_bf16_f32 v110, v104, v105
  v_cvt_pk_bf16_f32 v111, v106, v107
  buffer_store_dwordx2 v[110:111], v57, s[28:31], 0 offen offset:3584 sc1
  s_lshl_b32 s68, s2, 7
  s_add_u32 s68, s68, 32768
  s_waitcnt vmcnt(0)
  s_barrier
  s_cmp_lg_u32 s101, 0
  s_cbranch_scc1 FMZ_nopub
  v_mov_b32 v100, s68
  v_mov_b32 v101, s100
  v_cmp_eq_u32 vcc, 0, v1
  s_and_saveexec_b64 s[90:91], vcc
  buffer_store_dword v101, v100, s[32:35], 0 offen sc1
  s_mov_b64 exec, s[90:91]
FMZ_nopub:
  s_add_u32 s72, s62, 30408704
  s_addc_u32 s73, s63, 0
  s_mov_b32 s74, 15925248
  s_mov_b32 s75, 0x20000
  v_lshrrev_b32 v165, 4, v1
  v_bfe_u32 v166, v1, 2, 2
  v_and_b32 v167, 3, v1
  v_lshrrev_b32 v168, 1, v166
  v_lshl_add_u32 v168, v165, 1, v168
  v_and_b32 v168, 3, v168
  v_xor_b32 v168, s44, v168
  v_lshl_add_u32 v169, v165, 2, v166
  v_lshlrev_b32 v169, 7, v169
  v_lshl_add_u32 v169, v168, 5, v169
  v_lshl_add_u32 v169, v167, 3, v169
  v_add_u32 v169, 102400, v169

  s_mul_i32 s80, s76, 1990656
  s_mul_i32 s81, s44, 497664
  s_add_u32 s80, s80, s81
  s_lshl_b32 s81, s77, 10
  s_add_u32 s80, s80, s81
  s_add_u32 s80, s80, 331776
  ds_read_b64_tr_b16 v[172:173], v169 offset:0
  ds_read_b64_tr_b16 v[174:175], v169 offset:2048
  ds_read_b64_tr_b16 v[176:177], v169 offset:4096
  ds_read_b64_tr_b16 v[178:179], v169 offset:6144
  ds_read_b64_tr_b16 v[180:181], v169 offset:8192
  ds_read_b64_tr_b16 v[182:183], v169 offset:10240
  ds_read_b64_tr_b16 v[184:185], v169 offset:12288
  ds_read_b64_tr_b16 v[186:187], v169 offset:14336
  ds_read_b64_tr_b16 v[188:189], v169 offset:16384
  ds_read_b64_tr_b16 v[190:191], v169 offset:18432
  s_waitcnt lgkmcnt(8)
  s_add_u32 s81, s80, 0
  buffer_store_dwordx4 v[172:175], v155, s[72:75], s81 offen sc1
  s_waitcnt lgkmcnt(6)
  s_add_u32 s81, s80, 18432
  buffer_store_dwordx4 v[176:179], v155, s[72:75], s81 offen sc1
  s_waitcnt lgkmcnt(4)
  s_add_u32 s81, s80, 36864
  buffer_store_dwordx4 v[180:183], v155, s[72:75], s81 offen sc1
  s_waitcnt lgkmcnt(2)
  s_add_u32 s81, s80, 55296
  buffer_store_dwordx4 v[184:187], v155, s[72:75], s81 offen sc1
  s_waitcnt lgkmcnt(0)
  s_add_u32 s81, s80, 73728
  buffer_store_dwordx4 v[188:191], v155, s[72:75], s81 offen sc1
  ds_read_b64_tr_b16 v[172:173], v169 offset:20480
  ds_read_b64_tr_b16 v[174:175], v169 offset:22528
  ds_read_b64_tr_b16 v[176:177], v169 offset:24576
  ds_read_b64_tr_b16 v[178:179], v169 offset:26624
  ds_read_b64_tr_b16 v[180:181], v169 offset:28672
  ds_read_b64_tr_b16 v[182:183], v169 offset:30720
  ds_read_b64_tr_b16 v[184:185], v169 offset:32768
  ds_read_b64_tr_b16 v[186:187], v169 offset:34816
  s_waitcnt lgkmcnt(6)
  s_add_u32 s81, s80, 92160
  buffer_store_dwordx4 v[172:175], v155, s[72:75], s81 offen sc1
  s_waitcnt lgkmcnt(4)
  s_add_u32 s81, s80, 110592
  buffer_store_dwordx4 v[176:179], v155, s[72:75], s81 offen sc1
  s_waitcnt lgkmcnt(2)
  s_add_u32 s81, s80, 129024
  buffer_store_dwordx4 v[180:183], v155, s[72:75], s81 offen sc1
  s_waitcnt lgkmcnt(0)
  s_add_u32 s81, s80, 147456
  buffer_store_dwordx4 v[184:187], v155, s[72:75], s81 offen sc1
  s_branch MG_rows
MG_rows:
  s_load_dwordx2 s[4:5], s[0:1], 0
  s_load_dwordx2 s[26:27], s[0:1], 112
  s_lshr_b32 s28, s2, 6
  s_lshl_b32 s28, s28, 3
  s_and_b32 s29, s2, 7
  s_add_u32 s28, s28, s29
  s_bfe_u32 s29, s2, 0x30003
  s_lshl_b32 s30, s28, 6
  s_lshl_b32 s31, s29, 3
  s_add_u32 s30, s30, s31
  v_lshrrev_b32 v2, 6, v0
  v_and_b32 v1, 63, v0
  v_lshrrev_b32 v3, 3, v1
  v_and_b32 v4, 7, v1
  v_lshlrev_b32 v5, 3, v3
  v_lshl_add_u32 v5, v2, 6, v5
  v_add_u32 v6, s30, v4
  s_movk_i32 s32, 1152
  v_mul_lo_u32 v7, v6, s32
  v_lshl_add_u32 v7, v5, 1, v7
  v_lshlrev_b32 v8, 12, v0
  s_lshl_b32 s33, s30, 1
  v_add_u32 v8, s33, v8
  v_lshlrev_b32 v9, 1, v5
  v_lshlrev_b32 v10, 4, v0
  v_lshrrev_b32 v12, 4, v1
  v_bfe_u32 v13, v1, 1, 1
  v_lshl_add_u32 v12, v12, 1, v13
  v_lshlrev_b32 v12, 3, v12
  v_bfe_u32 v13, v1, 2, 2
  v_add_u32 v12, v12, v13
  v_lshl_add_u32 v12, v2, 6, v12
  v_lshlrev_b32 v12, 4, v12
  v_and_b32 v13, 1, v1
  v_lshl_add_u32 v11, v13, 3, v12
  v_lshlrev_b32 v12, 3, v4
  v_lshl_add_u32 v13, v2, 6, v12
  s_lshr_b32 s35, s29, 1
  s_mul_i32 s41, s28, 72*1024
  s_lshl_b32 s40, s35, 10
  s_add_u32 s41, s41, s40
  s_and_b32 s42, s29, 1
  s_lshl_b32 s42, s42, 3
  v_add_u32 v136, s42, v4
  v_lshrrev_b32 v14, 2, v3
  v_lshl_add_u32 v14, v2, 1, v14
  v_lshlrev_b32 v14, 12, v14
  v_and_b32 v15, 3, v3
  v_lshl_add_u32 v15, v15, 4, v136
  v_lshl_add_u32 v14, v15, 4, v14
  v_add_u32 v14, s41, v14
  s_mul_i32 s43, s28, 36*2048
  s_lshr_b32 s44, s35, 1
  s_lshl_b32 s44, s44, 10
  s_add_u32 s43, s43, s44
  s_and_b32 s44, s35, 1
  s_lshl_b32 s44, s44, 3
  s_add_u32 s43, s43, s44
  v_lshrrev_b32 v15, 1, v3
  v_lshl_add_u32 v15, v2, 2, v15
  v_lshlrev_b32 v15, 11, v15
  v_and_b32 v137, 1, v3
  v_lshl_add_u32 v15, v137, 9, v15
  v_lshl_add_u32 v15, v136, 4, v15
  v_add_u32 v15, s43, v15
  s_waitcnt lgkmcnt(0)
  s_mov_b32 s8, s4
  s_mov_b32 s9, s5
  s_mov_b32 s10, 2359296
  s_mov_b32 s11, 0x20000
  s_add_u32 s12, s26, 2359296
  s_addc_u32 s13, s27, 0
  s_mov_b32 s14, 2359296
  s_mov_b32 s15, 0x20000
  s_add_u32 s16, s26, 4718592
  s_addc_u32 s17, s27, 0
  s_mov_b32 s18, 6912
  s_mov_b32 s19, 0x20000
  s_add_u32 s20, s26, 4784128
  s_addc_u32 s21, s27, 0
  s_mov_b32 s22, 2359296
  s_mov_b32 s23, 0x20000
  s_add_u32 s36, s26, 7143424
  s_addc_u32 s37, s27, 0
  s_mov_b32 s38, 2359296
  s_mov_b32 s39, 0x20000
  s_add_u32 s40, s26, 47185920
  s_addc_u32 s41, s27, 0
  s_mov_b32 s42, 491520
  s_mov_b32 s43, 0x20000
  buffer_load_dwordx4 v[16:19], v7, s[8:11], 0 offen offset:0
  buffer_load_dwordx4 v[20:23], v7, s[8:11], 0 offen offset:512
  s_cmp_lg_u32 s101, 0
  s_cbranch_scc1 RW_x
  buffer_load_dwordx4 v[24:27], v7, s[8:11], 0 offen offset:1024
RW_x:
  v_min_u32 v140, 197, v0
  v_lshlrev_b32 v140, 7, v140
  v_add_u32 v140, 32768, v140
  s_mov_b32 s95, 200000
RW_poll:
  buffer_load_dword v141, v140, s[40:43], 0 offen sc1
  s_waitcnt vmcnt(0)
  v_cmp_ne_u32 vcc, s100, v141
  s_cbranch_vccz RW_go
  s_sub_u32 s95, s95, 1
  s_cmp_eq_u32 s95, 0
  s_cbranch_scc1 RW_go
  s_sleep 1
  s_branch RW_poll
RW_go:
  s_barrier
  s_cmp_lg_u32 s101, 1
  s_cbranch_scc1 RW_noq
  s_lshl_b32 s45, s2, 7
  s_add_u32 s45, s45, 163840
  v_mov_b32 v140, s45
  v_mov_b32 v141, s100
  v_cmp_eq_u32 vcc, 0, v1
  s_and_saveexec_b64 s[90:91], vcc
  buffer_store_dword v141, v140, s[40:43], 0 offen sc1
  s_mov_b64 exec, s[90:91]
RW_noq:
  s_mov_b32 s34, 0
  buffer_load_dwordx4 v[124:127], v8, s[12:15], s34 offen sc1
  s_mov_b32 s34, 1048576
  buffer_load_dwordx4 v[128:131], v8, s[12:15], s34 offen sc1
  s_cmp_lg_u32 s101, 0
  s_cbranch_scc1 RW_z
  s_mov_b32 s34, 2097152
  buffer_load_dwordx4 v[132:135], v8, s[12:15], s34 offen sc1
RW_z:
  buffer_load_dwordx4 v[64:67], v9, s[16:19], 0 offen offset:0 sc1
  buffer_load_dwordx4 v[68:71], v9, s[16:19], 0 offen offset:1152 sc1
  buffer_load_dwordx4 v[72:75], v9, s[16:19], 0 offen offset:2304 sc1
  buffer_load_dwordx4 v[76:79], v9, s[16:19], 0 offen offset:3456 sc1
  s_movk_i32 s34, 4608
  buffer_load_dwordx4 v[80:83], v9, s[16:19], s34 offen sc1
  buffer_load_dwordx4 v[84:87], v9, s[16:19], 0 offen offset:512 sc1
  buffer_load_dwordx4 v[88:91], v9, s[16:19], 0 offen offset:1664 sc1
  buffer_load_dwordx4 v[92:95], v9, s[16:19], 0 offen offset:2816 sc1
  buffer_load_dwordx4 v[96:99], v9, s[16:19], 0 offen offset:3968 sc1
  s_movk_i32 s34, 5120
  buffer_load_dwordx4 v[100:103], v9, s[16:19], s34 offen sc1
  s_cmp_lg_u32 s101, 0
  s_cbranch_scc1 RW_m
  buffer_load_dwordx4 v[104:107], v9, s[16:19], 0 offen offset:1024 sc1
  buffer_load_dwordx4 v[108:111], v9, s[16:19], 0 offen offset:2176 sc1
  buffer_load_dwordx4 v[112:115], v9, s[16:19], 0 offen offset:3328 sc1
  s_movk_i32 s34, 4480
  buffer_load_dwordx4 v[116:119], v9, s[16:19], s34 offen sc1
  s_movk_i32 s34, 5632
  buffer_load_dwordx4 v[120:123], v9, s[16:19], s34 offen sc1
RW_m:
  v_mov_b32 v164, 0
  v_mov_b32 v165, 0
  v_mov_b32 v166, 0
  v_mov_b32 v167, 0
  v_lshlrev_b32 v40, 16, v16
  v_and_b32 v41, 0xffff0000, v16
  v_lshlrev_b32 v42, 16, v17
  v_and_b32 v43, 0xffff0000, v17
  v_lshlrev_b32 v44, 16, v18
  v_and_b32 v45, 0xffff0000, v18
  v_lshlrev_b32 v46, 16, v19
  v_and_b32 v47, 0xffff0000, v19
  v_pk_add_f32 v[164:165], v[164:165], v[40:41]
  v_pk_fma_f32 v[166:167], v[40:41], v[40:41], v[166:167]
  v_pk_add_f32 v[164:165], v[164:165], v[42:43]
  v_pk_fma_f32 v[166:167], v[42:43], v[42:43], v[166:167]
  v_pk_add_f32 v[164:165], v[164:165], v[44:45]
  v_pk_fma_f32 v[166:167], v[44:45], v[44:45], v[166:167]
  v_pk_add_f32 v[164:165], v[164:165], v[46:47]
  v_pk_fma_f32 v[166:167], v[46:47], v[46:47], v[166:167]
  v_lshlrev_b32 v48, 16, v20
  v_and_b32 v49, 0xffff0000, v20
  v_lshlrev_b32 v50, 16, v21
  v_and_b32 v51, 0xffff0000, v21
  v_lshlrev_b32 v52, 16, v22
  v_and_b32 v53, 0xffff0000, v22
  v_lshlrev_b32 v54, 16, v23
  v_and_b32 v55, 0xffff0000, v23
  v_pk_add_f32 v[164:165], v[164:165], v[48:49]
  v_pk_fma_f32 v[166:167], v[48:49], v[48:49], v[166:167]
  v_pk_add_f32 v[164:165], v[164:165], v[50:51]
  v_pk_fma_f32 v[166:167], v[50:51], v[50:51], v[166:167]
  v_pk_add_f32 v[164:165], v[164:165], v[52:53]
  v_pk_fma_f32 v[166:167], v[52:53], v[52:53], v[166:167]
  v_pk_add_f32 v[164:165], v[164:165], v[54:55]
  v_pk_fma_f32 v[166:167], v[54:55], v[54:55], v[166:167]
  s_cmp_lg_u32 s101, 0
  s_cbranch_scc1 RW_s1
  v_lshlrev_b32 v56, 16, v24
  v_and_b32 v57, 0xffff0000, v24
  v_lshlrev_b32 v58, 16, v25
  v_and_b32 v59, 0xffff0000, v25
  v_lshlrev_b32 v60, 16, v26
  v_and_b32 v61, 0xffff0000, v26
  v_lshlrev_b32 v62, 16, v27
  v_and_b32 v63, 0xffff0000, v27
  v_pk_add_f32 v[164:165], v[164:165], v[56:57]
  v_pk_fma_f32 v[166:167], v[56:57], v[56:57], v[166:167]
  v_pk_add_f32 v[164:165], v[164:165], v[58:59]
  v_pk_fma_f32 v[166:167], v[58:59], v[58:59], v[166:167]
  v_pk_add_f32 v[164:165], v[164:165], v[60:61]
  v_pk_fma_f32 v[166:167], v[60:61], v[60:61], v[166:167]
  v_pk_add_f32 v[164:165], v[164:165], v[62:63]
  v_pk_fma_f32 v[166:167], v[62:63], v[62:63], v[166:167]
RW_s1:
  v_add_f32 v140, v164, v165
  v_add_f32 v141, v166, v167
  s_nop 1
  v_mov_b32_dpp v142, v140 row_ror:8 row_mask:0xf bank_mask:0xf
  v_mov_b32_dpp v143, v141 row_ror:8 row_mask:0xf bank_mask:0xf
  v_add_f32 v140, v140, v142
  v_add_f32 v141, v141, v143
  v_mov_b32 v142, v140
  v_mov_b32 v143, v141
  s_nop 1
  v_permlane16_swap_b32 v140, v142
  v_permlane16_swap_b32 v141, v143
  v_add_f32 v140, v140, v142
  v_add_f32 v141, v141, v143
  v_mov_b32 v142, v140
  v_mov_b32 v143, v141
  s_nop 1
  v_permlane32_swap_b32 v140, v142
  v_permlane32_swap_b32 v141, v143
  v_add_f32 v140, v140, v142
  v_add_f32 v141, v141, v143
  v_cmp_gt_u32 vcc, 8, v1
  s_and_saveexec_b64 s[46:47], vcc
  ds_write_b64 v13, v[140:141] offset:9216
  s_mov_b64 exec, s[46:47]
  s_cmp_lg_u32 s101, 0
  s_cbranch_scc1 RW_zw1
  s_waitcnt vmcnt(15)
  s_branch RW_zw2
RW_zw1:
  s_waitcnt vmcnt(10)
RW_zw2:
  ds_write_b128 v10, v[124:127] offset:0
  ds_write_b128 v10, v[128:131] offset:4096
  s_cmp_lg_u32 s101, 0
  s_cbranch_scc1 RW_zw
  ds_write_b128 v10, v[132:135] offset:8192
RW_zw:
  s_waitcnt lgkmcnt(0)
  s_barrier
  ds_read_b64_tr_b16 v[28:29], v11 offset:0
  ds_read_b64_tr_b16 v[30:31], v11 offset:64
  ds_read_b64_tr_b16 v[32:33], v11 offset:4096
  ds_read_b64_tr_b16 v[34:35], v11 offset:4160
  s_cmp_lg_u32 s101, 0
  s_cbranch_scc1 RW_tr
  ds_read_b64_tr_b16 v[36:37], v11 offset:8192
  ds_read_b64_tr_b16 v[38:39], v11 offset:8256
RW_tr:
  ds_read_b64 v[144:145], v12 offset:9216
  ds_read_b64 v[146:147], v12 offset:9280
  ds_read_b64 v[148:149], v12 offset:9344
  ds_read_b64 v[150:151], v12 offset:9408
  s_waitcnt lgkmcnt(0)
  v_add_f32 v144, v144, v146
  v_add_f32 v145, v145, v147
  v_add_f32 v148, v148, v150
  v_add_f32 v149, v149, v151
  v_add_f32 v144, v144, v148
  v_add_f32 v145, v145, v149
  v_mul_f32 v160, 0x3ae38e39, v144
  v_mul_f32 v161, 0x3ae38e39, v145
  v_fma_f32 v161, -v160, v160, v161
  v_max_f32 v161, 0, v161
  v_cvt_pk_bf16_f32 v160, v160, v160
  v_lshlrev_b32 v160, 16, v160
  v_cvt_pk_bf16_f32 v161, v161, v161
  v_lshlrev_b32 v161, 16, v161
  v_add_f32 v161, 0x3727c5ac, v161
  v_cvt_pk_bf16_f32 v161, v161, v161
  v_lshlrev_b32 v161, 16, v161
  v_sqrt_f32 v161, v161
  s_nop 0
  v_cvt_pk_bf16_f32 v161, v161, v161
  v_lshlrev_b32 v161, 16, v161
  v_rcp_f32 v161, v161
  s_nop 0
  s_waitcnt vmcnt(0)
  v_lshlrev_b32 v144, 16, v28
  v_and_b32 v145, 0xffff0000, v28
  v_lshlrev_b32 v146, 16, v64
  v_and_b32 v147, 0xffff0000, v64
  v_lshlrev_b32 v148, 16, v68
  v_and_b32 v149, 0xffff0000, v68
  v_lshlrev_b32 v150, 16, v72
  v_and_b32 v151, 0xffff0000, v72
  v_pk_add_f32 v[152:153], v[40:41], v[160:161] op_sel_hi:[1,0] neg_lo:[0,1] neg_hi:[0,1]
  v_pk_mul_f32 v[152:153], v[152:153], v[160:161] op_sel:[0,1]
  v_pk_fma_f32 v[152:153], v[152:153], v[148:149], v[146:147]
  v_pk_mul_f32 v[152:153], v[152:153], v[144:145]
  v_pk_fma_f32 v[152:153], v[152:153], v[150:151], v[40:41]
  v_cvt_pk_bf16_f32 v16, v152, v153
  v_lshlrev_b32 v144, 16, v29
  v_and_b32 v145, 0xffff0000, v29
  v_lshlrev_b32 v146, 16, v65
  v_and_b32 v147, 0xffff0000, v65
  v_lshlrev_b32 v148, 16, v69
  v_and_b32 v149, 0xffff0000, v69
  v_lshlrev_b32 v150, 16, v73
  v_and_b32 v151, 0xffff0000, v73
  v_pk_add_f32 v[152:153], v[42:43], v[160:161] op_sel_hi:[1,0] neg_lo:[0,1] neg_hi:[0,1]
  v_pk_mul_f32 v[152:153], v[152:153], v[160:161] op_sel:[0,1]
  v_pk_fma_f32 v[152:153], v[152:153], v[148:149], v[146:147]
  v_pk_mul_f32 v[152:153], v[152:153], v[144:145]
  v_pk_fma_f32 v[152:153], v[152:153], v[150:151], v[42:43]
  v_cvt_pk_bf16_f32 v17, v152, v153
  v_lshlrev_b32 v144, 16, v30
  v_and_b32 v145, 0xffff0000, v30
  v_lshlrev_b32 v146, 16, v66
  v_and_b32 v147, 0xffff0000, v66
  v_lshlrev_b32 v148, 16, v70
  v_and_b32 v149, 0xffff0000, v70
  v_lshlrev_b32 v150, 16, v74
  v_and_b32 v151, 0xffff0000, v74
  v_pk_add_f32 v[152:153], v[44:45], v[160:161] op_sel_hi:[1,0] neg_lo:[0,1] neg_hi:[0,1]
  v_pk_mul_f32 v[152:153], v[152:153], v[160:161] op_sel:[0,1]
  v_pk_fma_f32 v[152:153], v[152:153], v[148:149], v[146:147]
  v_pk_mul_f32 v[152:153], v[152:153], v[144:145]
  v_pk_fma_f32 v[152:153], v[152:153], v[150:151], v[44:45]
  v_cvt_pk_bf16_f32 v18, v152, v153
  v_lshlrev_b32 v144, 16, v31
  v_and_b32 v145, 0xffff0000, v31
  v_lshlrev_b32 v146, 16, v67
  v_and_b32 v147, 0xffff0000, v67
  v_lshlrev_b32 v148, 16, v71
  v_and_b32 v149, 0xffff0000, v71
  v_lshlrev_b32 v150, 16, v75
  v_and_b32 v151, 0xffff0000, v75
  v_pk_add_f32 v[152:153], v[46:47], v[160:161] op_sel_hi:[1,0] neg_lo:[0,1] neg_hi:[0,1]
  v_pk_mul_f32 v[152:153], v[152:153], v[160:161] op_sel:[0,1]
  v_pk_fma_f32 v[152:153], v[152:153], v[148:149], v[146:147]
  v_pk_mul_f32 v[152:153], v[152:153], v[144:145]
  v_pk_fma_f32 v[152:153], v[152:153], v[150:151], v[46:47]
  v_cvt_pk_bf16_f32 v19, v152, v153
  s_mov_b32 s34, 0
  buffer_store_dwordx2 v[16:17], v15, s[36:39], s34 offen sc1
  buffer_store_dwordx2 v[18:19], v15, s[36:39], s34 offen offset:256 sc1
  v_lshlrev_b32 v144, 16, v32
  v_and_b32 v145, 0xffff0000, v32
  v_lshlrev_b32 v146, 16, v84
  v_and_b32 v147, 0xffff0000, v84
  v_lshlrev_b32 v148, 16, v88
  v_and_b32 v149, 0xffff0000, v88
  v_lshlrev_b32 v150, 16, v92
  v_and_b32 v151, 0xffff0000, v92
  v_pk_add_f32 v[152:153], v[48:49], v[160:161] op_sel_hi:[1,0] neg_lo:[0,1] neg_hi:[0,1]
  v_pk_mul_f32 v[152:153], v[152:153], v[160:161] op_sel:[0,1]
  v_pk_fma_f32 v[152:153], v[152:153], v[148:149], v[146:147]
  v_pk_mul_f32 v[152:153], v[152:153], v[144:145]
  v_pk_fma_f32 v[152:153], v[152:153], v[150:151], v[48:49]
  v_cvt_pk_bf16_f32 v20, v152, v153
  v_lshlrev_b32 v144, 16, v33
  v_and_b32 v145, 0xffff0000, v33
  v_lshlrev_b32 v146, 16, v85
  v_and_b32 v147, 0xffff0000, v85
  v_lshlrev_b32 v148, 16, v89
  v_and_b32 v149, 0xffff0000, v89
  v_lshlrev_b32 v150, 16, v93
  v_and_b32 v151, 0xffff0000, v93
  v_pk_add_f32 v[152:153], v[50:51], v[160:161] op_sel_hi:[1,0] neg_lo:[0,1] neg_hi:[0,1]
  v_pk_mul_f32 v[152:153], v[152:153], v[160:161] op_sel:[0,1]
  v_pk_fma_f32 v[152:153], v[152:153], v[148:149], v[146:147]
  v_pk_mul_f32 v[152:153], v[152:153], v[144:145]
  v_pk_fma_f32 v[152:153], v[152:153], v[150:151], v[50:51]
  v_cvt_pk_bf16_f32 v21, v152, v153
  v_lshlrev_b32 v144, 16, v34
  v_and_b32 v145, 0xffff0000, v34
  v_lshlrev_b32 v146, 16, v86
  v_and_b32 v147, 0xffff0000, v86
  v_lshlrev_b32 v148, 16, v90
  v_and_b32 v149, 0xffff0000, v90
  v_lshlrev_b32 v150, 16, v94
  v_and_b32 v151, 0xffff0000, v94
  v_pk_add_f32 v[152:153], v[52:53], v[160:161] op_sel_hi:[1,0] neg_lo:[0,1] neg_hi:[0,1]
  v_pk_mul_f32 v[152:153], v[152:153], v[160:161] op_sel:[0,1]
  v_pk_fma_f32 v[152:153], v[152:153], v[148:149], v[146:147]
  v_pk_mul_f32 v[152:153], v[152:153], v[144:145]
  v_pk_fma_f32 v[152:153], v[152:153], v[150:151], v[52:53]
  v_cvt_pk_bf16_f32 v22, v152, v153
  v_lshlrev_b32 v144, 16, v35
  v_and_b32 v145, 0xffff0000, v35
  v_lshlrev_b32 v146, 16, v87
  v_and_b32 v147, 0xffff0000, v87
  v_lshlrev_b32 v148, 16, v91
  v_and_b32 v149, 0xffff0000, v91
  v_lshlrev_b32 v150, 16, v95
  v_and_b32 v151, 0xffff0000, v95
  v_pk_add_f32 v[152:153], v[54:55], v[160:161] op_sel_hi:[1,0] neg_lo:[0,1] neg_hi:[0,1]
  v_pk_mul_f32 v[152:153], v[152:153], v[160:161] op_sel:[0,1]
  v_pk_fma_f32 v[152:153], v[152:153], v[148:149], v[146:147]
  v_pk_mul_f32 v[152:153], v[152:153], v[144:145]
  v_pk_fma_f32 v[152:153], v[152:153], v[150:151], v[54:55]
  v_cvt_pk_bf16_f32 v23, v152, v153
  s_mov_b32 s34, 32768
  buffer_store_dwordx2 v[20:21], v15, s[36:39], s34 offen sc1
  buffer_store_dwordx2 v[22:23], v15, s[36:39], s34 offen offset:256 sc1
  s_cmp_lg_u32 s101, 0
  s_cbranch_scc1 RW_x1
  v_lshlrev_b32 v144, 16, v36
  v_and_b32 v145, 0xffff0000, v36
  v_lshlrev_b32 v146, 16, v104
  v_and_b32 v147, 0xffff0000, v104
  v_lshlrev_b32 v148, 16, v108
  v_and_b32 v149, 0xffff0000, v108
  v_lshlrev_b32 v150, 16, v112
  v_and_b32 v151, 0xffff0000, v112
  v_pk_add_f32 v[152:153], v[56:57], v[160:161] op_sel_hi:[1,0] neg_lo:[0,1] neg_hi:[0,1]
  v_pk_mul_f32 v[152:153], v[152:153], v[160:161] op_sel:[0,1]
  v_pk_fma_f32 v[152:153], v[152:153], v[148:149], v[146:147]
  v_pk_mul_f32 v[152:153], v[152:153], v[144:145]
  v_pk_fma_f32 v[152:153], v[152:153], v[150:151], v[56:57]
  v_cvt_pk_bf16_f32 v24, v152, v153
  v_lshlrev_b32 v144, 16, v37
  v_and_b32 v145, 0xffff0000, v37
  v_lshlrev_b32 v146, 16, v105
  v_and_b32 v147, 0xffff0000, v105
  v_lshlrev_b32 v148, 16, v109
  v_and_b32 v149, 0xffff0000, v109
  v_lshlrev_b32 v150, 16, v113
  v_and_b32 v151, 0xffff0000, v113
  v_pk_add_f32 v[152:153], v[58:59], v[160:161] op_sel_hi:[1,0] neg_lo:[0,1] neg_hi:[0,1]
  v_pk_mul_f32 v[152:153], v[152:153], v[160:161] op_sel:[0,1]
  v_pk_fma_f32 v[152:153], v[152:153], v[148:149], v[146:147]
  v_pk_mul_f32 v[152:153], v[152:153], v[144:145]
  v_pk_fma_f32 v[152:153], v[152:153], v[150:151], v[58:59]
  v_cvt_pk_bf16_f32 v25, v152, v153
  v_lshlrev_b32 v144, 16, v38
  v_and_b32 v145, 0xffff0000, v38
  v_lshlrev_b32 v146, 16, v106
  v_and_b32 v147, 0xffff0000, v106
  v_lshlrev_b32 v148, 16, v110
  v_and_b32 v149, 0xffff0000, v110
  v_lshlrev_b32 v150, 16, v114
  v_and_b32 v151, 0xffff0000, v114
  v_pk_add_f32 v[152:153], v[60:61], v[160:161] op_sel_hi:[1,0] neg_lo:[0,1] neg_hi:[0,1]
  v_pk_mul_f32 v[152:153], v[152:153], v[160:161] op_sel:[0,1]
  v_pk_fma_f32 v[152:153], v[152:153], v[148:149], v[146:147]
  v_pk_mul_f32 v[152:153], v[152:153], v[144:145]
  v_pk_fma_f32 v[152:153], v[152:153], v[150:151], v[60:61]
  v_cvt_pk_bf16_f32 v26, v152, v153
  v_lshlrev_b32 v144, 16, v39
  v_and_b32 v145, 0xffff0000, v39
  v_lshlrev_b32 v146, 16, v107
  v_and_b32 v147, 0xffff0000, v107
  v_lshlrev_b32 v148, 16, v111
  v_and_b32 v149, 0xffff0000, v111
  v_lshlrev_b32 v150, 16, v115
  v_and_b32 v151, 0xffff0000, v115
  v_pk_add_f32 v[152:153], v[62:63], v[160:161] op_sel_hi:[1,0] neg_lo:[0,1] neg_hi:[0,1]
  v_pk_mul_f32 v[152:153], v[152:153], v[160:161] op_sel:[0,1]
  v_pk_fma_f32 v[152:153], v[152:153], v[148:149], v[146:147]
  v_pk_mul_f32 v[152:153], v[152:153], v[144:145]
  v_pk_fma_f32 v[152:153], v[152:153], v[150:151], v[62:63]
  v_cvt_pk_bf16_f32 v27, v152, v153
  s_mov_b32 s34, 65536
  buffer_store_dwordx2 v[24:25], v15, s[36:39], s34 offen sc1
  buffer_store_dwordx2 v[26:27], v15, s[36:39], s34 offen offset:256 sc1
RW_x1:
  v_mov_b32 v164, 0
  v_mov_b32 v165, 0
  v_mov_b32 v166, 0
  v_mov_b32 v167, 0
  v_lshlrev_b32 v40, 16, v16
  v_and_b32 v41, 0xffff0000, v16
  v_lshlrev_b32 v42, 16, v17
  v_and_b32 v43, 0xffff0000, v17
  v_lshlrev_b32 v44, 16, v18
  v_and_b32 v45, 0xffff0000, v18
  v_lshlrev_b32 v46, 16, v19
  v_and_b32 v47, 0xffff0000, v19
  v_pk_add_f32 v[164:165], v[164:165], v[40:41]
  v_pk_fma_f32 v[166:167], v[40:41], v[40:41], v[166:167]
  v_pk_add_f32 v[164:165], v[164:165], v[42:43]
  v_pk_fma_f32 v[166:167], v[42:43], v[42:43], v[166:167]
  v_pk_add_f32 v[164:165], v[164:165], v[44:45]
  v_pk_fma_f32 v[166:167], v[44:45], v[44:45], v[166:167]
  v_pk_add_f32 v[164:165], v[164:165], v[46:47]
  v_pk_fma_f32 v[166:167], v[46:47], v[46:47], v[166:167]
  v_lshlrev_b32 v48, 16, v20
  v_and_b32 v49, 0xffff0000, v20
  v_lshlrev_b32 v50, 16, v21
  v_and_b32 v51, 0xffff0000, v21
  v_lshlrev_b32 v52, 16, v22
  v_and_b32 v53, 0xffff0000, v22
  v_lshlrev_b32 v54, 16, v23
  v_and_b32 v55, 0xffff0000, v23
  v_pk_add_f32 v[164:165], v[164:165], v[48:49]
  v_pk_fma_f32 v[166:167], v[48:49], v[48:49], v[166:167]
  v_pk_add_f32 v[164:165], v[164:165], v[50:51]
  v_pk_fma_f32 v[166:167], v[50:51], v[50:51], v[166:167]
  v_pk_add_f32 v[164:165], v[164:165], v[52:53]
  v_pk_fma_f32 v[166:167], v[52:53], v[52:53], v[166:167]
  v_pk_add_f32 v[164:165], v[164:165], v[54:55]
  v_pk_fma_f32 v[166:167], v[54:55], v[54:55], v[166:167]
  s_cmp_lg_u32 s101, 0
  s_cbranch_scc1 RW_s2
  v_lshlrev_b32 v56, 16, v24
  v_and_b32 v57, 0xffff0000, v24
  v_lshlrev_b32 v58, 16, v25
  v_and_b32 v59, 0xffff0000, v25
  v_lshlrev_b32 v60, 16, v26
  v_and_b32 v61, 0xffff0000, v26
  v_lshlrev_b32 v62, 16, v27
  v_and_b32 v63, 0xffff0000, v27
  v_pk_add_f32 v[164:165], v[164:165], v[56:57]
  v_pk_fma_f32 v[166:167], v[56:57], v[56:57], v[166:167]
  v_pk_add_f32 v[164:165], v[164:165], v[58:59]
  v_pk_fma_f32 v[166:167], v[58:59], v[58:59], v[166:167]
  v_pk_add_f32 v[164:165], v[164:165], v[60:61]
  v_pk_fma_f32 v[166:167], v[60:61], v[60:61], v[166:167]
  v_pk_add_f32 v[164:165], v[164:165], v[62:63]
  v_pk_fma_f32 v[166:167], v[62:63], v[62:63], v[166:167]
RW_s2:
  v_add_f32 v140, v164, v165
  v_add_f32 v141, v166, v167
  s_nop 1
  v_mov_b32_dpp v142, v140 row_ror:8 row_mask:0xf bank_mask:0xf
  v_mov_b32_dpp v143, v141 row_ror:8 row_mask:0xf bank_mask:0xf
  v_add_f32 v140, v140, v142
  v_add_f32 v141, v141, v143
  v_mov_b32 v142, v140
  v_mov_b32 v143, v141
  s_nop 1
  v_permlane16_swap_b32 v140, v142
  v_permlane16_swap_b32 v141, v143
  v_add_f32 v140, v140, v142
  v_add_f32 v141, v141, v143
  v_mov_b32 v142, v140
  v_mov_b32 v143, v141
  s_nop 1
  v_permlane32_swap_b32 v140, v142
  v_permlane32_swap_b32 v141, v143
  v_add_f32 v140, v140, v142
  v_add_f32 v141, v141, v143
  v_cmp_gt_u32 vcc, 8, v1
  s_and_saveexec_b64 s[46:47], vcc
  ds_write_b64 v13, v[140:141] offset:10240
  s_mov_b64 exec, s[46:47]
  s_waitcnt lgkmcnt(0)
  s_barrier
  ds_read_b64 v[144:145], v12 offset:10240
  ds_read_b64 v[146:147], v12 offset:10304
  ds_read_b64 v[148:149], v12 offset:10368
  ds_read_b64 v[150:151], v12 offset:10432
  s_waitcnt lgkmcnt(0)
  v_add_f32 v144, v144, v146
  v_add_f32 v145, v145, v147
  v_add_f32 v148, v148, v150
  v_add_f32 v149, v149, v151
  v_add_f32 v144, v144, v148
  v_add_f32 v145, v145, v149
  v_mul_f32 v160, 0x3ae38e39, v144
  v_mul_f32 v161, 0x3ae38e39, v145
  v_fma_f32 v161, -v160, v160, v161
  v_max_f32 v161, 0, v161
  v_cvt_pk_bf16_f32 v160, v160, v160
  v_lshlrev_b32 v160, 16, v160
  v_cvt_pk_bf16_f32 v161, v161, v161
  v_lshlrev_b32 v161, 16, v161
  v_add_f32 v161, 0x3727c5ac, v161
  v_cvt_pk_bf16_f32 v161, v161, v161
  v_lshlrev_b32 v161, 16, v161
  v_sqrt_f32 v161, v161
  s_nop 0
  v_cvt_pk_bf16_f32 v161, v161, v161
  v_lshlrev_b32 v161, 16, v161
  v_rcp_f32 v161, v161
  s_nop 0
  v_lshlrev_b32 v146, 16, v76
  v_and_b32 v147, 0xffff0000, v76
  v_lshlrev_b32 v148, 16, v80
  v_and_b32 v149, 0xffff0000, v80
  v_pk_add_f32 v[152:153], v[40:41], v[160:161] op_sel_hi:[1,0] neg_lo:[0,1] neg_hi:[0,1]
  v_pk_mul_f32 v[152:153], v[152:153], v[160:161] op_sel:[0,1]
  v_pk_fma_f32 v[152:153], v[152:153], v[148:149], v[146:147]
  v_cvt_pk_bf16_f32 v28, v152, v153
  v_lshlrev_b32 v146, 16, v77
  v_and_b32 v147, 0xffff0000, v77
  v_lshlrev_b32 v148, 16, v81
  v_and_b32 v149, 0xffff0000, v81
  v_pk_add_f32 v[152:153], v[42:43], v[160:161] op_sel_hi:[1,0] neg_lo:[0,1] neg_hi:[0,1]
  v_pk_mul_f32 v[152:153], v[152:153], v[160:161] op_sel:[0,1]
  v_pk_fma_f32 v[152:153], v[152:153], v[148:149], v[146:147]
  v_cvt_pk_bf16_f32 v29, v152, v153
  v_lshlrev_b32 v146, 16, v78
  v_and_b32 v147, 0xffff0000, v78
  v_lshlrev_b32 v148, 16, v82
  v_and_b32 v149, 0xffff0000, v82
  v_pk_add_f32 v[152:153], v[44:45], v[160:161] op_sel_hi:[1,0] neg_lo:[0,1] neg_hi:[0,1]
  v_pk_mul_f32 v[152:153], v[152:153], v[160:161] op_sel:[0,1]
  v_pk_fma_f32 v[152:153], v[152:153], v[148:149], v[146:147]
  v_cvt_pk_bf16_f32 v30, v152, v153
  v_lshlrev_b32 v146, 16, v79
  v_and_b32 v147, 0xffff0000, v79
  v_lshlrev_b32 v148, 16, v83
  v_and_b32 v149, 0xffff0000, v83
  v_pk_add_f32 v[152:153], v[46:47], v[160:161] op_sel_hi:[1,0] neg_lo:[0,1] neg_hi:[0,1]
  v_pk_mul_f32 v[152:153], v[152:153], v[160:161] op_sel:[0,1]
  v_pk_fma_f32 v[152:153], v[152:153], v[148:149], v[146:147]
  v_cvt_pk_bf16_f32 v31, v152, v153
  s_mov_b32 s34, 0
  buffer_store_dwordx4 v[28:31], v14, s[20:23], s34 offen sc1
  v_lshlrev_b32 v146, 16, v96
  v_and_b32 v147, 0xffff0000, v96
  v_lshlrev_b32 v148, 16, v100
  v_and_b32 v149, 0xffff0000, v100
  v_pk_add_f32 v[152:153], v[48:49], v[160:161] op_sel_hi:[1,0] neg_lo:[0,1] neg_hi:[0,1]
  v_pk_mul_f32 v[152:153], v[152:153], v[160:161] op_sel:[0,1]
  v_pk_fma_f32 v[152:153], v[152:153], v[148:149], v[146:147]
  v_cvt_pk_bf16_f32 v32, v152, v153
  v_lshlrev_b32 v146, 16, v97
  v_and_b32 v147, 0xffff0000, v97
  v_lshlrev_b32 v148, 16, v101
  v_and_b32 v149, 0xffff0000, v101
  v_pk_add_f32 v[152:153], v[50:51], v[160:161] op_sel_hi:[1,0] neg_lo:[0,1] neg_hi:[0,1]
  v_pk_mul_f32 v[152:153], v[152:153], v[160:161] op_sel:[0,1]
  v_pk_fma_f32 v[152:153], v[152:153], v[148:149], v[146:147]
  v_cvt_pk_bf16_f32 v33, v152, v153
  v_lshlrev_b32 v146, 16, v98
  v_and_b32 v147, 0xffff0000, v98
  v_lshlrev_b32 v148, 16, v102
  v_and_b32 v149, 0xffff0000, v102
  v_pk_add_f32 v[152:153], v[52:53], v[160:161] op_sel_hi:[1,0] neg_lo:[0,1] neg_hi:[0,1]
  v_pk_mul_f32 v[152:153], v[152:153], v[160:161] op_sel:[0,1]
  v_pk_fma_f32 v[152:153], v[152:153], v[148:149], v[146:147]
  v_cvt_pk_bf16_f32 v34, v152, v153
  v_lshlrev_b32 v146, 16, v99
  v_and_b32 v147, 0xffff0000, v99
  v_lshlrev_b32 v148, 16, v103
  v_and_b32 v149, 0xffff0000, v103
  v_pk_add_f32 v[152:153], v[54:55], v[160:161] op_sel_hi:[1,0] neg_lo:[0,1] neg_hi:[0,1]
  v_pk_mul_f32 v[152:153], v[152:153], v[160:161] op_sel:[0,1]
  v_pk_fma_f32 v[152:153], v[152:153], v[148:149], v[146:147]
  v_cvt_pk_bf16_f32 v35, v152, v153
  s_mov_b32 s34, 32768
  buffer_store_dwordx4 v[32:35], v14, s[20:23], s34 offen sc1
  s_cmp_lg_u32 s101, 0
  s_cbranch_scc1 RW_h2
  v_lshlrev_b32 v146, 16, v116
  v_and_b32 v147, 0xffff0000, v116
  v_lshlrev_b32 v148, 16, v120
  v_and_b32 v149, 0xffff0000, v120
  v_pk_add_f32 v[152:153], v[56:57], v[160:161] op_sel_hi:[1,0] neg_lo:[0,1] neg_hi:[0,1]
  v_pk_mul_f32 v[152:153], v[152:153], v[160:161] op_sel:[0,1]
  v_pk_fma_f32 v[152:153], v[152:153], v[148:149], v[146:147]
  v_cvt_pk_bf16_f32 v36, v152, v153
  v_lshlrev_b32 v146, 16, v117
  v_and_b32 v147, 0xffff0000, v117
  v_lshlrev_b32 v148, 16, v121
  v_and_b32 v149, 0xffff0000, v121
  v_pk_add_f32 v[152:153], v[58:59], v[160:161] op_sel_hi:[1,0] neg_lo:[0,1] neg_hi:[0,1]
  v_pk_mul_f32 v[152:153], v[152:153], v[160:161] op_sel:[0,1]
  v_pk_fma_f32 v[152:153], v[152:153], v[148:149], v[146:147]
  v_cvt_pk_bf16_f32 v37, v152, v153
  v_lshlrev_b32 v146, 16, v118
  v_and_b32 v147, 0xffff0000, v118
  v_lshlrev_b32 v148, 16, v122
  v_and_b32 v149, 0xffff0000, v122
  v_pk_add_f32 v[152:153], v[60:61], v[160:161] op_sel_hi:[1,0] neg_lo:[0,1] neg_hi:[0,1]
  v_pk_mul_f32 v[152:153], v[152:153], v[160:161] op_sel:[0,1]
  v_pk_fma_f32 v[152:153], v[152:153], v[148:149], v[146:147]
  v_cvt_pk_bf16_f32 v38, v152, v153
  v_lshlrev_b32 v146, 16, v119
  v_and_b32 v147, 0xffff0000, v119
  v_lshlrev_b32 v148, 16, v123
  v_and_b32 v149, 0xffff0000, v123
  v_pk_add_f32 v[152:153], v[62:63], v[160:161] op_sel_hi:[1,0] neg_lo:[0,1] neg_hi:[0,1]
  v_pk_mul_f32 v[152:153], v[152:153], v[160:161] op_sel:[0,1]
  v_pk_fma_f32 v[152:153], v[152:153], v[148:149], v[146:147]
  v_cvt_pk_bf16_f32 v39, v152, v153
  s_mov_b32 s34, 65536
  buffer_store_dwordx4 v[36:39], v14, s[20:23], s34 offen sc1
RW_h2:
  s_lshl_b32 s57, s28, 3
  s_add_u32 s57, s57, s29
  s_lshl_b32 s57, s57, 7
  s_add_u32 s57, s57, 98304
  s_waitcnt vmcnt(0)
  s_barrier
  s_cmp_lg_u32 s101, 0
  s_cbranch_scc1 RWP_nopub
  v_mov_b32 v140, s57
  v_mov_b32 v141, s100
  v_cmp_eq_u32 vcc, 0, v1
  s_and_saveexec_b64 s[90:91], vcc
  buffer_store_dword v141, v140, s[40:43], 0 offen sc1
  s_mov_b64 exec, s[90:91]
RWP_nopub:
  s_load_dwordx2 s[26:27], s[0:1], 112
  v_lshrrev_b32 v7, 6, v0
  v_and_b32 v1, 63, v0
  s_and_b32 s28, s2, 3
  s_lshl_b32 s28, s28, 1
  s_bfe_u32 s29, s2, 0x10003
  s_add_u32 s28, s28, s29
  s_bfe_u32 s29, s2, 0x10002
  s_lshl_b32 s29, s29, 4
  s_lshr_b32 s31, s2, 4
  s_add_u32 s29, s29, s31
  v_readfirstlane_b32 s30, v7
  v_lshlrev_b32 v2, 4, v1
  s_mul_i32 s40, s28, 1990656
  s_mul_i32 s33, s30, 497664
  s_add_u32 s40, s40, s33
  s_lshl_b32 s48, s30, 10
  s_mul_i32 s49, s29, 73728
  s_add_u32 s49, s49, s48
  s_lshr_b32 s32, s30, 1
  s_and_b32 s31, s30, 1
  s_lshl_b32 s34, s32, 12
  s_lshl_b32 s35, s31, 3
  s_add_u32 s34, s34, s35
  s_add_u32 s34, s34, 73728
  v_add_u32 v4, s34, v2
  s_mov_b32 s43, 57344
  s_mul_i32 s51, s30, 18432
  s_add_u32 s51, s51, 73728
  v_add_u32 v51, s51, v2
  v_mov_b32 v6, v2
  v_add_u32 v40, 0x10000, v2
  v_add_u32 v41, 0x20000, v2
  v_mov_b32 v5, 0xbdd2d3e8
  s_mul_i32 s36, s28, 2359296
  s_mul_i32 s37, s29, 73728
  s_add_u32 s36, s36, s37
  s_lshl_b32 s37, s30, 11
  s_add_u32 s44, s36, s37
  s_waitcnt lgkmcnt(0)
  s_add_u32 s8, s26, 30408704
  s_addc_u32 s9, s27, 0
  s_add_u32 s8, s8, s40
  s_addc_u32 s9, s9, 0
  s_mov_b32 s10, 497664
  s_mov_b32 s11, 0x20000
  s_mov_b32 s40, 0
  s_add_u32 s16, s26, 10485760
  s_addc_u32 s17, s27, 0
  s_mov_b32 s18, 18874368
  s_mov_b32 s19, 0x20000
  s_add_u32 s20, s26, 4784128
  s_addc_u32 s21, s27, 0
  s_mov_b32 s22, 2359296
  s_mov_b32 s23, 0x20000
  s_add_u32 s52, s26, 47185920
  s_addc_u32 s53, s27, 0
  s_mov_b32 s54, 491520
  s_mov_b32 s55, 0x20000
  s_load_dwordx2 s[78:79], s[0:1], 96
  s_mul_i32 s64, s28, 2359296
  s_mul_i32 s65, s29, 73728
  s_add_u32 s64, s64, s65
  s_lshl_b32 s66, s30, 11
  s_add_u32 s64, s64, s66
  s_lshl_b32 s69, s28, 13
  s_add_u32 s66, s66, s65
  s_add_u32 s66, s66, s69
  s_lshl_b32 s67, s29, 3
  s_add_u32 s67, s67, s28
  s_lshl_b32 s67, s67, 2
  s_add_u32 s67, s67, s30
  s_lshl_b32 s67, s67, 7
  s_lshl_b32 s68, s30, 14
  s_lshl_b32 s71, s28, 2
  s_add_u32 s71, s71, s30
  s_lshl_b32 s71, s71, 5
  s_add_u32 s71, s71, 5760
  v_and_b32 v46, 7, v1
  s_lshl_b32 s69, s29, 3
  v_add_u32 v46, s69, v46
  v_lshlrev_b32 v46, 2, v46
  v_add_u32 v46, s30, v46
  v_lshlrev_b32 v46, 7, v46
  v_add_u32 v46, 229376, v46
  v_and_b32 v47, 3, v1
  v_min_u32 v47, 2, v47
  v_add_u32 v47, s28, v47
  v_add_u32 v47, 1, v47
  v_and_b32 v47, 7, v47
  v_add_u32 v47, s69, v47
  v_lshlrev_b32 v47, 2, v47
  v_add_u32 v47, s30, v47
  v_lshlrev_b32 v47, 7, v47
  v_add_u32 v47, 360448, v47
  v_lshrrev_b32 v48, 4, v1
  v_and_b32 v49, 15, v1
  v_and_b32 v50, 1, v48
  v_lshl_add_u32 v49, v50, 4, v49
  s_lshl_b32 s69, s29, 6
  v_add_u32 v49, s69, v49
  s_movk_i32 s69, 1152
  v_mul_lo_u32 v49, v49, s69
  v_lshrrev_b32 v50, 1, v48
  v_lshl_add_u32 v49, v50, 4, v49
  v_lshlrev_b32 v48, 3, v48
  s_waitcnt lgkmcnt(0)
  s_mov_b32 s76, s78
  s_mov_b32 s77, s79
  s_mov_b32 s78, 2359296
  s_mov_b32 s79, 0x20000
  s_add_u32 s72, s26, 4718592
  s_addc_u32 s73, s27, 0
  s_mov_b32 s74, 6912
  s_mov_b32 s75, 0x20000
  s_add_u32 s84, s26, 50331648
  s_addc_u32 s85, s27, 0
  s_mov_b32 s86, 9437184
  s_mov_b32 s87, 0x20000
  s_lshl_b32 s80, s29, 5
  s_add_u32 s80, s80, s30
  s_mul_i32 s80, s80, 9216
  s_mul_i32 s81, s28, 36864
  s_add_u32 s81, s81, s80
  v_and_b32 v42, 7, v1
  s_lshl_b32 s56, s29, 3
  v_add_u32 v42, s56, v42
  v_lshlrev_b32 v42, 7, v42
  v_add_u32 v42, 98304, v42
  v_lshlrev_b32 v43, 7, v0
  v_add_u32 v44, 163840, v43
  v_add_u32 v43, 47104, v43
  v_cmp_gt_u32 vcc, 144, v0
  s_nop 1
  v_cndmask_b32 v44, v43, v44, vcc
  s_mov_b32 s95, 200000
FF_poll:
  buffer_load_dword v43, v42, s[52:55], 0 offen sc1
  buffer_load_dword v45, v44, s[52:55], 0 offen sc1
  s_waitcnt vmcnt(0)
  v_xor_b32 v43, s100, v43
  v_xor_b32 v45, s100, v45
  v_or_b32 v43, v43, v45
  v_cmp_ne_u32 vcc, 0, v43
  s_cbranch_vccz FF_go
  s_sub_u32 s95, s95, 1
  s_cmp_eq_u32 s95, 0
  s_cbranch_scc1 FF_go
  s_sleep 1
  s_branch FF_poll
FF_go:
  s_barrier
  s_add_u32 m0, s48, 0
  s_add_u32 s50, s49, 0
  buffer_load_dwordx4 v2, s[20:23], s50 offen sc1 lds
  s_add_u32 m0, s48, 4096
  s_add_u32 s50, s49, 4096
  buffer_load_dwordx4 v2, s[20:23], s50 offen sc1 lds
  s_add_u32 m0, s48, 8192
  s_add_u32 s50, s49, 8192
  buffer_load_dwordx4 v2, s[20:23], s50 offen sc1 lds
  s_add_u32 m0, s48, 12288
  s_add_u32 s50, s49, 12288
  buffer_load_dwordx4 v2, s[20:23], s50 offen sc1 lds
  s_add_u32 m0, s48, 16384
  s_add_u32 s50, s49, 16384
  buffer_load_dwordx4 v2, s[20:23], s50 offen sc1 lds
  s_add_u32 m0, s48, 20480
  s_add_u32 s50, s49, 20480
  buffer_load_dwordx4 v2, s[20:23], s50 offen sc1 lds
  buffer_load_dwordx4 v[128:131], v2, s[8:11], s40 offen offset:0 sc1
  buffer_load_dwordx4 v[132:135], v2, s[8:11], s40 offen offset:1024 sc1
  s_add_u32 s40, s40, 2048
  buffer_load_dwordx4 v[136:139], v2, s[8:11], s40 offen offset:0 sc1
  buffer_load_dwordx4 v[140:143], v2, s[8:11], s40 offen offset:1024 sc1
  s_add_u32 s40, s40, 2048
  buffer_load_dwordx4 v[144:147], v2, s[8:11], s40 offen offset:0 sc1
  buffer_load_dwordx4 v[148:151], v2, s[8:11], s40 offen offset:1024 sc1
  s_add_u32 s40, s40, 2048
  buffer_load_dwordx4 v[152:155], v2, s[8:11], s40 offen offset:0 sc1
  buffer_load_dwordx4 v[156:159], v2, s[8:11], s40 offen offset:1024 sc1
  s_add_u32 s40, s40, 2048
  buffer_load_dwordx4 v[160:163], v2, s[8:11], s40 offen offset:0 sc1
  buffer_load_dwordx4 v[164:167], v2, s[8:11], s40 offen offset:1024 sc1
  s_add_u32 s40, s40, 2048
  buffer_load_dwordx4 v[168:171], v2, s[8:11], s40 offen offset:0 sc1
  buffer_load_dwordx4 v[172:175], v2, s[8:11], s40 offen offset:1024 sc1
  s_add_u32 s40, s40, 2048
  s_add_u32 m0, s48, 24576
  s_add_u32 s50, s49, 24576
  buffer_load_dwordx4 v2, s[20:23], s50 offen sc1 lds
  s_add_u32 m0, s48, 28672
  s_add_u32 s50, s49, 28672
  buffer_load_dwordx4 v2, s[20:23], s50 offen sc1 lds
  s_add_u32 m0, s48, 32768
  s_add_u32 s50, s49, 32768
  buffer_load_dwordx4 v2, s[20:23], s50 offen sc1 lds
  s_add_u32 m0, s48, 36864
  s_add_u32 s50, s49, 36864
  buffer_load_dwordx4 v2, s[20:23], s50 offen sc1 lds
  s_add_u32 m0, s48, 40960
  s_add_u32 s50, s49, 40960
  buffer_load_dwordx4 v2, s[20:23], s50 offen sc1 lds
  s_add_u32 m0, s48, 45056
  s_add_u32 s50, s49, 45056
  buffer_load_dwordx4 v2, s[20:23], s50 offen sc1 lds
  s_add_u32 m0, s48, 49152
  s_add_u32 s50, s49, 49152
  buffer_load_dwordx4 v2, s[20:23], s50 offen sc1 lds
  s_add_u32 m0, s48, 53248
  s_add_u32 s50, s49, 53248
  buffer_load_dwordx4 v2, s[20:23], s50 offen sc1 lds
  s_add_u32 m0, s48, 57344
  s_add_u32 s50, s49, 57344
  buffer_load_dwordx4 v2, s[20:23], s50 offen sc1 lds
  s_add_u32 m0, s48, 61440
  s_add_u32 s50, s49, 61440
  buffer_load_dwordx4 v2, s[20:23], s50 offen sc1 lds
  s_add_u32 m0, s48, 65536
  s_add_u32 s50, s49, 65536
  buffer_load_dwordx4 v2, s[20:23], s50 offen sc1 lds
  s_add_u32 m0, s48, 69632
  s_add_u32 s50, s49, 69632
  buffer_load_dwordx4 v2, s[20:23], s50 offen sc1 lds
  buffer_load_dwordx4 v[176:179], v2, s[8:11], s40 offen offset:0 sc1
  buffer_load_dwordx4 v[180:183], v2, s[8:11], s40 offen offset:1024 sc1
  s_add_u32 s40, s40, 2048
  buffer_load_dwordx4 v[184:187], v2, s[8:11], s40 offen offset:0 sc1
  buffer_load_dwordx4 v[188:191], v2, s[8:11], s40 offen offset:1024 sc1
  s_add_u32 s40, s40, 2048
  buffer_load_dwordx4 v[192:195], v2, s[8:11], s40 offen offset:0 sc1
  buffer_load_dwordx4 v[196:199], v2, s[8:11], s40 offen offset:1024 sc1
  s_add_u32 s40, s40, 2048
  buffer_load_dwordx4 v[200:203], v2, s[8:11], s40 offen offset:0 sc1
  buffer_load_dwordx4 v[204:207], v2, s[8:11], s40 offen offset:1024 sc1
  s_add_u32 s40, s40, 2048
  buffer_load_dwordx4 v[208:211], v2, s[8:11], s40 offen offset:0 sc1
  buffer_load_dwordx4 v[212:215], v2, s[8:11], s40 offen offset:1024 sc1
  s_add_u32 s40, s40, 2048
  buffer_load_dwordx4 v[216:219], v2, s[8:11], s40 offen offset:0 sc1
  s_waitcnt vmcnt(35)
  s_barrier
  ds_read_b128 a[0:3], v6 offset:0
  ds_read_b128 a[4:7], v6 offset:1024
  ds_read_b128 a[8:11], v6 offset:2048
  ds_read_b128 a[12:15], v6 offset:3072
  ds_read_b128 a[16:19], v6 offset:4096
  ds_read_b128 a[20:23], v6 offset:5120
  ds_read_b128 a[24:27], v6 offset:6144
  ds_read_b128 a[28:31], v6 offset:7168
  ds_read_b128 a[32:35], v6 offset:8192
  ds_read_b128 a[36:39], v6 offset:9216
  ds_read_b128 a[40:43], v6 offset:10240
  ds_read_b128 a[44:47], v6 offset:11264
  s_waitcnt lgkmcnt(4)
  ds_read_b128 a[48:51], v6 offset:12288
  ds_read_b128 a[52:55], v6 offset:13312
  ds_read_b128 a[56:59], v6 offset:14336
  ds_read_b128 a[60:63], v6 offset:15360
  ds_read_b128 a[64:67], v6 offset:16384
  ds_read_b128 a[68:71], v6 offset:17408
  ds_read_b128 a[72:75], v6 offset:18432
  ds_read_b128 a[76:79], v6 offset:19456
  s_waitcnt lgkmcnt(4)
  ds_read_b128 a[80:83], v6 offset:20480
  ds_read_b128 a[84:87], v6 offset:21504
  ds_read_b128 a[88:91], v6 offset:22528
  ds_read_b128 a[92:95], v6 offset:23552
  s_waitcnt lgkmcnt(0)
  s_waitcnt vmcnt(34)
  s_mov_b32 s45, 4
.p2align 6
F_loop:
  s_waitcnt lgkmcnt(0)
  v_mfma_f32_16x16x32_bf16 v[64:67], v[128:131], a[0:3], 0
  buffer_load_dwordx4 v[220:223], v2, s[8:11], s40 offen offset:1024 sc1
  s_add_u32 s40, s40, 2048
  v_mfma_f32_16x16x32_bf16 v[68:71], v[128:131], a[4:7], 0
  v_mfma_f32_16x16x32_bf16 v[72:75], v[128:131], a[8:11], 0
  v_mfma_f32_16x16x32_bf16 v[76:79], v[128:131], a[12:15], 0
  s_waitcnt vmcnt(22)
  v_mfma_f32_16x16x32_bf16 v[80:83], v[132:135], a[0:3], 0
  buffer_load_dwordx4 v[128:131], v2, s[8:11], s40 offen offset:0 sc1
  v_mfma_f32_16x16x32_bf16 v[84:87], v[132:135], a[4:7], 0
  v_mfma_f32_16x16x32_bf16 v[88:91], v[132:135], a[8:11], 0
  v_mfma_f32_16x16x32_bf16 v[92:95], v[132:135], a[12:15], 0
  s_waitcnt vmcnt(22)
  v_mfma_f32_16x16x32_bf16 v[64:67], v[136:139], a[16:19], v[64:67]
  buffer_load_dwordx4 v[132:135], v2, s[8:11], s40 offen offset:1024 sc1
  s_add_u32 s40, s40, 2048
  v_mfma_f32_16x16x32_bf16 v[68:71], v[136:139], a[20:23], v[68:71]
  s_add_u32 s43, s43, 8192
  v_mfma_f32_16x16x32_bf16 v[72:75], v[136:139], a[24:27], v[72:75]
  s_cmp_eq_u32 s43, 73728
  s_cselect_b32 s43, 0, s43
  v_mfma_f32_16x16x32_bf16 v[76:79], v[136:139], a[28:31], v[76:79]
  v_add_u32 v3, s43, v4
  s_waitcnt vmcnt(22)
  v_mfma_f32_16x16x32_bf16 v[80:83], v[140:143], a[16:19], v[80:83]
  buffer_load_dwordx4 v[136:139], v2, s[8:11], s40 offen offset:0 sc1
  v_mul_f32 v8, v96, v96
  v_mfma_f32_16x16x32_bf16 v[84:87], v[140:143], a[20:23], v[84:87]
  v_mul_f32 v9, v97, v97
  v_mul_f32 v10, v98, v98
  v_mfma_f32_16x16x32_bf16 v[88:91], v[140:143], a[24:27], v[88:91]
  v_mul_f32 v11, v99, v99
  v_fmaak_f32 v8, v5, v8, 0xc0135761
  v_mfma_f32_16x16x32_bf16 v[92:95], v[140:143], a[28:31], v[92:95]
  v_fmaak_f32 v9, v5, v9, 0xc0135761
  s_waitcnt vmcnt(22)
  v_mfma_f32_16x16x32_bf16 v[64:67], v[144:147], a[32:35], v[64:67]
  buffer_load_dwordx4 v[140:143], v2, s[8:11], s40 offen offset:1024 sc1
  s_add_u32 s40, s40, 2048
  v_mfma_f32_16x16x32_bf16 v[68:71], v[144:147], a[36:39], v[68:71]
  v_fmaak_f32 v10, v5, v10, 0xc0135761
  v_fmaak_f32 v11, v5, v11, 0xc0135761
  v_mfma_f32_16x16x32_bf16 v[72:75], v[144:147], a[40:43], v[72:75]
  v_mul_f32 v8, v96, v8
  v_mul_f32 v9, v97, v9
  v_mfma_f32_16x16x32_bf16 v[76:79], v[144:147], a[44:47], v[76:79]
  v_mul_f32 v10, v98, v10
  s_waitcnt vmcnt(22)
  v_mfma_f32_16x16x32_bf16 v[80:83], v[148:151], a[32:35], v[80:83]
  buffer_load_dwordx4 v[144:147], v2, s[8:11], s40 offen offset:0 sc1
  v_mul_f32 v11, v99, v11
  v_mfma_f32_16x16x32_bf16 v[84:87], v[148:151], a[36:39], v[84:87]
  v_exp_f32 v8, v8
  v_mfma_f32_16x16x32_bf16 v[88:91], v[148:151], a[40:43], v[88:91]
  v_exp_f32 v9, v9
  v_mfma_f32_16x16x32_bf16 v[92:95], v[148:151], a[44:47], v[92:95]
  v_mul_f32 v12, v96, v112
  s_waitcnt vmcnt(22)
  v_mfma_f32_16x16x32_bf16 v[64:67], v[152:155], a[48:51], v[64:67]
  buffer_load_dwordx4 v[148:151], v2, s[8:11], s40 offen offset:1024 sc1
  s_add_u32 s40, s40, 2048
  v_mfma_f32_16x16x32_bf16 v[68:71], v[152:155], a[52:55], v[68:71]
  v_exp_f32 v10, v10
  v_mfma_f32_16x16x32_bf16 v[72:75], v[152:155], a[56:59], v[72:75]
  v_exp_f32 v11, v11
  v_mfma_f32_16x16x32_bf16 v[76:79], v[152:155], a[60:63], v[76:79]
  v_mul_f32 v13, v97, v113
  s_waitcnt vmcnt(22)
  v_mfma_f32_16x16x32_bf16 v[80:83], v[156:159], a[48:51], v[80:83]
  buffer_load_dwordx4 v[152:155], v2, s[8:11], s40 offen offset:0 sc1
  v_mul_f32 v14, v98, v114
  v_mfma_f32_16x16x32_bf16 v[84:87], v[156:159], a[52:55], v[84:87]
  v_mul_f32 v15, v99, v115
  v_add_f32 v8, 1.0, v8
  v_mfma_f32_16x16x32_bf16 v[88:91], v[156:159], a[56:59], v[88:91]
  v_add_f32 v9, 1.0, v9
  v_add_f32 v10, 1.0, v10
  v_mfma_f32_16x16x32_bf16 v[92:95], v[156:159], a[60:63], v[92:95]
  v_add_f32 v11, 1.0, v11
  s_waitcnt vmcnt(22)
  v_mfma_f32_16x16x32_bf16 v[64:67], v[160:163], a[64:67], v[64:67]
  buffer_load_dwordx4 v[156:159], v2, s[8:11], s40 offen offset:1024 sc1
  s_add_u32 s40, s40, 2048
  v_mfma_f32_16x16x32_bf16 v[68:71], v[160:163], a[68:71], v[68:71]
  v_rcp_f32 v8, v8
  v_mfma_f32_16x16x32_bf16 v[72:75], v[160:163], a[72:75], v[72:75]
  v_rcp_f32 v9, v9
  v_mfma_f32_16x16x32_bf16 v[76:79], v[160:163], a[76:79], v[76:79]
  v_mul_f32 v12, v12, v8
  s_waitcnt vmcnt(22)
  v_mfma_f32_16x16x32_bf16 v[80:83], v[164:167], a[64:67], v[80:83]
  buffer_load_dwordx4 v[160:163], v2, s[8:11], s40 offen offset:0 sc1
  v_mul_f32 v13, v13, v9
  v_mfma_f32_16x16x32_bf16 v[84:87], v[164:167], a[68:71], v[84:87]
  v_rcp_f32 v10, v10
  v_mfma_f32_16x16x32_bf16 v[88:91], v[164:167], a[72:75], v[88:91]
  v_rcp_f32 v11, v11
  v_mfma_f32_16x16x32_bf16 v[92:95], v[164:167], a[76:79], v[92:95]
  v_mul_f32 v14, v14, v10
  s_waitcnt vmcnt(22)
  v_mfma_f32_16x16x32_bf16 v[64:67], v[168:171], a[80:83], v[64:67]
  buffer_load_dwordx4 v[164:167], v2, s[8:11], s40 offen offset:1024 sc1
  s_add_u32 s40, s40, 2048
  v_mfma_f32_16x16x32_bf16 v[68:71], v[168:171], a[84:87], v[68:71]
  v_mul_f32 v15, v15, v11
  v_cvt_pk_bf16_f32 v16, v12, v13
  v_mfma_f32_16x16x32_bf16 v[72:75], v[168:171], a[88:91], v[72:75]
  v_cvt_pk_bf16_f32 v17, v14, v15
  ds_write_b64 v3, v[16:17] offset:0
  v_mfma_f32_16x16x32_bf16 v[76:79], v[168:171], a[92:95], v[76:79]
  v_mul_f32 v8, v100, v100
  s_waitcnt vmcnt(22)
  v_mfma_f32_16x16x32_bf16 v[80:83], v[172:175], a[80:83], v[80:83]
  buffer_load_dwordx4 v[168:171], v2, s[8:11], s40 offen offset:0 sc1
  v_mul_f32 v9, v101, v101
  v_mfma_f32_16x16x32_bf16 v[84:87], v[172:175], a[84:87], v[84:87]
  v_mul_f32 v10, v102, v102
  v_mul_f32 v11, v103, v103
  v_mfma_f32_16x16x32_bf16 v[88:91], v[172:175], a[88:91], v[88:91]
  v_fmaak_f32 v8, v5, v8, 0xc0135761
  v_fmaak_f32 v9, v5, v9, 0xc0135761
  v_mfma_f32_16x16x32_bf16 v[92:95], v[172:175], a[92:95], v[92:95]
  v_fmaak_f32 v10, v5, v10, 0xc0135761
  s_waitcnt vmcnt(22)
  s_cmp_lg_u32 s45, 4
  s_cbranch_scc1 F_skip1
  s_waitcnt vmcnt(29)
  s_barrier
  ds_read_b128 a[96:99], v6 offset:24576
  ds_read_b128 a[100:103], v6 offset:25600
  ds_read_b128 a[104:107], v6 offset:26624
  ds_read_b128 a[108:111], v6 offset:27648
  ds_read_b128 a[112:115], v6 offset:28672
  ds_read_b128 a[116:119], v6 offset:29696
  ds_read_b128 a[120:123], v6 offset:30720
  ds_read_b128 a[124:127], v6 offset:31744
  ds_read_b128 a[128:131], v6 offset:32768
  ds_read_b128 a[132:135], v6 offset:33792
  ds_read_b128 a[136:139], v6 offset:34816
  ds_read_b128 a[140:143], v6 offset:35840
  s_waitcnt lgkmcnt(4)
  ds_read_b128 a[144:147], v6 offset:36864
  ds_read_b128 a[148:151], v6 offset:37888
  ds_read_b128 a[152:155], v6 offset:38912
  ds_read_b128 a[156:159], v6 offset:39936
  ds_read_b128 a[160:163], v6 offset:40960
  ds_read_b128 a[164:167], v6 offset:41984
  ds_read_b128 a[168:171], v6 offset:43008
  ds_read_b128 a[172:175], v6 offset:44032
  s_waitcnt lgkmcnt(4)
  ds_read_b128 a[176:179], v6 offset:45056
  ds_read_b128 a[180:183], v6 offset:46080
  ds_read_b128 a[184:187], v6 offset:47104
  ds_read_b128 a[188:191], v6 offset:48128
  s_waitcnt lgkmcnt(0)
F_skip1:
  v_mfma_f32_16x16x32_bf16 v[64:67], v[176:179], a[96:99], v[64:67]
  buffer_load_dwordx4 v[172:175], v2, s[8:11], s40 offen offset:1024 sc1
  s_add_u32 s40, s40, 2048
  v_mfma_f32_16x16x32_bf16 v[68:71], v[176:179], a[100:103], v[68:71]
  v_fmaak_f32 v11, v5, v11, 0xc0135761
  v_mul_f32 v8, v100, v8
  v_mfma_f32_16x16x32_bf16 v[72:75], v[176:179], a[104:107], v[72:75]
  v_mul_f32 v9, v101, v9
  v_mul_f32 v10, v102, v10
  v_mfma_f32_16x16x32_bf16 v[76:79], v[176:179], a[108:111], v[76:79]
  v_mul_f32 v11, v103, v11
  s_waitcnt vmcnt(22)
  v_mfma_f32_16x16x32_bf16 v[80:83], v[180:183], a[96:99], v[80:83]
  buffer_load_dwordx4 v[176:179], v2, s[8:11], s40 offen offset:0 sc1
  v_mul_f32 v12, v100, v116
  v_mfma_f32_16x16x32_bf16 v[84:87], v[180:183], a[100:103], v[84:87]
  v_exp_f32 v8, v8
  v_mfma_f32_16x16x32_bf16 v[88:91], v[180:183], a[104:107], v[88:91]
  v_exp_f32 v9, v9
  v_mfma_f32_16x16x32_bf16 v[92:95], v[180:183], a[108:111], v[92:95]
  v_mul_f32 v13, v101, v117
  s_waitcnt vmcnt(22)
  v_mfma_f32_16x16x32_bf16 v[64:67], v[184:187], a[112:115], v[64:67]
  buffer_load_dwordx4 v[180:183], v2, s[8:11], s40 offen offset:1024 sc1
  s_add_u32 s40, s40, 2048
  v_mfma_f32_16x16x32_bf16 v[68:71], v[184:187], a[116:119], v[68:71]
  v_exp_f32 v10, v10
  v_mfma_f32_16x16x32_bf16 v[72:75], v[184:187], a[120:123], v[72:75]
  v_exp_f32 v11, v11
  v_mfma_f32_16x16x32_bf16 v[76:79], v[184:187], a[124:127], v[76:79]
  v_mul_f32 v14, v102, v118
  s_waitcnt vmcnt(22)
  v_mfma_f32_16x16x32_bf16 v[80:83], v[188:191], a[112:115], v[80:83]
  buffer_load_dwordx4 v[184:187], v2, s[8:11], s40 offen offset:0 sc1
  v_mul_f32 v15, v103, v119
  v_mfma_f32_16x16x32_bf16 v[84:87], v[188:191], a[116:119], v[84:87]
  v_add_f32 v8, 1.0, v8
  v_add_f32 v9, 1.0, v9
  v_mfma_f32_16x16x32_bf16 v[88:91], v[188:191], a[120:123], v[88:91]
  v_add_f32 v10, 1.0, v10
  v_add_f32 v11, 1.0, v11
  v_mfma_f32_16x16x32_bf16 v[92:95], v[188:191], a[124:127], v[92:95]
  s_waitcnt vmcnt(22)
  v_mfma_f32_16x16x32_bf16 v[64:67], v[192:195], a[128:131], v[64:67]
  buffer_load_dwordx4 v[188:191], v2, s[8:11], s40 offen offset:1024 sc1
  s_add_u32 s40, s40, 2048
  v_mfma_f32_16x16x32_bf16 v[68:71], v[192:195], a[132:135], v[68:71]
  v_rcp_f32 v8, v8
  v_mfma_f32_16x16x32_bf16 v[72:75], v[192:195], a[136:139], v[72:75]
  v_rcp_f32 v9, v9
  v_mfma_f32_16x16x32_bf16 v[76:79], v[192:195], a[140:143], v[76:79]
  v_mul_f32 v12, v12, v8
  s_waitcnt vmcnt(22)
  v_mfma_f32_16x16x32_bf16 v[80:83], v[196:199], a[128:131], v[80:83]
  buffer_load_dwordx4 v[192:195], v2, s[8:11], s40 offen offset:0 sc1
  v_mul_f32 v13, v13, v9
  v_mfma_f32_16x16x32_bf16 v[84:87], v[196:199], a[132:135], v[84:87]
  v_rcp_f32 v10, v10
  v_mfma_f32_16x16x32_bf16 v[88:91], v[196:199], a[136:139], v[88:91]
  v_rcp_f32 v11, v11
  v_mfma_f32_16x16x32_bf16 v[92:95], v[196:199], a[140:143], v[92:95]
  v_mul_f32 v14, v14, v10
  s_waitcnt vmcnt(22)
  v_mfma_f32_16x16x32_bf16 v[64:67], v[200:203], a[144:147], v[64:67]
  buffer_load_dwordx4 v[196:199], v2, s[8:11], s40 offen offset:1024 sc1
  s_add_u32 s40, s40, 2048
  v_mfma_f32_16x16x32_bf16 v[68:71], v[200:203], a[148:151], v[68:71]
  v_mul_f32 v15, v15, v11
  v_cvt_pk_bf16_f32 v18, v12, v13
  v_mfma_f32_16x16x32_bf16 v[72:75], v[200:203], a[152:155], v[72:75]
  v_cvt_pk_bf16_f32 v19, v14, v15
  ds_write_b64 v3, v[18:19] offset:1024
  v_mfma_f32_16x16x32_bf16 v[76:79], v[200:203], a[156:159], v[76:79]
  v_mul_f32 v8, v104, v104
  s_waitcnt vmcnt(22)
  v_mfma_f32_16x16x32_bf16 v[80:83], v[204:207], a[144:147], v[80:83]
  buffer_load_dwordx4 v[200:203], v2, s[8:11], s40 offen offset:0 sc1
  v_mul_f32 v9, v105, v105
  v_mfma_f32_16x16x32_bf16 v[84:87], v[204:207], a[148:151], v[84:87]
  v_mul_f32 v10, v106, v106
  v_mul_f32 v11, v107, v107
  v_mfma_f32_16x16x32_bf16 v[88:91], v[204:207], a[152:155], v[88:91]
  v_fmaak_f32 v8, v5, v8, 0xc0135761
  v_fmaak_f32 v9, v5, v9, 0xc0135761
  v_mfma_f32_16x16x32_bf16 v[92:95], v[204:207], a[156:159], v[92:95]
  v_fmaak_f32 v10, v5, v10, 0xc0135761
  s_waitcnt vmcnt(22)
  v_mfma_f32_16x16x32_bf16 v[64:67], v[208:211], a[160:163], v[64:67]
  buffer_load_dwordx4 v[204:207], v2, s[8:11], s40 offen offset:1024 sc1
  s_add_u32 s40, s40, 2048
  v_mfma_f32_16x16x32_bf16 v[68:71], v[208:211], a[164:167], v[68:71]
  v_fmaak_f32 v11, v5, v11, 0xc0135761
  v_mul_f32 v8, v104, v8
  v_mfma_f32_16x16x32_bf16 v[72:75], v[208:211], a[168:171], v[72:75]
  v_mul_f32 v9, v105, v9
  v_mul_f32 v10, v106, v10
  v_mfma_f32_16x16x32_bf16 v[76:79], v[208:211], a[172:175], v[76:79]
  v_mul_f32 v11, v107, v11
  s_waitcnt vmcnt(22)
  v_mfma_f32_16x16x32_bf16 v[80:83], v[212:215], a[160:163], v[80:83]
  buffer_load_dwordx4 v[208:211], v2, s[8:11], s40 offen offset:0 sc1
  v_mul_f32 v12, v104, v120
  v_mfma_f32_16x16x32_bf16 v[84:87], v[212:215], a[164:167], v[84:87]
  v_exp_f32 v8, v8
  v_mfma_f32_16x16x32_bf16 v[88:91], v[212:215], a[168:171], v[88:91]
  v_exp_f32 v9, v9
  v_mfma_f32_16x16x32_bf16 v[92:95], v[212:215], a[172:175], v[92:95]
  v_mul_f32 v13, v105, v121
  s_waitcnt vmcnt(22)
  v_mfma_f32_16x16x32_bf16 v[64:67], v[216:219], a[176:179], v[64:67]
  buffer_load_dwordx4 v[212:215], v2, s[8:11], s40 offen offset:1024 sc1
  s_add_u32 s40, s40, 2048
  v_mfma_f32_16x16x32_bf16 v[68:71], v[216:219], a[180:183], v[68:71]
  v_exp_f32 v10, v10
  v_mfma_f32_16x16x32_bf16 v[72:75], v[216:219], a[184:187], v[72:75]
  v_exp_f32 v11, v11
  v_mfma_f32_16x16x32_bf16 v[76:79], v[216:219], a[188:191], v[76:79]
  v_mul_f32 v14, v106, v122
  s_waitcnt vmcnt(22)
  v_mfma_f32_16x16x32_bf16 v[80:83], v[220:223], a[176:179], v[80:83]
  buffer_load_dwordx4 v[216:219], v2, s[8:11], s40 offen offset:0 sc1
  v_mul_f32 v15, v107, v123
  v_mfma_f32_16x16x32_bf16 v[84:87], v[220:223], a[180:183], v[84:87]
  v_add_f32 v8, 1.0, v8
  v_add_f32 v9, 1.0, v9
  v_mfma_f32_16x16x32_bf16 v[88:91], v[220:223], a[184:187], v[88:91]
  v_add_f32 v10, 1.0, v10
  v_add_f32 v11, 1.0, v11
  v_mfma_f32_16x16x32_bf16 v[92:95], v[220:223], a[188:191], v[92:95]
  s_waitcnt vmcnt(22)
  s_cmp_lg_u32 s45, 4
  s_cbranch_scc1 F_skip2
  s_waitcnt vmcnt(35)
  s_barrier
  ds_read_b128 a[192:195], v6 offset:49152
  ds_read_b128 a[196:199], v6 offset:50176
  ds_read_b128 a[200:203], v6 offset:51200
  ds_read_b128 a[204:207], v6 offset:52224
  ds_read_b128 a[208:211], v6 offset:53248
  ds_read_b128 a[212:215], v6 offset:54272
  ds_read_b128 a[216:219], v6 offset:55296
  ds_read_b128 a[220:223], v6 offset:56320
  ds_read_b128 a[224:227], v6 offset:57344
  ds_read_b128 a[228:231], v6 offset:58368
  ds_read_b128 a[232:235], v6 offset:59392
  ds_read_b128 a[236:239], v6 offset:60416
  s_waitcnt lgkmcnt(4)
  ds_read_b128 a[240:243], v6 offset:61440
  ds_read_b128 a[244:247], v6 offset:62464
  ds_read_b128 a[248:251], v6 offset:63488
  ds_read_b128 a[252:255], v6 offset:64512
  ds_read_b128 v[224:227], v40 offset:0
  ds_read_b128 v[228:231], v40 offset:1024
  ds_read_b128 v[232:235], v40 offset:2048
  ds_read_b128 v[236:239], v40 offset:3072
  s_waitcnt lgkmcnt(4)
  ds_read_b128 v[240:243], v40 offset:4096
  ds_read_b128 v[244:247], v40 offset:5120
  ds_read_b128 v[248:251], v40 offset:6144
  ds_read_b128 v[252:255], v40 offset:7168
  s_waitcnt lgkmcnt(0)
F_skip2:
  v_mfma_f32_16x16x32_bf16 v[64:67], v[128:131], a[192:195], v[64:67]
  buffer_load_dwordx4 v[220:223], v2, s[8:11], s40 offen offset:1024 sc1
  s_add_u32 s40, s40, 2048
  v_mfma_f32_16x16x32_bf16 v[68:71], v[128:131], a[196:199], v[68:71]
  v_rcp_f32 v8, v8
  v_mfma_f32_16x16x32_bf16 v[72:75], v[128:131], a[200:203], v[72:75]
  v_rcp_f32 v9, v9
  v_mfma_f32_16x16x32_bf16 v[76:79], v[128:131], a[204:207], v[76:79]
  v_mul_f32 v12, v12, v8
  s_waitcnt vmcnt(22)
  v_mfma_f32_16x16x32_bf16 v[80:83], v[132:135], a[192:195], v[80:83]
  buffer_load_dwordx4 v[128:131], v2, s[8:11], s40 offen offset:0 sc1
  v_mul_f32 v13, v13, v9
  v_mfma_f32_16x16x32_bf16 v[84:87], v[132:135], a[196:199], v[84:87]
  v_rcp_f32 v10, v10
  v_mfma_f32_16x16x32_bf16 v[88:91], v[132:135], a[200:203], v[88:91]
  v_rcp_f32 v11, v11
  v_mfma_f32_16x16x32_bf16 v[92:95], v[132:135], a[204:207], v[92:95]
  v_mul_f32 v14, v14, v10
  s_waitcnt vmcnt(22)
  v_mfma_f32_16x16x32_bf16 v[64:67], v[136:139], a[208:211], v[64:67]
  buffer_load_dwordx4 v[132:135], v2, s[8:11], s40 offen offset:1024 sc1
  s_add_u32 s40, s40, 2048
  v_mfma_f32_16x16x32_bf16 v[68:71], v[136:139], a[212:215], v[68:71]
  v_mul_f32 v15, v15, v11
  v_cvt_pk_bf16_f32 v20, v12, v13
  v_mfma_f32_16x16x32_bf16 v[72:75], v[136:139], a[216:219], v[72:75]
  v_cvt_pk_bf16_f32 v21, v14, v15
  ds_write_b64 v3, v[20:21] offset:2048
  v_mfma_f32_16x16x32_bf16 v[76:79], v[136:139], a[220:223], v[76:79]
  v_mul_f32 v8, v108, v108
  s_waitcnt vmcnt(22)
  v_mfma_f32_16x16x32_bf16 v[80:83], v[140:143], a[208:211], v[80:83]
  buffer_load_dwordx4 v[136:139], v2, s[8:11], s40 offen offset:0 sc1
  v_mul_f32 v9, v109, v109
  v_mfma_f32_16x16x32_bf16 v[84:87], v[140:143], a[212:215], v[84:87]
  v_mul_f32 v10, v110, v110
  v_mul_f32 v11, v111, v111
  v_mfma_f32_16x16x32_bf16 v[88:91], v[140:143], a[216:219], v[88:91]
  v_fmaak_f32 v8, v5, v8, 0xc0135761
  v_fmaak_f32 v9, v5, v9, 0xc0135761
  v_mfma_f32_16x16x32_bf16 v[92:95], v[140:143], a[220:223], v[92:95]
  v_fmaak_f32 v10, v5, v10, 0xc0135761
  s_waitcnt vmcnt(22)
  v_mfma_f32_16x16x32_bf16 v[64:67], v[144:147], a[224:227], v[64:67]
  buffer_load_dwordx4 v[140:143], v2, s[8:11], s40 offen offset:1024 sc1
  s_add_u32 s40, s40, 2048
  v_mfma_f32_16x16x32_bf16 v[68:71], v[144:147], a[228:231], v[68:71]
  v_fmaak_f32 v11, v5, v11, 0xc0135761
  v_mul_f32 v8, v108, v8
  v_mfma_f32_16x16x32_bf16 v[72:75], v[144:147], a[232:235], v[72:75]
  v_mul_f32 v9, v109, v9
  v_mul_f32 v10, v110, v10
  v_mfma_f32_16x16x32_bf16 v[76:79], v[144:147], a[236:239], v[76:79]
  v_mul_f32 v11, v111, v11
  s_waitcnt vmcnt(22)
  v_mfma_f32_16x16x32_bf16 v[80:83], v[148:151], a[224:227], v[80:83]
  buffer_load_dwordx4 v[144:147], v2, s[8:11], s40 offen offset:0 sc1
  v_mul_f32 v12, v108, v124
  v_mfma_f32_16x16x32_bf16 v[84:87], v[148:151], a[228:231], v[84:87]
  v_exp_f32 v8, v8
  v_mfma_f32_16x16x32_bf16 v[88:91], v[148:151], a[232:235], v[88:91]
  v_exp_f32 v9, v9
  v_mfma_f32_16x16x32_bf16 v[92:95], v[148:151], a[236:239], v[92:95]
  v_mul_f32 v13, v109, v125
  s_waitcnt vmcnt(22)
  v_mfma_f32_16x16x32_bf16 v[64:67], v[152:155], a[240:243], v[64:67]
  buffer_load_dwordx4 v[148:151], v2, s[8:11], s40 offen offset:1024 sc1
  s_add_u32 s40, s40, 2048
  v_mfma_f32_16x16x32_bf16 v[68:71], v[152:155], a[244:247], v[68:71]
  v_exp_f32 v10, v10
  v_mfma_f32_16x16x32_bf16 v[72:75], v[152:155], a[248:251], v[72:75]
  v_exp_f32 v11, v11
  v_mfma_f32_16x16x32_bf16 v[76:79], v[152:155], a[252:255], v[76:79]
  v_mul_f32 v14, v110, v126
  s_waitcnt vmcnt(22)
  v_mfma_f32_16x16x32_bf16 v[80:83], v[156:159], a[240:243], v[80:83]
  buffer_load_dwordx4 v[152:155], v2, s[8:11], s40 offen offset:0 sc1
  v_mul_f32 v15, v111, v127
  v_mfma_f32_16x16x32_bf16 v[84:87], v[156:159], a[244:247], v[84:87]
  v_add_f32 v8, 1.0, v8
  v_add_f32 v9, 1.0, v9
  v_mfma_f32_16x16x32_bf16 v[88:91], v[156:159], a[248:251], v[88:91]
  v_add_f32 v10, 1.0, v10
  v_add_f32 v11, 1.0, v11
  v_mfma_f32_16x16x32_bf16 v[92:95], v[156:159], a[252:255], v[92:95]
  s_waitcnt vmcnt(22)
  v_mfma_f32_16x16x32_bf16 v[64:67], v[160:163], v[224:227], v[64:67]
  buffer_load_dwordx4 v[156:159], v2, s[8:11], s40 offen offset:1024 sc1
  s_add_u32 s40, s40, 2048
  v_mfma_f32_16x16x32_bf16 v[68:71], v[160:163], v[228:231], v[68:71]
  v_rcp_f32 v8, v8
  v_mfma_f32_16x16x32_bf16 v[72:75], v[160:163], v[232:235], v[72:75]
  v_rcp_f32 v9, v9
  v_mfma_f32_16x16x32_bf16 v[76:79], v[160:163], v[236:239], v[76:79]
  v_mul_f32 v12, v12, v8
  s_waitcnt vmcnt(22)
  v_mfma_f32_16x16x32_bf16 v[80:83], v[164:167], v[224:227], v[80:83]
  buffer_load_dwordx4 v[160:163], v2, s[8:11], s40 offen offset:0 sc1
  v_mul_f32 v13, v13, v9
  v_mfma_f32_16x16x32_bf16 v[84:87], v[164:167], v[228:231], v[84:87]
  v_rcp_f32 v10, v10
  v_mfma_f32_16x16x32_bf16 v[88:91], v[164:167], v[232:235], v[88:91]
  v_rcp_f32 v11, v11
  v_mfma_f32_16x16x32_bf16 v[92:95], v[164:167], v[236:239], v[92:95]
  v_mul_f32 v14, v14, v10
  s_waitcnt vmcnt(22)
  v_mfma_f32_16x16x32_bf16 v[64:67], v[168:171], v[240:243], v[64:67]
  buffer_load_dwordx4 v[164:167], v2, s[8:11], s40 offen offset:1024 sc1
  s_add_u32 s40, s40, 2048
  v_mfma_f32_16x16x32_bf16 v[68:71], v[168:171], v[244:247], v[68:71]
  v_mul_f32 v15, v15, v11
  v_cvt_pk_bf16_f32 v22, v12, v13
  v_mfma_f32_16x16x32_bf16 v[72:75], v[168:171], v[248:251], v[72:75]
  v_cvt_pk_bf16_f32 v23, v14, v15
  ds_write_b64 v3, v[22:23] offset:3072
  v_mfma_f32_16x16x32_bf16 v[76:79], v[168:171], v[252:255], v[76:79]
  s_waitcnt vmcnt(22)
  v_mfma_f32_16x16x32_bf16 v[80:83], v[172:175], v[240:243], v[80:83]
  buffer_load_dwordx4 v[168:171], v2, s[8:11], s40 offen offset:0 sc1
  v_mfma_f32_16x16x32_bf16 v[84:87], v[172:175], v[244:247], v[84:87]
  v_mfma_f32_16x16x32_bf16 v[88:91], v[172:175], v[248:251], v[88:91]
  v_mfma_f32_16x16x32_bf16 v[92:95], v[172:175], v[252:255], v[92:95]
  s_waitcnt vmcnt(22)
  s_waitcnt lgkmcnt(0)
  v_mfma_f32_16x16x32_bf16 v[96:99], v[176:179], a[0:3], 0
  buffer_load_dwordx4 v[172:175], v2, s[8:11], s40 offen offset:1024 sc1
  s_add_u32 s40, s40, 2048
  v_mfma_f32_16x16x32_bf16 v[100:103], v[176:179], a[4:7], 0
  v_mfma_f32_16x16x32_bf16 v[104:107], v[176:179], a[8:11], 0
  v_mfma_f32_16x16x32_bf16 v[108:111], v[176:179], a[12:15], 0
  s_waitcnt vmcnt(22)
  v_mfma_f32_16x16x32_bf16 v[112:115], v[180:183], a[0:3], 0
  buffer_load_dwordx4 v[176:179], v2, s[8:11], s40 offen offset:0 sc1
  v_mfma_f32_16x16x32_bf16 v[116:119], v[180:183], a[4:7], 0
  v_mfma_f32_16x16x32_bf16 v[120:123], v[180:183], a[8:11], 0
  v_mfma_f32_16x16x32_bf16 v[124:127], v[180:183], a[12:15], 0
  s_waitcnt vmcnt(22)
  v_mfma_f32_16x16x32_bf16 v[96:99], v[184:187], a[16:19], v[96:99]
  buffer_load_dwordx4 v[180:183], v2, s[8:11], s40 offen offset:1024 sc1
  s_add_u32 s40, s40, 2048
  v_mfma_f32_16x16x32_bf16 v[100:103], v[184:187], a[20:23], v[100:103]
  s_add_u32 s43, s43, 8192
  v_mfma_f32_16x16x32_bf16 v[104:107], v[184:187], a[24:27], v[104:107]
  s_cmp_eq_u32 s43, 73728
  s_cselect_b32 s43, 0, s43
  v_mfma_f32_16x16x32_bf16 v[108:111], v[184:187], a[28:31], v[108:111]
  v_add_u32 v3, s43, v4
  s_waitcnt vmcnt(22)
  v_mfma_f32_16x16x32_bf16 v[112:115], v[188:191], a[16:19], v[112:115]
  buffer_load_dwordx4 v[184:187], v2, s[8:11], s40 offen offset:0 sc1
  v_mul_f32 v8, v64, v64
  v_mfma_f32_16x16x32_bf16 v[116:119], v[188:191], a[20:23], v[116:119]
  v_mul_f32 v9, v65, v65
  v_mul_f32 v10, v66, v66
  v_mfma_f32_16x16x32_bf16 v[120:123], v[188:191], a[24:27], v[120:123]
  v_mul_f32 v11, v67, v67
  v_fmaak_f32 v8, v5, v8, 0xc0135761
  v_mfma_f32_16x16x32_bf16 v[124:127], v[188:191], a[28:31], v[124:127]
  v_fmaak_f32 v9, v5, v9, 0xc0135761
  s_waitcnt vmcnt(22)
  v_mfma_f32_16x16x32_bf16 v[96:99], v[192:195], a[32:35], v[96:99]
  buffer_load_dwordx4 v[188:191], v2, s[8:11], s40 offen offset:1024 sc1
  s_add_u32 s40, s40, 2048
  v_mfma_f32_16x16x32_bf16 v[100:103], v[192:195], a[36:39], v[100:103]
  v_fmaak_f32 v10, v5, v10, 0xc0135761
  v_fmaak_f32 v11, v5, v11, 0xc0135761
  v_mfma_f32_16x16x32_bf16 v[104:107], v[192:195], a[40:43], v[104:107]
  v_mul_f32 v8, v64, v8
  v_mul_f32 v9, v65, v9
  v_mfma_f32_16x16x32_bf16 v[108:111], v[192:195], a[44:47], v[108:111]
  v_mul_f32 v10, v66, v10
  s_waitcnt vmcnt(22)
  v_mfma_f32_16x16x32_bf16 v[112:115], v[196:199], a[32:35], v[112:115]
  buffer_load_dwordx4 v[192:195], v2, s[8:11], s40 offen offset:0 sc1
  v_mul_f32 v11, v67, v11
  v_mfma_f32_16x16x32_bf16 v[116:119], v[196:199], a[36:39], v[116:119]
  v_exp_f32 v8, v8
  v_mfma_f32_16x16x32_bf16 v[120:123], v[196:199], a[40:43], v[120:123]
  v_exp_f32 v9, v9
  v_mfma_f32_16x16x32_bf16 v[124:127], v[196:199], a[44:47], v[124:127]
  v_mul_f32 v12, v64, v80
  s_waitcnt vmcnt(22)
  v_mfma_f32_16x16x32_bf16 v[96:99], v[200:203], a[48:51], v[96:99]
  buffer_load_dwordx4 v[196:199], v2, s[8:11], s40 offen offset:1024 sc1
  s_add_u32 s40, s40, 2048
  v_mfma_f32_16x16x32_bf16 v[100:103], v[200:203], a[52:55], v[100:103]
  v_exp_f32 v10, v10
  v_mfma_f32_16x16x32_bf16 v[104:107], v[200:203], a[56:59], v[104:107]
  v_exp_f32 v11, v11
  v_mfma_f32_16x16x32_bf16 v[108:111], v[200:203], a[60:63], v[108:111]
  v_mul_f32 v13, v65, v81
  s_waitcnt vmcnt(22)
  v_mfma_f32_16x16x32_bf16 v[112:115], v[204:207], a[48:51], v[112:115]
  buffer_load_dwordx4 v[200:203], v2, s[8:11], s40 offen offset:0 sc1
  v_mul_f32 v14, v66, v82
  v_mfma_f32_16x16x32_bf16 v[116:119], v[204:207], a[52:55], v[116:119]
  v_mul_f32 v15, v67, v83
  v_add_f32 v8, 1.0, v8
  v_mfma_f32_16x16x32_bf16 v[120:123], v[204:207], a[56:59], v[120:123]
  v_add_f32 v9, 1.0, v9
  v_add_f32 v10, 1.0, v10
  v_mfma_f32_16x16x32_bf16 v[124:127], v[204:207], a[60:63], v[124:127]
  v_add_f32 v11, 1.0, v11
  s_waitcnt vmcnt(22)
  v_mfma_f32_16x16x32_bf16 v[96:99], v[208:211], a[64:67], v[96:99]
  buffer_load_dwordx4 v[204:207], v2, s[8:11], s40 offen offset:1024 sc1
  s_add_u32 s40, s40, 2048
  v_mfma_f32_16x16x32_bf16 v[100:103], v[208:211], a[68:71], v[100:103]
  v_rcp_f32 v8, v8
  v_mfma_f32_16x16x32_bf16 v[104:107], v[208:211], a[72:75], v[104:107]
  v_rcp_f32 v9, v9
  v_mfma_f32_16x16x32_bf16 v[108:111], v[208:211], a[76:79], v[108:111]
  v_mul_f32 v12, v12, v8
  s_waitcnt vmcnt(22)
  v_mfma_f32_16x16x32_bf16 v[112:115], v[212:215], a[64:67], v[112:115]
  buffer_load_dwordx4 v[208:211], v2, s[8:11], s40 offen offset:0 sc1
  v_mul_f32 v13, v13, v9
  v_mfma_f32_16x16x32_bf16 v[116:119], v[212:215], a[68:71], v[116:119]
  v_rcp_f32 v10, v10
  v_mfma_f32_16x16x32_bf16 v[120:123], v[212:215], a[72:75], v[120:123]
  v_rcp_f32 v11, v11
  v_mfma_f32_16x16x32_bf16 v[124:127], v[212:215], a[76:79], v[124:127]
  v_mul_f32 v14, v14, v10
  s_waitcnt vmcnt(22)
  v_mfma_f32_16x16x32_bf16 v[96:99], v[216:219], a[80:83], v[96:99]
  buffer_load_dwordx4 v[212:215], v2, s[8:11], s40 offen offset:1024 sc1
  s_add_u32 s40, s40, 2048
  v_mfma_f32_16x16x32_bf16 v[100:103], v[216:219], a[84:87], v[100:103]
  v_mul_f32 v15, v15, v11
  v_cvt_pk_bf16_f32 v16, v12, v13
  v_mfma_f32_16x16x32_bf16 v[104:107], v[216:219], a[88:91], v[104:107]
  v_cvt_pk_bf16_f32 v17, v14, v15
  ds_write_b64 v3, v[16:17] offset:0
  v_mfma_f32_16x16x32_bf16 v[108:111], v[216:219], a[92:95], v[108:111]
  v_mul_f32 v8, v68, v68
  s_waitcnt vmcnt(22)
  v_mfma_f32_16x16x32_bf16 v[112:115], v[220:223], a[80:83], v[112:115]
  buffer_load_dwordx4 v[216:219], v2, s[8:11], s40 offen offset:0 sc1
  v_mul_f32 v9, v69, v69
  v_mfma_f32_16x16x32_bf16 v[116:119], v[220:223], a[84:87], v[116:119]
  v_mul_f32 v10, v70, v70
  v_mul_f32 v11, v71, v71
  v_mfma_f32_16x16x32_bf16 v[120:123], v[220:223], a[88:91], v[120:123]
  v_fmaak_f32 v8, v5, v8, 0xc0135761
  v_fmaak_f32 v9, v5, v9, 0xc0135761
  v_mfma_f32_16x16x32_bf16 v[124:127], v[220:223], a[92:95], v[124:127]
  v_fmaak_f32 v10, v5, v10, 0xc0135761
  s_waitcnt vmcnt(22)
  v_mfma_f32_16x16x32_bf16 v[96:99], v[128:131], a[96:99], v[96:99]
  buffer_load_dwordx4 v[220:223], v2, s[8:11], s40 offen offset:1024 sc1
  s_add_u32 s40, s40, 2048
  v_mfma_f32_16x16x32_bf16 v[100:103], v[128:131], a[100:103], v[100:103]
  v_fmaak_f32 v11, v5, v11, 0xc0135761
  v_mul_f32 v8, v68, v8
  v_mfma_f32_16x16x32_bf16 v[104:107], v[128:131], a[104:107], v[104:107]
  v_mul_f32 v9, v69, v9
  v_mul_f32 v10, v70, v10
  v_mfma_f32_16x16x32_bf16 v[108:111], v[128:131], a[108:111], v[108:111]
  v_mul_f32 v11, v71, v11
  s_waitcnt vmcnt(22)
  v_mfma_f32_16x16x32_bf16 v[112:115], v[132:135], a[96:99], v[112:115]
  buffer_load_dwordx4 v[128:131], v2, s[8:11], s40 offen offset:0 sc1
  v_mul_f32 v12, v68, v84
  v_mfma_f32_16x16x32_bf16 v[116:119], v[132:135], a[100:103], v[116:119]
  v_exp_f32 v8, v8
  v_mfma_f32_16x16x32_bf16 v[120:123], v[132:135], a[104:107], v[120:123]
  v_exp_f32 v9, v9
  v_mfma_f32_16x16x32_bf16 v[124:127], v[132:135], a[108:111], v[124:127]
  v_mul_f32 v13, v69, v85
  s_waitcnt vmcnt(22)
  v_mfma_f32_16x16x32_bf16 v[96:99], v[136:139], a[112:115], v[96:99]
  buffer_load_dwordx4 v[132:135], v2, s[8:11], s40 offen offset:1024 sc1
  s_add_u32 s40, s40, 2048
  v_mfma_f32_16x16x32_bf16 v[100:103], v[136:139], a[116:119], v[100:103]
  v_exp_f32 v10, v10
  v_mfma_f32_16x16x32_bf16 v[104:107], v[136:139], a[120:123], v[104:107]
  v_exp_f32 v11, v11
  v_mfma_f32_16x16x32_bf16 v[108:111], v[136:139], a[124:127], v[108:111]
  v_mul_f32 v14, v70, v86
  s_waitcnt vmcnt(22)
  v_mfma_f32_16x16x32_bf16 v[112:115], v[140:143], a[112:115], v[112:115]
  buffer_load_dwordx4 v[136:139], v2, s[8:11], s40 offen offset:0 sc1
  v_mul_f32 v15, v71, v87
  v_mfma_f32_16x16x32_bf16 v[116:119], v[140:143], a[116:119], v[116:119]
  v_add_f32 v8, 1.0, v8
  v_add_f32 v9, 1.0, v9
  v_mfma_f32_16x16x32_bf16 v[120:123], v[140:143], a[120:123], v[120:123]
  v_add_f32 v10, 1.0, v10
  v_add_f32 v11, 1.0, v11
  v_mfma_f32_16x16x32_bf16 v[124:127], v[140:143], a[124:127], v[124:127]
  s_waitcnt vmcnt(22)
  v_mfma_f32_16x16x32_bf16 v[96:99], v[144:147], a[128:131], v[96:99]
  buffer_load_dwordx4 v[140:143], v2, s[8:11], s40 offen offset:1024 sc1
  s_add_u32 s40, s40, 2048
  v_mfma_f32_16x16x32_bf16 v[100:103], v[144:147], a[132:135], v[100:103]
  v_rcp_f32 v8, v8
  v_mfma_f32_16x16x32_bf16 v[104:107], v[144:147], a[136:139], v[104:107]
  v_rcp_f32 v9, v9
  v_mfma_f32_16x16x32_bf16 v[108:111], v[144:147], a[140:143], v[108:111]
  v_mul_f32 v12, v12, v8
  s_waitcnt vmcnt(22)
  v_mfma_f32_16x16x32_bf16 v[112:115], v[148:151], a[128:131], v[112:115]
  buffer_load_dwordx4 v[144:147], v2, s[8:11], s40 offen offset:0 sc1
  v_mul_f32 v13, v13, v9
  v_mfma_f32_16x16x32_bf16 v[116:119], v[148:151], a[132:135], v[116:119]
  v_rcp_f32 v10, v10
  v_mfma_f32_16x16x32_bf16 v[120:123], v[148:151], a[136:139], v[120:123]
  v_rcp_f32 v11, v11
  v_mfma_f32_16x16x32_bf16 v[124:127], v[148:151], a[140:143], v[124:127]
  v_mul_f32 v14, v14, v10
  s_waitcnt vmcnt(22)
  v_mfma_f32_16x16x32_bf16 v[96:99], v[152:155], a[144:147], v[96:99]
  buffer_load_dwordx4 v[148:151], v2, s[8:11], s40 offen offset:1024 sc1
  s_add_u32 s40, s40, 2048
  v_mfma_f32_16x16x32_bf16 v[100:103], v[152:155], a[148:151], v[100:103]
  v_mul_f32 v15, v15, v11
  v_cvt_pk_bf16_f32 v18, v12, v13
  v_mfma_f32_16x16x32_bf16 v[104:107], v[152:155], a[152:155], v[104:107]
  v_cvt_pk_bf16_f32 v19, v14, v15
  ds_write_b64 v3, v[18:19] offset:1024
  v_mfma_f32_16x16x32_bf16 v[108:111], v[152:155], a[156:159], v[108:111]
  v_mul_f32 v8, v72, v72
  s_waitcnt vmcnt(22)
  v_mfma_f32_16x16x32_bf16 v[112:115], v[156:159], a[144:147], v[112:115]
  buffer_load_dwordx4 v[152:155], v2, s[8:11], s40 offen offset:0 sc1
  v_mul_f32 v9, v73, v73
  v_mfma_f32_16x16x32_bf16 v[116:119], v[156:159], a[148:151], v[116:119]
  v_mul_f32 v10, v74, v74
  v_mul_f32 v11, v75, v75
  v_mfma_f32_16x16x32_bf16 v[120:123], v[156:159], a[152:155], v[120:123]
  v_fmaak_f32 v8, v5, v8, 0xc0135761
  v_fmaak_f32 v9, v5, v9, 0xc0135761
  v_mfma_f32_16x16x32_bf16 v[124:127], v[156:159], a[156:159], v[124:127]
  v_fmaak_f32 v10, v5, v10, 0xc0135761
  s_waitcnt vmcnt(22)
  v_mfma_f32_16x16x32_bf16 v[96:99], v[160:163], a[160:163], v[96:99]
  buffer_load_dwordx4 v[156:159], v2, s[8:11], s40 offen offset:1024 sc1
  s_add_u32 s40, s40, 2048
  v_mfma_f32_16x16x32_bf16 v[100:103], v[160:163], a[164:167], v[100:103]
  v_fmaak_f32 v11, v5, v11, 0xc0135761
  v_mul_f32 v8, v72, v8
  v_mfma_f32_16x16x32_bf16 v[104:107], v[160:163], a[168:171], v[104:107]
  v_mul_f32 v9, v73, v9
  v_mul_f32 v10, v74, v10
  v_mfma_f32_16x16x32_bf16 v[108:111], v[160:163], a[172:175], v[108:111]
  v_mul_f32 v11, v75, v11
  s_waitcnt vmcnt(22)
  v_mfma_f32_16x16x32_bf16 v[112:115], v[164:167], a[160:163], v[112:115]
  buffer_load_dwordx4 v[160:163], v2, s[8:11], s40 offen offset:0 sc1
  v_mul_f32 v12, v72, v88
  v_mfma_f32_16x16x32_bf16 v[116:119], v[164:167], a[164:167], v[116:119]
  v_exp_f32 v8, v8
  v_mfma_f32_16x16x32_bf16 v[120:123], v[164:167], a[168:171], v[120:123]
  v_exp_f32 v9, v9
  v_mfma_f32_16x16x32_bf16 v[124:127], v[164:167], a[172:175], v[124:127]
  v_mul_f32 v13, v73, v89
  s_waitcnt vmcnt(22)
  v_mfma_f32_16x16x32_bf16 v[96:99], v[168:171], a[176:179], v[96:99]
  buffer_load_dwordx4 v[164:167], v2, s[8:11], s40 offen offset:1024 sc1
  s_add_u32 s40, s40, 2048
  v_mfma_f32_16x16x32_bf16 v[100:103], v[168:171], a[180:183], v[100:103]
  v_exp_f32 v10, v10
  v_mfma_f32_16x16x32_bf16 v[104:107], v[168:171], a[184:187], v[104:107]
  v_exp_f32 v11, v11
  v_mfma_f32_16x16x32_bf16 v[108:111], v[168:171], a[188:191], v[108:111]
  v_mul_f32 v14, v74, v90
  s_waitcnt vmcnt(22)
  v_mfma_f32_16x16x32_bf16 v[112:115], v[172:175], a[176:179], v[112:115]
  buffer_load_dwordx4 v[168:171], v2, s[8:11], s40 offen offset:0 sc1
  v_mul_f32 v15, v75, v91
  v_mfma_f32_16x16x32_bf16 v[116:119], v[172:175], a[180:183], v[116:119]
  v_add_f32 v8, 1.0, v8
  v_add_f32 v9, 1.0, v9
  v_mfma_f32_16x16x32_bf16 v[120:123], v[172:175], a[184:187], v[120:123]
  v_add_f32 v10, 1.0, v10
  v_add_f32 v11, 1.0, v11
  v_mfma_f32_16x16x32_bf16 v[124:127], v[172:175], a[188:191], v[124:127]
  s_waitcnt vmcnt(22)
  v_mfma_f32_16x16x32_bf16 v[96:99], v[176:179], a[192:195], v[96:99]
  buffer_load_dwordx4 v[172:175], v2, s[8:11], s40 offen offset:1024 sc1
  s_add_u32 s40, s40, 2048
  v_mfma_f32_16x16x32_bf16 v[100:103], v[176:179], a[196:199], v[100:103]
  v_rcp_f32 v8, v8
  v_mfma_f32_16x16x32_bf16 v[104:107], v[176:179], a[200:203], v[104:107]
  v_rcp_f32 v9, v9
  v_mfma_f32_16x16x32_bf16 v[108:111], v[176:179], a[204:207], v[108:111]
  v_mul_f32 v12, v12, v8
  s_waitcnt vmcnt(22)
  v_mfma_f32_16x16x32_bf16 v[112:115], v[180:183], a[192:195], v[112:115]
  buffer_load_dwordx4 v[176:179], v2, s[8:11], s40 offen offset:0 sc1
  v_mul_f32 v13, v13, v9
  v_mfma_f32_16x16x32_bf16 v[116:119], v[180:183], a[196:199], v[116:119]
  v_rcp_f32 v10, v10
  v_mfma_f32_16x16x32_bf16 v[120:123], v[180:183], a[200:203], v[120:123]
  v_rcp_f32 v11, v11
  v_mfma_f32_16x16x32_bf16 v[124:127], v[180:183], a[204:207], v[124:127]
  v_mul_f32 v14, v14, v10
  s_waitcnt vmcnt(22)
  v_mfma_f32_16x16x32_bf16 v[96:99], v[184:187], a[208:211], v[96:99]
  buffer_load_dwordx4 v[180:183], v2, s[8:11], s40 offen offset:1024 sc1
  s_add_u32 s40, s40, 2048
  v_mfma_f32_16x16x32_bf16 v[100:103], v[184:187], a[212:215], v[100:103]
  v_mul_f32 v15, v15, v11
  v_cvt_pk_bf16_f32 v20, v12, v13
  v_mfma_f32_16x16x32_bf16 v[104:107], v[184:187], a[216:219], v[104:107]
  v_cvt_pk_bf16_f32 v21, v14, v15
  ds_write_b64 v3, v[20:21] offset:2048
  v_mfma_f32_16x16x32_bf16 v[108:111], v[184:187], a[220:223], v[108:111]
  v_mul_f32 v8, v76, v76
  s_waitcnt vmcnt(22)
  v_mfma_f32_16x16x32_bf16 v[112:115], v[188:191], a[208:211], v[112:115]
  buffer_load_dwordx4 v[184:187], v2, s[8:11], s40 offen offset:0 sc1
  v_mul_f32 v9, v77, v77
  v_mfma_f32_16x16x32_bf16 v[116:119], v[188:191], a[212:215], v[116:119]
  v_mul_f32 v10, v78, v78
  v_mul_f32 v11, v79, v79
  v_mfma_f32_16x16x32_bf16 v[120:123], v[188:191], a[216:219], v[120:123]
  v_fmaak_f32 v8, v5, v8, 0xc0135761
  v_fmaak_f32 v9, v5, v9, 0xc0135761
  v_mfma_f32_16x16x32_bf16 v[124:127], v[188:191], a[220:223], v[124:127]
  v_fmaak_f32 v10, v5, v10, 0xc0135761
  s_waitcnt vmcnt(22)
  v_mfma_f32_16x16x32_bf16 v[96:99], v[192:195], a[224:227], v[96:99]
  buffer_load_dwordx4 v[188:191], v2, s[8:11], s40 offen offset:1024 sc1
  s_add_u32 s40, s40, 2048
  v_mfma_f32_16x16x32_bf16 v[100:103], v[192:195], a[228:231], v[100:103]
  v_fmaak_f32 v11, v5, v11, 0xc0135761
  v_mul_f32 v8, v76, v8
  v_mfma_f32_16x16x32_bf16 v[104:107], v[192:195], a[232:235], v[104:107]
  v_mul_f32 v9, v77, v9
  v_mul_f32 v10, v78, v10
  v_mfma_f32_16x16x32_bf16 v[108:111], v[192:195], a[236:239], v[108:111]
  v_mul_f32 v11, v79, v11
  s_waitcnt vmcnt(22)
  v_mfma_f32_16x16x32_bf16 v[112:115], v[196:199], a[224:227], v[112:115]
  buffer_load_dwordx4 v[192:195], v2, s[8:11], s40 offen offset:0 sc1
  v_mul_f32 v12, v76, v92
  v_mfma_f32_16x16x32_bf16 v[116:119], v[196:199], a[228:231], v[116:119]
  v_exp_f32 v8, v8
  v_mfma_f32_16x16x32_bf16 v[120:123], v[196:199], a[232:235], v[120:123]
  v_exp_f32 v9, v9
  v_mfma_f32_16x16x32_bf16 v[124:127], v[196:199], a[236:239], v[124:127]
  v_mul_f32 v13, v77, v93
  s_waitcnt vmcnt(22)
  v_mfma_f32_16x16x32_bf16 v[96:99], v[200:203], a[240:243], v[96:99]
  buffer_load_dwordx4 v[196:199], v2, s[8:11], s40 offen offset:1024 sc1
  s_add_u32 s40, s40, 2048
  v_mfma_f32_16x16x32_bf16 v[100:103], v[200:203], a[244:247], v[100:103]
  v_exp_f32 v10, v10
  v_mfma_f32_16x16x32_bf16 v[104:107], v[200:203], a[248:251], v[104:107]
  v_exp_f32 v11, v11
  v_mfma_f32_16x16x32_bf16 v[108:111], v[200:203], a[252:255], v[108:111]
  v_mul_f32 v14, v78, v94
  s_waitcnt vmcnt(22)
  v_mfma_f32_16x16x32_bf16 v[112:115], v[204:207], a[240:243], v[112:115]
  buffer_load_dwordx4 v[200:203], v2, s[8:11], s40 offen offset:0 sc1
  v_mul_f32 v15, v79, v95
  v_mfma_f32_16x16x32_bf16 v[116:119], v[204:207], a[244:247], v[116:119]
  v_add_f32 v8, 1.0, v8
  v_add_f32 v9, 1.0, v9
  v_mfma_f32_16x16x32_bf16 v[120:123], v[204:207], a[248:251], v[120:123]
  v_add_f32 v10, 1.0, v10
  v_add_f32 v11, 1.0, v11
  v_mfma_f32_16x16x32_bf16 v[124:127], v[204:207], a[252:255], v[124:127]
  s_waitcnt vmcnt(22)
  v_mfma_f32_16x16x32_bf16 v[96:99], v[208:211], v[224:227], v[96:99]
  buffer_load_dwordx4 v[204:207], v2, s[8:11], s40 offen offset:1024 sc1
  s_add_u32 s40, s40, 2048
  v_mfma_f32_16x16x32_bf16 v[100:103], v[208:211], v[228:231], v[100:103]
  v_rcp_f32 v8, v8
  v_mfma_f32_16x16x32_bf16 v[104:107], v[208:211], v[232:235], v[104:107]
  v_rcp_f32 v9, v9
  v_mfma_f32_16x16x32_bf16 v[108:111], v[208:211], v[236:239], v[108:111]
  v_mul_f32 v12, v12, v8
  s_waitcnt vmcnt(22)
  v_mfma_f32_16x16x32_bf16 v[112:115], v[212:215], v[224:227], v[112:115]
  buffer_load_dwordx4 v[208:211], v2, s[8:11], s40 offen offset:0 sc1
  v_mul_f32 v13, v13, v9
  v_mfma_f32_16x16x32_bf16 v[116:119], v[212:215], v[228:231], v[116:119]
  v_rcp_f32 v10, v10
  v_mfma_f32_16x16x32_bf16 v[120:123], v[212:215], v[232:235], v[120:123]
  v_rcp_f32 v11, v11
  v_mfma_f32_16x16x32_bf16 v[124:127], v[212:215], v[236:239], v[124:127]
  v_mul_f32 v14, v14, v10
  s_waitcnt vmcnt(22)
  v_mfma_f32_16x16x32_bf16 v[96:99], v[216:219], v[240:243], v[96:99]
  buffer_load_dwordx4 v[212:215], v2, s[8:11], s40 offen offset:1024 sc1
  s_add_u32 s40, s40, 2048
  v_mfma_f32_16x16x32_bf16 v[100:103], v[216:219], v[244:247], v[100:103]
  v_mul_f32 v15, v15, v11
  v_cvt_pk_bf16_f32 v22, v12, v13
  v_mfma_f32_16x16x32_bf16 v[104:107], v[216:219], v[248:251], v[104:107]
  v_cvt_pk_bf16_f32 v23, v14, v15
  ds_write_b64 v3, v[22:23] offset:3072
  v_mfma_f32_16x16x32_bf16 v[108:111], v[216:219], v[252:255], v[108:111]
  s_waitcnt vmcnt(22)
  v_mfma_f32_16x16x32_bf16 v[112:115], v[220:223], v[240:243], v[112:115]
  buffer_load_dwordx4 v[216:219], v2, s[8:11], s40 offen offset:0 sc1
  v_mfma_f32_16x16x32_bf16 v[116:119], v[220:223], v[244:247], v[116:119]
  v_mfma_f32_16x16x32_bf16 v[120:123], v[220:223], v[248:251], v[120:123]
  v_mfma_f32_16x16x32_bf16 v[124:127], v[220:223], v[252:255], v[124:127]
  s_waitcnt vmcnt(22)
  s_sub_u32 s45, s45, 1
  s_cmp_lg_u32 s45, 0
  s_cbranch_scc1 F_loop
  s_waitcnt lgkmcnt(0)
  s_barrier
  v_mfma_f32_16x16x32_bf16 v[64:67], v[128:131], a[0:3], 0
  buffer_load_dwordx4 v[220:223], v2, s[8:11], s40 offen offset:1024 sc1
  s_add_u32 s40, s40, 2048
  v_mfma_f32_16x16x32_bf16 v[68:71], v[128:131], a[4:7], 0
  v_mfma_f32_16x16x32_bf16 v[72:75], v[128:131], a[8:11], 0
  v_mfma_f32_16x16x32_bf16 v[76:79], v[128:131], a[12:15], 0
  s_waitcnt vmcnt(22)
  v_mfma_f32_16x16x32_bf16 v[80:83], v[132:135], a[0:3], 0
  buffer_load_dwordx4 v[128:131], v2, s[8:11], s40 offen offset:0 sc1
  v_mfma_f32_16x16x32_bf16 v[84:87], v[132:135], a[4:7], 0
  v_mfma_f32_16x16x32_bf16 v[88:91], v[132:135], a[8:11], 0
  v_mfma_f32_16x16x32_bf16 v[92:95], v[132:135], a[12:15], 0
  s_waitcnt vmcnt(22)
  v_mfma_f32_16x16x32_bf16 v[64:67], v[136:139], a[16:19], v[64:67]
  buffer_load_dwordx4 v[132:135], v2, s[8:11], s40 offen offset:1024 sc1
  s_add_u32 s40, s40, 2048
  ds_read_b128 a[0:3], v40 offset:8192
  v_mfma_f32_16x16x32_bf16 v[68:71], v[136:139], a[20:23], v[68:71]
  ds_read_b128 a[4:7], v40 offset:9216
  s_add_u32 s43, s43, 8192
  v_mfma_f32_16x16x32_bf16 v[72:75], v[136:139], a[24:27], v[72:75]
  ds_read_b128 a[8:11], v40 offset:10240
  v_mfma_f32_16x16x32_bf16 v[76:79], v[136:139], a[28:31], v[76:79]
  ds_read_b128 a[12:15], v40 offset:11264
  s_waitcnt vmcnt(22)
  v_mfma_f32_16x16x32_bf16 v[80:83], v[140:143], a[16:19], v[80:83]
  buffer_load_dwordx4 v[136:139], v2, s[8:11], s40 offen offset:0 sc1
  v_mfma_f32_16x16x32_bf16 v[84:87], v[140:143], a[20:23], v[84:87]
  s_cmp_eq_u32 s43, 73728
  s_cselect_b32 s43, 0, s43
  v_mfma_f32_16x16x32_bf16 v[88:91], v[140:143], a[24:27], v[88:91]
  v_add_u32 v3, s43, v4
  v_mul_f32 v8, v96, v96
  v_mfma_f32_16x16x32_bf16 v[92:95], v[140:143], a[28:31], v[92:95]
  v_mul_f32 v9, v97, v97
  s_waitcnt vmcnt(22)
  v_mfma_f32_16x16x32_bf16 v[64:67], v[144:147], a[32:35], v[64:67]
  buffer_load_dwordx4 v[140:143], v2, s[8:11], s40 offen offset:1024 sc1
  s_add_u32 s40, s40, 2048
  ds_read_b128 a[16:19], v40 offset:12288
  v_mfma_f32_16x16x32_bf16 v[68:71], v[144:147], a[36:39], v[68:71]
  ds_read_b128 a[20:23], v40 offset:13312
  v_mul_f32 v10, v98, v98
  v_mfma_f32_16x16x32_bf16 v[72:75], v[144:147], a[40:43], v[72:75]
  ds_read_b128 a[24:27], v40 offset:14336
  v_mul_f32 v11, v99, v99
  v_mfma_f32_16x16x32_bf16 v[76:79], v[144:147], a[44:47], v[76:79]
  ds_read_b128 a[28:31], v40 offset:15360
  s_waitcnt vmcnt(22)
  v_mfma_f32_16x16x32_bf16 v[80:83], v[148:151], a[32:35], v[80:83]
  buffer_load_dwordx4 v[144:147], v2, s[8:11], s40 offen offset:0 sc1
  v_fmaak_f32 v8, v5, v8, 0xc0135761
  v_mfma_f32_16x16x32_bf16 v[84:87], v[148:151], a[36:39], v[84:87]
  v_fmaak_f32 v9, v5, v9, 0xc0135761
  v_fmaak_f32 v10, v5, v10, 0xc0135761
  v_mfma_f32_16x16x32_bf16 v[88:91], v[148:151], a[40:43], v[88:91]
  v_fmaak_f32 v11, v5, v11, 0xc0135761
  v_mul_f32 v8, v96, v8
  v_mfma_f32_16x16x32_bf16 v[92:95], v[148:151], a[44:47], v[92:95]
  v_mul_f32 v9, v97, v9
  s_waitcnt vmcnt(22)
  v_mfma_f32_16x16x32_bf16 v[64:67], v[152:155], a[48:51], v[64:67]
  buffer_load_dwordx4 v[148:151], v2, s[8:11], s40 offen offset:1024 sc1
  s_add_u32 s40, s40, 2048
  ds_read_b128 a[32:35], v40 offset:16384
  v_mfma_f32_16x16x32_bf16 v[68:71], v[152:155], a[52:55], v[68:71]
  ds_read_b128 a[36:39], v40 offset:17408
  v_mul_f32 v10, v98, v10
  v_mfma_f32_16x16x32_bf16 v[72:75], v[152:155], a[56:59], v[72:75]
  ds_read_b128 a[40:43], v40 offset:18432
  v_mul_f32 v11, v99, v11
  v_mfma_f32_16x16x32_bf16 v[76:79], v[152:155], a[60:63], v[76:79]
  ds_read_b128 a[44:47], v40 offset:19456
  s_waitcnt vmcnt(22)
  v_mfma_f32_16x16x32_bf16 v[80:83], v[156:159], a[48:51], v[80:83]
  buffer_load_dwordx4 v[152:155], v2, s[8:11], s40 offen offset:0 sc1
  v_mul_f32 v12, v96, v112
  v_mfma_f32_16x16x32_bf16 v[84:87], v[156:159], a[52:55], v[84:87]
  v_exp_f32 v8, v8
  v_mfma_f32_16x16x32_bf16 v[88:91], v[156:159], a[56:59], v[88:91]
  v_exp_f32 v9, v9
  v_mfma_f32_16x16x32_bf16 v[92:95], v[156:159], a[60:63], v[92:95]
  v_mul_f32 v13, v97, v113
  s_waitcnt vmcnt(22)
  v_mfma_f32_16x16x32_bf16 v[64:67], v[160:163], a[64:67], v[64:67]
  buffer_load_dwordx4 v[156:159], v2, s[8:11], s40 offen offset:1024 sc1
  s_add_u32 s40, s40, 2048
  s_waitcnt lgkmcnt(4)
  ds_read_b128 a[48:51], v40 offset:20480
  v_mfma_f32_16x16x32_bf16 v[68:71], v[160:163], a[68:71], v[68:71]
  ds_read_b128 a[52:55], v40 offset:21504
  v_mul_f32 v14, v98, v114
  v_mfma_f32_16x16x32_bf16 v[72:75], v[160:163], a[72:75], v[72:75]
  ds_read_b128 a[56:59], v40 offset:22528
  v_mul_f32 v15, v99, v115
  v_mfma_f32_16x16x32_bf16 v[76:79], v[160:163], a[76:79], v[76:79]
  ds_read_b128 a[60:63], v40 offset:23552
  s_waitcnt vmcnt(22)
  v_mfma_f32_16x16x32_bf16 v[80:83], v[164:167], a[64:67], v[80:83]
  buffer_load_dwordx4 v[160:163], v2, s[8:11], s40 offen offset:0 sc1
  v_add_f32 v8, 1.0, v8
  v_mfma_f32_16x16x32_bf16 v[84:87], v[164:167], a[68:71], v[84:87]
  v_exp_f32 v10, v10
  v_mfma_f32_16x16x32_bf16 v[88:91], v[164:167], a[72:75], v[88:91]
  v_exp_f32 v11, v11
  v_mfma_f32_16x16x32_bf16 v[92:95], v[164:167], a[76:79], v[92:95]
  v_add_f32 v9, 1.0, v9
  s_waitcnt vmcnt(22)
  v_mfma_f32_16x16x32_bf16 v[64:67], v[168:171], a[80:83], v[64:67]
  buffer_load_dwordx4 v[164:167], v2, s[8:11], s40 offen offset:1024 sc1
  s_add_u32 s40, s40, 2048
  ds_read_b128 a[64:67], v40 offset:24576
  v_mfma_f32_16x16x32_bf16 v[68:71], v[168:171], a[84:87], v[68:71]
  ds_read_b128 a[68:71], v40 offset:25600
  v_add_f32 v10, 1.0, v10
  v_mfma_f32_16x16x32_bf16 v[72:75], v[168:171], a[88:91], v[72:75]
  ds_read_b128 a[72:75], v40 offset:26624
  v_add_f32 v11, 1.0, v11
  v_mfma_f32_16x16x32_bf16 v[76:79], v[168:171], a[92:95], v[76:79]
  ds_read_b128 a[76:79], v40 offset:27648
  s_waitcnt vmcnt(22)
  v_mfma_f32_16x16x32_bf16 v[80:83], v[172:175], a[80:83], v[80:83]
  buffer_load_dwordx4 v[168:171], v2, s[8:11], s40 offen offset:0 sc1
  v_mfma_f32_16x16x32_bf16 v[84:87], v[172:175], a[84:87], v[84:87]
  v_rcp_f32 v8, v8
  v_mfma_f32_16x16x32_bf16 v[88:91], v[172:175], a[88:91], v[88:91]
  v_rcp_f32 v9, v9
  v_mfma_f32_16x16x32_bf16 v[92:95], v[172:175], a[92:95], v[92:95]
  v_mul_f32 v12, v12, v8
  s_waitcnt vmcnt(22)
  v_mfma_f32_16x16x32_bf16 v[64:67], v[176:179], a[96:99], v[64:67]
  buffer_load_dwordx4 v[172:175], v2, s[8:11], s40 offen offset:1024 sc1
  s_add_u32 s40, s40, 2048
  s_waitcnt lgkmcnt(4)
  ds_read_b128 a[80:83], v40 offset:28672
  v_mfma_f32_16x16x32_bf16 v[68:71], v[176:179], a[100:103], v[68:71]
  ds_read_b128 a[84:87], v40 offset:29696
  v_mul_f32 v13, v13, v9
  v_mfma_f32_16x16x32_bf16 v[72:75], v[176:179], a[104:107], v[72:75]
  ds_read_b128 a[88:91], v40 offset:30720
  v_cvt_pk_bf16_f32 v16, v12, v13
  v_mfma_f32_16x16x32_bf16 v[76:79], v[176:179], a[108:111], v[76:79]
  ds_read_b128 a[92:95], v40 offset:31744
  s_waitcnt vmcnt(22)
  v_mfma_f32_16x16x32_bf16 v[80:83], v[180:183], a[96:99], v[80:83]
  s_mov_b32 s40, 479232
  buffer_load_dwordx4 v[176:179], v2, s[8:11], s40 offen offset:0 sc1
  v_mul_f32 v8, v100, v100
  v_mfma_f32_16x16x32_bf16 v[84:87], v[180:183], a[100:103], v[84:87]
  v_rcp_f32 v10, v10
  v_mfma_f32_16x16x32_bf16 v[88:91], v[180:183], a[104:107], v[88:91]
  v_rcp_f32 v11, v11
  v_mfma_f32_16x16x32_bf16 v[92:95], v[180:183], a[108:111], v[92:95]
  v_mul_f32 v14, v14, v10
  s_waitcnt vmcnt(22)
  v_mfma_f32_16x16x32_bf16 v[64:67], v[184:187], a[112:115], v[64:67]
  buffer_load_dwordx4 v[180:183], v2, s[8:11], s40 offen offset:1024 sc1
  s_add_u32 s40, s40, 2048
  ds_read_b128 a[96:99], v40 offset:32768
  v_mfma_f32_16x16x32_bf16 v[68:71], v[184:187], a[116:119], v[68:71]
  ds_read_b128 a[100:103], v40 offset:33792
  v_mul_f32 v15, v15, v11
  v_mfma_f32_16x16x32_bf16 v[72:75], v[184:187], a[120:123], v[72:75]
  ds_read_b128 a[104:107], v40 offset:34816
  v_cvt_pk_bf16_f32 v17, v14, v15
  v_mfma_f32_16x16x32_bf16 v[76:79], v[184:187], a[124:127], v[76:79]
  ds_read_b128 a[108:111], v40 offset:35840
  s_waitcnt vmcnt(22)
  v_mfma_f32_16x16x32_bf16 v[80:83], v[188:191], a[112:115], v[80:83]
  buffer_load_dwordx4 v[184:187], v2, s[8:11], s40 offen offset:0 sc1
  s_waitcnt lgkmcnt(4)
  ds_write_b64 v3, v[16:17] offset:0
  v_mfma_f32_16x16x32_bf16 v[84:87], v[188:191], a[116:119], v[84:87]
  v_mul_f32 v9, v101, v101
  v_mul_f32 v10, v102, v102
  v_mfma_f32_16x16x32_bf16 v[88:91], v[188:191], a[120:123], v[88:91]
  v_mul_f32 v11, v103, v103
  v_fmaak_f32 v8, v5, v8, 0xc0135761
  v_mfma_f32_16x16x32_bf16 v[92:95], v[188:191], a[124:127], v[92:95]
  v_fmaak_f32 v9, v5, v9, 0xc0135761
  s_waitcnt vmcnt(22)
  v_mfma_f32_16x16x32_bf16 v[64:67], v[192:195], a[128:131], v[64:67]
  buffer_load_dwordx4 v[188:191], v2, s[8:11], s40 offen offset:1024 sc1
  s_add_u32 s40, s40, 2048
  ds_read_b128 a[112:115], v40 offset:36864
  v_mfma_f32_16x16x32_bf16 v[68:71], v[192:195], a[132:135], v[68:71]
  ds_read_b128 a[116:119], v40 offset:37888
  v_fmaak_f32 v10, v5, v10, 0xc0135761
  v_mfma_f32_16x16x32_bf16 v[72:75], v[192:195], a[136:139], v[72:75]
  ds_read_b128 a[120:123], v40 offset:38912
  v_fmaak_f32 v11, v5, v11, 0xc0135761
  v_mfma_f32_16x16x32_bf16 v[76:79], v[192:195], a[140:143], v[76:79]
  ds_read_b128 a[124:127], v40 offset:39936
  s_waitcnt vmcnt(22)
  v_mfma_f32_16x16x32_bf16 v[80:83], v[196:199], a[128:131], v[80:83]
  buffer_load_dwordx4 v[192:195], v2, s[8:11], s40 offen offset:0 sc1
  v_mul_f32 v8, v100, v8
  v_mfma_f32_16x16x32_bf16 v[84:87], v[196:199], a[132:135], v[84:87]
  v_mul_f32 v9, v101, v9
  v_mul_f32 v10, v102, v10
  v_mfma_f32_16x16x32_bf16 v[88:91], v[196:199], a[136:139], v[88:91]
  v_mul_f32 v11, v103, v11
  v_mul_f32 v12, v100, v116
  v_mfma_f32_16x16x32_bf16 v[92:95], v[196:199], a[140:143], v[92:95]
  v_mul_f32 v13, v101, v117
  s_waitcnt vmcnt(22)
  v_mfma_f32_16x16x32_bf16 v[64:67], v[200:203], a[144:147], v[64:67]
  buffer_load_dwordx4 v[196:199], v2, s[8:11], s40 offen offset:1024 sc1
  s_add_u32 s40, s40, 2048
  ds_read_b128 a[128:131], v40 offset:40960
  v_mfma_f32_16x16x32_bf16 v[68:71], v[200:203], a[148:151], v[68:71]
  ds_read_b128 a[132:135], v40 offset:41984
  v_mul_f32 v14, v102, v118
  v_mfma_f32_16x16x32_bf16 v[72:75], v[200:203], a[152:155], v[72:75]
  ds_read_b128 a[136:139], v40 offset:43008
  v_mul_f32 v15, v103, v119
  v_mfma_f32_16x16x32_bf16 v[76:79], v[200:203], a[156:159], v[76:79]
  s_waitcnt lgkmcnt(4)
  ds_read_b128 a[140:143], v40 offset:44032
  s_waitcnt vmcnt(22)
  v_mfma_f32_16x16x32_bf16 v[80:83], v[204:207], a[144:147], v[80:83]
  buffer_load_dwordx4 v[200:203], v2, s[8:11], s40 offen offset:0 sc1
  v_mfma_f32_16x16x32_bf16 v[84:87], v[204:207], a[148:151], v[84:87]
  v_exp_f32 v8, v8
  v_mfma_f32_16x16x32_bf16 v[88:91], v[204:207], a[152:155], v[88:91]
  v_exp_f32 v9, v9
  v_mfma_f32_16x16x32_bf16 v[92:95], v[204:207], a[156:159], v[92:95]
  v_add_f32 v8, 1.0, v8
  s_waitcnt vmcnt(22)
  v_mfma_f32_16x16x32_bf16 v[64:67], v[208:211], a[160:163], v[64:67]
  buffer_load_dwordx4 v[204:207], v2, s[8:11], s40 offen offset:1024 sc1
  s_add_u32 s40, s40, 2048
  ds_read_b128 a[144:147], v40 offset:45056
  v_mfma_f32_16x16x32_bf16 v[68:71], v[208:211], a[164:167], v[68:71]
  ds_read_b128 a[148:151], v40 offset:46080
  v_add_f32 v9, 1.0, v9
  v_mfma_f32_16x16x32_bf16 v[72:75], v[208:211], a[168:171], v[72:75]
  ds_read_b128 a[152:155], v40 offset:47104
  v_mfma_f32_16x16x32_bf16 v[76:79], v[208:211], a[172:175], v[76:79]
  ds_read_b128 a[156:159], v40 offset:48128
  s_waitcnt vmcnt(22)
  v_mfma_f32_16x16x32_bf16 v[80:83], v[212:215], a[160:163], v[80:83]
  buffer_load_dwordx4 v[208:211], v2, s[8:11], s40 offen offset:0 sc1
  v_mfma_f32_16x16x32_bf16 v[84:87], v[212:215], a[164:167], v[84:87]
  v_exp_f32 v10, v10
  v_mfma_f32_16x16x32_bf16 v[88:91], v[212:215], a[168:171], v[88:91]
  v_exp_f32 v11, v11
  v_mfma_f32_16x16x32_bf16 v[92:95], v[212:215], a[172:175], v[92:95]
  v_add_f32 v10, 1.0, v10
  s_waitcnt vmcnt(22)
  v_mfma_f32_16x16x32_bf16 v[64:67], v[216:219], a[176:179], v[64:67]
  buffer_load_dwordx4 v[212:215], v2, s[8:11], s40 offen offset:1024 sc1
  s_add_u32 s40, s40, 2048
  ds_read_b128 a[160:163], v40 offset:49152
  v_mfma_f32_16x16x32_bf16 v[68:71], v[216:219], a[180:183], v[68:71]
  ds_read_b128 a[164:167], v40 offset:50176
  v_add_f32 v11, 1.0, v11
  v_mfma_f32_16x16x32_bf16 v[72:75], v[216:219], a[184:187], v[72:75]
  ds_read_b128 a[168:171], v40 offset:51200
  v_mfma_f32_16x16x32_bf16 v[76:79], v[216:219], a[188:191], v[76:79]
  s_waitcnt lgkmcnt(4)
  ds_read_b128 a[172:175], v40 offset:52224
  s_waitcnt vmcnt(22)
  v_mfma_f32_16x16x32_bf16 v[80:83], v[220:223], a[176:179], v[80:83]
  buffer_load_dwordx4 v[216:219], v2, s[8:11], s40 offen offset:0 sc1
  v_mfma_f32_16x16x32_bf16 v[84:87], v[220:223], a[180:183], v[84:87]
  v_rcp_f32 v8, v8
  v_mfma_f32_16x16x32_bf16 v[88:91], v[220:223], a[184:187], v[88:91]
  v_rcp_f32 v9, v9
  v_mfma_f32_16x16x32_bf16 v[92:95], v[220:223], a[188:191], v[92:95]
  v_mul_f32 v12, v12, v8
  s_waitcnt vmcnt(22)
  v_mfma_f32_16x16x32_bf16 v[64:67], v[128:131], a[192:195], v[64:67]
  buffer_load_dwordx4 v[220:223], v2, s[8:11], s40 offen offset:1024 sc1
  s_add_u32 s40, s40, 2048
  ds_read_b128 a[176:179], v40 offset:53248
  v_mfma_f32_16x16x32_bf16 v[68:71], v[128:131], a[196:199], v[68:71]
  ds_read_b128 a[180:183], v40 offset:54272
  v_mul_f32 v13, v13, v9
  v_mfma_f32_16x16x32_bf16 v[72:75], v[128:131], a[200:203], v[72:75]
  ds_read_b128 a[184:187], v40 offset:55296
  v_cvt_pk_bf16_f32 v18, v12, v13
  v_mfma_f32_16x16x32_bf16 v[76:79], v[128:131], a[204:207], v[76:79]
  ds_read_b128 a[188:191], v40 offset:56320
  s_waitcnt vmcnt(22)
  v_mfma_f32_16x16x32_bf16 v[80:83], v[132:135], a[192:195], v[80:83]
  buffer_load_dwordx4 v[128:131], v2, s[8:11], s40 offen offset:0 sc1
  v_mul_f32 v8, v104, v104
  v_mfma_f32_16x16x32_bf16 v[84:87], v[132:135], a[196:199], v[84:87]
  v_rcp_f32 v10, v10
  v_mfma_f32_16x16x32_bf16 v[88:91], v[132:135], a[200:203], v[88:91]
  v_rcp_f32 v11, v11
  v_mfma_f32_16x16x32_bf16 v[92:95], v[132:135], a[204:207], v[92:95]
  v_mul_f32 v14, v14, v10
  s_waitcnt vmcnt(22)
  v_mfma_f32_16x16x32_bf16 v[64:67], v[136:139], a[208:211], v[64:67]
  buffer_load_dwordx4 v[132:135], v2, s[8:11], s40 offen offset:1024 sc1
  s_add_u32 s40, s40, 2048
  ds_read_b128 a[192:195], v40 offset:57344
  v_mfma_f32_16x16x32_bf16 v[68:71], v[136:139], a[212:215], v[68:71]
  ds_read_b128 a[196:199], v40 offset:58368
  v_mul_f32 v15, v15, v11
  v_mfma_f32_16x16x32_bf16 v[72:75], v[136:139], a[216:219], v[72:75]
  ds_read_b128 a[200:203], v40 offset:59392
  v_cvt_pk_bf16_f32 v19, v14, v15
  v_mfma_f32_16x16x32_bf16 v[76:79], v[136:139], a[220:223], v[76:79]
  s_waitcnt lgkmcnt(4)
  ds_read_b128 a[204:207], v40 offset:60416
  s_waitcnt vmcnt(22)
  v_mfma_f32_16x16x32_bf16 v[80:83], v[140:143], a[208:211], v[80:83]
  buffer_load_dwordx4 v[136:139], v2, s[8:11], s40 offen offset:0 sc1
  ds_write_b64 v3, v[18:19] offset:1024
  v_mfma_f32_16x16x32_bf16 v[84:87], v[140:143], a[212:215], v[84:87]
  v_mul_f32 v9, v105, v105
  v_mul_f32 v10, v106, v106
  v_mfma_f32_16x16x32_bf16 v[88:91], v[140:143], a[216:219], v[88:91]
  v_mul_f32 v11, v107, v107
  v_fmaak_f32 v8, v5, v8, 0xc0135761
  v_mfma_f32_16x16x32_bf16 v[92:95], v[140:143], a[220:223], v[92:95]
  v_fmaak_f32 v9, v5, v9, 0xc0135761
  s_waitcnt vmcnt(22)
  v_mfma_f32_16x16x32_bf16 v[64:67], v[144:147], a[224:227], v[64:67]
  buffer_load_dwordx4 v[140:143], v2, s[8:11], s40 offen offset:1024 sc1
  s_add_u32 s40, s40, 2048
  ds_read_b128 a[208:211], v40 offset:61440
  v_mfma_f32_16x16x32_bf16 v[68:71], v[144:147], a[228:231], v[68:71]
  ds_read_b128 a[212:215], v40 offset:62464
  v_fmaak_f32 v10, v5, v10, 0xc0135761
  v_mfma_f32_16x16x32_bf16 v[72:75], v[144:147], a[232:235], v[72:75]
  ds_read_b128 a[216:219], v40 offset:63488
  v_fmaak_f32 v11, v5, v11, 0xc0135761
  v_mfma_f32_16x16x32_bf16 v[76:79], v[144:147], a[236:239], v[76:79]
  ds_read_b128 a[220:223], v40 offset:64512
  s_waitcnt vmcnt(22)
  v_mfma_f32_16x16x32_bf16 v[80:83], v[148:151], a[224:227], v[80:83]
  buffer_load_dwordx4 v[144:147], v2, s[8:11], s40 offen offset:0 sc1
  v_mul_f32 v8, v104, v8
  v_mfma_f32_16x16x32_bf16 v[84:87], v[148:151], a[228:231], v[84:87]
  v_mul_f32 v9, v105, v9
  v_mul_f32 v10, v106, v10
  v_mfma_f32_16x16x32_bf16 v[88:91], v[148:151], a[232:235], v[88:91]
  v_mul_f32 v11, v107, v11
  v_mul_f32 v12, v104, v120
  v_mfma_f32_16x16x32_bf16 v[92:95], v[148:151], a[236:239], v[92:95]
  v_mul_f32 v13, v105, v121
  s_waitcnt vmcnt(22)
  v_mfma_f32_16x16x32_bf16 v[64:67], v[152:155], a[240:243], v[64:67]
  buffer_load_dwordx4 v[148:151], v2, s[8:11], s40 offen offset:1024 sc1
  s_add_u32 s40, s40, 2048
  v_mfma_f32_16x16x32_bf16 v[68:71], v[152:155], a[244:247], v[68:71]
  v_exp_f32 v8, v8
  v_mfma_f32_16x16x32_bf16 v[72:75], v[152:155], a[248:251], v[72:75]
  v_exp_f32 v9, v9
  v_mfma_f32_16x16x32_bf16 v[76:79], v[152:155], a[252:255], v[76:79]
  v_mul_f32 v14, v106, v122
  s_waitcnt vmcnt(22)
  v_mfma_f32_16x16x32_bf16 v[80:83], v[156:159], a[240:243], v[80:83]
  s_add_u32 s65, s28, 1
  s_and_b32 s65, s65, 7
  s_mul_i32 s65, s65, 18432
  s_add_u32 s40, s65, 331776
  buffer_load_dwordx4 v[152:155], v2, s[8:11], s40 offen offset:0 sc1
  v_mul_f32 v15, v107, v123
  v_mfma_f32_16x16x32_bf16 v[84:87], v[156:159], a[244:247], v[84:87]
  v_exp_f32 v10, v10
  v_mfma_f32_16x16x32_bf16 v[88:91], v[156:159], a[248:251], v[88:91]
  v_exp_f32 v11, v11
  v_mfma_f32_16x16x32_bf16 v[92:95], v[156:159], a[252:255], v[92:95]
  v_add_f32 v8, 1.0, v8
  s_waitcnt vmcnt(22)
  v_mfma_f32_16x16x32_bf16 v[64:67], v[160:163], v[224:227], v[64:67]
  buffer_load_dwordx4 v[156:159], v2, s[8:11], s40 offen offset:1024 sc1
  s_add_u32 s40, s40, 2048
  v_mfma_f32_16x16x32_bf16 v[68:71], v[160:163], v[228:231], v[68:71]
  v_add_f32 v9, 1.0, v9
  v_add_f32 v10, 1.0, v10
  v_mfma_f32_16x16x32_bf16 v[72:75], v[160:163], v[232:235], v[72:75]
  v_add_f32 v11, 1.0, v11
  v_mfma_f32_16x16x32_bf16 v[76:79], v[160:163], v[236:239], v[76:79]
  s_waitcnt vmcnt(22)
  v_mfma_f32_16x16x32_bf16 v[80:83], v[164:167], v[224:227], v[80:83]
  buffer_load_dwordx4 v[160:163], v2, s[8:11], s40 offen offset:0 sc1
  v_mfma_f32_16x16x32_bf16 v[84:87], v[164:167], v[228:231], v[84:87]
  v_rcp_f32 v8, v8
  v_mfma_f32_16x16x32_bf16 v[88:91], v[164:167], v[232:235], v[88:91]
  v_rcp_f32 v9, v9
  v_mfma_f32_16x16x32_bf16 v[92:95], v[164:167], v[236:239], v[92:95]
  v_mul_f32 v12, v12, v8
  s_waitcnt vmcnt(22)
  v_mfma_f32_16x16x32_bf16 v[64:67], v[168:171], v[240:243], v[64:67]
  buffer_load_dwordx4 v[164:167], v2, s[8:11], s40 offen offset:1024 sc1
  s_add_u32 s40, s40, 2048
  v_mfma_f32_16x16x32_bf16 v[68:71], v[168:171], v[244:247], v[68:71]
  v_rcp_f32 v10, v10
  v_mfma_f32_16x16x32_bf16 v[72:75], v[168:171], v[248:251], v[72:75]
  v_rcp_f32 v11, v11
  v_mfma_f32_16x16x32_bf16 v[76:79], v[168:171], v[252:255], v[76:79]
  v_mul_f32 v13, v13, v9
  s_waitcnt vmcnt(22)
  v_mfma_f32_16x16x32_bf16 v[80:83], v[172:175], v[240:243], v[80:83]
  buffer_load_dwordx4 v[168:171], v2, s[8:11], s40 offen offset:0 sc1
  v_mul_f32 v14, v14, v10
  v_mfma_f32_16x16x32_bf16 v[84:87], v[172:175], v[244:247], v[84:87]
  v_mul_f32 v15, v15, v11
  v_cvt_pk_bf16_f32 v20, v12, v13
  v_mfma_f32_16x16x32_bf16 v[88:91], v[172:175], v[248:251], v[88:91]
  v_cvt_pk_bf16_f32 v21, v14, v15
  ds_write_b64 v3, v[20:21] offset:2048
  v_mfma_f32_16x16x32_bf16 v[92:95], v[172:175], v[252:255], v[92:95]
  v_mul_f32 v8, v108, v108
  s_waitcnt vmcnt(22)
  v_mul_f32 v9, v109, v109
  v_mul_f32 v10, v110, v110
  v_mul_f32 v11, v111, v111
  v_fmaak_f32 v8, v5, v8, 0xc0135761
  v_fmaak_f32 v9, v5, v9, 0xc0135761
  v_fmaak_f32 v10, v5, v10, 0xc0135761
  v_fmaak_f32 v11, v5, v11, 0xc0135761
  v_mul_f32 v8, v108, v8
  v_mul_f32 v9, v109, v9
  v_mul_f32 v10, v110, v10
  v_mul_f32 v11, v111, v11
  v_exp_f32 v8, v8
  v_exp_f32 v9, v9
  v_exp_f32 v10, v10
  v_exp_f32 v11, v11
  v_mul_f32 v12, v108, v124
  v_mul_f32 v13, v109, v125
  v_mul_f32 v14, v110, v126
  v_mul_f32 v15, v111, v127
  v_add_f32 v8, 1.0, v8
  v_add_f32 v9, 1.0, v9
  v_add_f32 v10, 1.0, v10
  v_add_f32 v11, 1.0, v11
  v_rcp_f32 v8, v8
  v_rcp_f32 v9, v9
  v_rcp_f32 v10, v10
  v_rcp_f32 v11, v11
  v_mul_f32 v12, v12, v8
  v_mul_f32 v13, v13, v9
  v_mul_f32 v14, v14, v10
  v_mul_f32 v15, v15, v11
  v_cvt_pk_bf16_f32 v22, v12, v13
  v_cvt_pk_bf16_f32 v23, v14, v15
  ds_write_b64 v3, v[22:23] offset:3072
  s_add_u32 s20, s26, 7143424
  s_addc_u32 s21, s27, 0
  s_mov_b32 s22, 2359296
  s_mov_b32 s23, 0x20000
  s_mov_b32 s45, 65536
  s_waitcnt lgkmcnt(0)
  s_barrier
  ds_read_b128 a[224:227], v41 offset:0
  ds_read_b128 a[228:231], v41 offset:1024
  ds_read_b128 a[232:235], v41 offset:2048
  ds_read_b128 a[236:239], v41 offset:3072
  ds_read_b128 a[240:243], v41 offset:4096
  ds_read_b128 a[244:247], v41 offset:5120
  ds_read_b128 a[248:251], v41 offset:6144
  ds_read_b128 a[252:255], v41 offset:7168
  s_add_u32 s43, s43, 8192
  v_add_u32 v3, s43, v4
  v_mfma_f32_16x16x32_bf16 v[96:99], v[176:179], a[0:3], 0
  buffer_load_dwordx4 v[172:175], v2, s[8:11], s40 offen offset:1024 sc1
  s_add_u32 s40, s40, 2048
  v_mfma_f32_16x16x32_bf16 v[100:103], v[176:179], a[4:7], 0
  v_mfma_f32_16x16x32_bf16 v[104:107], v[176:179], a[8:11], 0
  v_mfma_f32_16x16x32_bf16 v[108:111], v[176:179], a[12:15], 0
  s_waitcnt vmcnt(22)
  v_mfma_f32_16x16x32_bf16 v[96:99], v[180:183], a[16:19], v[96:99]
  buffer_load_dwordx4 v[176:179], v2, s[8:11], s40 offen offset:0 sc1
  v_mul_f32 v8, v64, v64
  v_mfma_f32_16x16x32_bf16 v[100:103], v[180:183], a[20:23], v[100:103]
  v_mul_f32 v9, v65, v65
  v_mul_f32 v10, v66, v66
  v_mfma_f32_16x16x32_bf16 v[104:107], v[180:183], a[24:27], v[104:107]
  v_mul_f32 v11, v67, v67
  v_fmaak_f32 v8, v5, v8, 0xc0135761
  v_mfma_f32_16x16x32_bf16 v[108:111], v[180:183], a[28:31], v[108:111]
  v_fmaak_f32 v9, v5, v9, 0xc0135761
  s_waitcnt vmcnt(22)
  v_mfma_f32_16x16x32_bf16 v[96:99], v[184:187], a[32:35], v[96:99]
  buffer_load_dwordx4 v[180:183], v2, s[8:11], s40 offen offset:1024 sc1
  s_add_u32 s40, s40, 2048
  v_mfma_f32_16x16x32_bf16 v[100:103], v[184:187], a[36:39], v[100:103]
  v_fmaak_f32 v10, v5, v10, 0xc0135761
  v_fmaak_f32 v11, v5, v11, 0xc0135761
  v_mfma_f32_16x16x32_bf16 v[104:107], v[184:187], a[40:43], v[104:107]
  v_mul_f32 v8, v64, v8
  v_mul_f32 v9, v65, v9
  v_mfma_f32_16x16x32_bf16 v[108:111], v[184:187], a[44:47], v[108:111]
  v_mul_f32 v10, v66, v10
  s_waitcnt vmcnt(22)
  v_mfma_f32_16x16x32_bf16 v[96:99], v[188:191], a[48:51], v[96:99]
  buffer_load_dwordx4 v[184:187], v2, s[8:11], s40 offen offset:0 sc1
  v_mul_f32 v11, v67, v11
  v_mfma_f32_16x16x32_bf16 v[100:103], v[188:191], a[52:55], v[100:103]
  v_exp_f32 v8, v8
  v_mfma_f32_16x16x32_bf16 v[104:107], v[188:191], a[56:59], v[104:107]
  v_exp_f32 v9, v9
  v_mfma_f32_16x16x32_bf16 v[108:111], v[188:191], a[60:63], v[108:111]
  v_mul_f32 v12, v64, v80
  s_waitcnt vmcnt(22)
  v_mfma_f32_16x16x32_bf16 v[96:99], v[192:195], a[64:67], v[96:99]
  buffer_load_dwordx4 v[188:191], v2, s[8:11], s40 offen offset:1024 sc1
  s_add_u32 s40, s40, 2048
  v_mfma_f32_16x16x32_bf16 v[100:103], v[192:195], a[68:71], v[100:103]
  v_exp_f32 v10, v10
  v_mfma_f32_16x16x32_bf16 v[104:107], v[192:195], a[72:75], v[104:107]
  v_exp_f32 v11, v11
  v_mfma_f32_16x16x32_bf16 v[108:111], v[192:195], a[76:79], v[108:111]
  v_mul_f32 v13, v65, v81
  s_waitcnt vmcnt(22)
  v_mfma_f32_16x16x32_bf16 v[96:99], v[196:199], a[80:83], v[96:99]
  buffer_load_dwordx4 v[192:195], v2, s[8:11], s40 offen offset:0 sc1
  v_mul_f32 v14, v66, v82
  v_mfma_f32_16x16x32_bf16 v[100:103], v[196:199], a[84:87], v[100:103]
  v_mul_f32 v15, v67, v83
  v_add_f32 v8, 1.0, v8
  v_mfma_f32_16x16x32_bf16 v[104:107], v[196:199], a[88:91], v[104:107]
  v_add_f32 v9, 1.0, v9
  v_add_f32 v10, 1.0, v10
  v_mfma_f32_16x16x32_bf16 v[108:111], v[196:199], a[92:95], v[108:111]
  v_add_f32 v11, 1.0, v11
  s_waitcnt vmcnt(22)
  v_mfma_f32_16x16x32_bf16 v[96:99], v[200:203], a[96:99], v[96:99]
  buffer_load_dwordx4 v[196:199], v2, s[8:11], s40 offen offset:1024 sc1
  s_add_u32 s40, s40, 2048
  v_mfma_f32_16x16x32_bf16 v[100:103], v[200:203], a[100:103], v[100:103]
  v_rcp_f32 v8, v8
  v_mfma_f32_16x16x32_bf16 v[104:107], v[200:203], a[104:107], v[104:107]
  v_rcp_f32 v9, v9
  v_mfma_f32_16x16x32_bf16 v[108:111], v[200:203], a[108:111], v[108:111]
  v_mul_f32 v12, v12, v8
  s_waitcnt vmcnt(22)
  v_mfma_f32_16x16x32_bf16 v[96:99], v[204:207], a[112:115], v[96:99]
  buffer_load_dwordx4 v[200:203], v2, s[8:11], s40 offen offset:0 sc1
  v_mul_f32 v13, v13, v9
  v_mfma_f32_16x16x32_bf16 v[100:103], v[204:207], a[116:119], v[100:103]
  v_rcp_f32 v10, v10
  v_mfma_f32_16x16x32_bf16 v[104:107], v[204:207], a[120:123], v[104:107]
  v_rcp_f32 v11, v11
  v_mfma_f32_16x16x32_bf16 v[108:111], v[204:207], a[124:127], v[108:111]
  v_mul_f32 v14, v14, v10
  s_waitcnt vmcnt(22)
  v_mfma_f32_16x16x32_bf16 v[96:99], v[208:211], a[128:131], v[96:99]
  buffer_load_dwordx4 v[204:207], v2, s[8:11], s40 offen offset:1024 sc1
  s_add_u32 s40, s40, 2048
  v_mfma_f32_16x16x32_bf16 v[100:103], v[208:211], a[132:135], v[100:103]
  v_mul_f32 v15, v15, v11
  v_cvt_pk_bf16_f32 v16, v12, v13
  v_mfma_f32_16x16x32_bf16 v[104:107], v[208:211], a[136:139], v[104:107]
  v_cvt_pk_bf16_f32 v17, v14, v15
  ds_write_b64 v3, v[16:17] offset:0
  v_mfma_f32_16x16x32_bf16 v[108:111], v[208:211], a[140:143], v[108:111]
  v_mul_f32 v8, v68, v68
  s_waitcnt vmcnt(22)
  v_mfma_f32_16x16x32_bf16 v[96:99], v[212:215], a[144:147], v[96:99]
  buffer_load_dwordx4 v[208:211], v2, s[8:11], s40 offen offset:0 sc1
  v_mul_f32 v9, v69, v69
  v_mfma_f32_16x16x32_bf16 v[100:103], v[212:215], a[148:151], v[100:103]
  v_mul_f32 v10, v70, v70
  v_mul_f32 v11, v71, v71
  v_mfma_f32_16x16x32_bf16 v[104:107], v[212:215], a[152:155], v[104:107]
  v_fmaak_f32 v8, v5, v8, 0xc0135761
  v_fmaak_f32 v9, v5, v9, 0xc0135761
  v_mfma_f32_16x16x32_bf16 v[108:111], v[212:215], a[156:159], v[108:111]
  v_fmaak_f32 v10, v5, v10, 0xc0135761
  s_waitcnt vmcnt(22)
  v_mfma_f32_16x16x32_bf16 v[96:99], v[216:219], a[160:163], v[96:99]
  buffer_load_dwordx4 v[212:215], v2, s[8:11], s40 offen offset:1024 sc1
  s_add_u32 s40, s40, 2048
  v_mfma_f32_16x16x32_bf16 v[100:103], v[216:219], a[164:167], v[100:103]
  v_fmaak_f32 v11, v5, v11, 0xc0135761
  v_mul_f32 v8, v68, v8
  v_mfma_f32_16x16x32_bf16 v[104:107], v[216:219], a[168:171], v[104:107]
  v_mul_f32 v9, v69, v9
  v_mul_f32 v10, v70, v10
  v_mfma_f32_16x16x32_bf16 v[108:111], v[216:219], a[172:175], v[108:111]
  v_mul_f32 v11, v71, v11
  s_waitcnt vmcnt(22)
  v_mfma_f32_16x16x32_bf16 v[96:99], v[220:223], a[176:179], v[96:99]
  buffer_load_dwordx4 v[216:219], v2, s[8:11], s40 offen offset:0 sc1
  v_mul_f32 v12, v68, v84
  v_mfma_f32_16x16x32_bf16 v[100:103], v[220:223], a[180:183], v[100:103]
  v_exp_f32 v8, v8
  v_mfma_f32_16x16x32_bf16 v[104:107], v[220:223], a[184:187], v[104:107]
  v_exp_f32 v9, v9
  v_mfma_f32_16x16x32_bf16 v[108:111], v[220:223], a[188:191], v[108:111]
  v_mul_f32 v13, v69, v85
  s_waitcnt vmcnt(22)
  v_mfma_f32_16x16x32_bf16 v[96:99], v[128:131], a[192:195], v[96:99]
  buffer_load_dwordx4 v[220:223], v2, s[8:11], s40 offen offset:1024 sc1
  s_add_u32 s40, s40, 2048
  v_mfma_f32_16x16x32_bf16 v[100:103], v[128:131], a[196:199], v[100:103]
  v_exp_f32 v10, v10
  v_mfma_f32_16x16x32_bf16 v[104:107], v[128:131], a[200:203], v[104:107]
  v_exp_f32 v11, v11
  v_mfma_f32_16x16x32_bf16 v[108:111], v[128:131], a[204:207], v[108:111]
  v_mul_f32 v14, v70, v86
  s_waitcnt vmcnt(22)
  v_mfma_f32_16x16x32_bf16 v[96:99], v[132:135], a[208:211], v[96:99]
  s_add_u32 s65, s28, 2
  s_and_b32 s65, s65, 7
  s_mul_i32 s65, s65, 18432
  s_add_u32 s40, s65, 331776
  buffer_load_dwordx4 v[128:131], v2, s[8:11], s40 offen offset:0 sc1
  v_mul_f32 v15, v71, v87
  v_mfma_f32_16x16x32_bf16 v[100:103], v[132:135], a[212:215], v[100:103]
  v_add_f32 v8, 1.0, v8
  v_add_f32 v9, 1.0, v9
  v_mfma_f32_16x16x32_bf16 v[104:107], v[132:135], a[216:219], v[104:107]
  v_add_f32 v10, 1.0, v10
  v_add_f32 v11, 1.0, v11
  v_mfma_f32_16x16x32_bf16 v[108:111], v[132:135], a[220:223], v[108:111]
  s_waitcnt vmcnt(22)
  s_waitcnt lgkmcnt(0)
  v_mfma_f32_16x16x32_bf16 v[96:99], v[136:139], a[224:227], v[96:99]
  buffer_load_dwordx4 v[132:135], v2, s[8:11], s40 offen offset:1024 sc1
  s_add_u32 s40, s40, 2048
  v_mfma_f32_16x16x32_bf16 v[100:103], v[136:139], a[228:231], v[100:103]
  v_rcp_f32 v8, v8
  v_mfma_f32_16x16x32_bf16 v[104:107], v[136:139], a[232:235], v[104:107]
  v_rcp_f32 v9, v9
  v_mfma_f32_16x16x32_bf16 v[108:111], v[136:139], a[236:239], v[108:111]
  v_mul_f32 v12, v12, v8
  s_waitcnt vmcnt(22)
  v_mfma_f32_16x16x32_bf16 v[96:99], v[140:143], a[240:243], v[96:99]
  buffer_load_dwordx4 v[136:139], v2, s[8:11], s40 offen offset:0 sc1
  v_mul_f32 v13, v13, v9
  v_mfma_f32_16x16x32_bf16 v[100:103], v[140:143], a[244:247], v[100:103]
  v_rcp_f32 v10, v10
  v_mfma_f32_16x16x32_bf16 v[104:107], v[140:143], a[248:251], v[104:107]
  v_rcp_f32 v11, v11
  v_mfma_f32_16x16x32_bf16 v[108:111], v[140:143], a[252:255], v[108:111]
  v_mul_f32 v14, v14, v10
  s_waitcnt vmcnt(22)
  v_mul_f32 v15, v15, v11
  v_cvt_pk_bf16_f32 v18, v12, v13
  v_cvt_pk_bf16_f32 v19, v14, v15
  ds_write_b64 v3, v[18:19] offset:1024
  v_mul_f32 v8, v72, v72
  v_mul_f32 v9, v73, v73
  v_mul_f32 v10, v74, v74
  v_mul_f32 v11, v75, v75
  v_fmaak_f32 v8, v5, v8, 0xc0135761
  v_fmaak_f32 v9, v5, v9, 0xc0135761
  v_fmaak_f32 v10, v5, v10, 0xc0135761
  v_fmaak_f32 v11, v5, v11, 0xc0135761
  v_mul_f32 v8, v72, v8
  v_mul_f32 v9, v73, v9
  v_mul_f32 v10, v74, v10
  v_mul_f32 v11, v75, v11
  v_exp_f32 v8, v8
  v_exp_f32 v9, v9
  v_exp_f32 v10, v10
  v_exp_f32 v11, v11
  v_mul_f32 v12, v72, v88
  v_mul_f32 v13, v73, v89
  v_mul_f32 v14, v74, v90
  v_mul_f32 v15, v75, v91
  v_add_f32 v8, 1.0, v8
  v_add_f32 v9, 1.0, v9
  v_add_f32 v10, 1.0, v10
  v_add_f32 v11, 1.0, v11
  v_rcp_f32 v8, v8
  v_rcp_f32 v9, v9
  v_rcp_f32 v10, v10
  v_rcp_f32 v11, v11
  v_mul_f32 v12, v12, v8
  v_mul_f32 v13, v13, v9
  v_mul_f32 v14, v14, v10
  v_mul_f32 v15, v15, v11
  v_cvt_pk_bf16_f32 v20, v12, v13
  v_cvt_pk_bf16_f32 v21, v14, v15
  ds_write_b64 v3, v[20:21] offset:2048
  v_mul_f32 v8, v76, v76
  v_mul_f32 v9, v77, v77
  v_mul_f32 v10, v78, v78
  v_mul_f32 v11, v79, v79
  v_fmaak_f32 v8, v5, v8, 0xc0135761
  v_fmaak_f32 v9, v5, v9, 0xc0135761
  v_fmaak_f32 v10, v5, v10, 0xc0135761
  v_fmaak_f32 v11, v5, v11, 0xc0135761
  v_mul_f32 v8, v76, v8
  v_mul_f32 v9, v77, v9
  v_mul_f32 v10, v78, v10
  v_mul_f32 v11, v79, v11
  v_exp_f32 v8, v8
  v_exp_f32 v9, v9
  v_exp_f32 v10, v10
  v_exp_f32 v11, v11
  v_mul_f32 v12, v76, v92
  v_mul_f32 v13, v77, v93
  v_mul_f32 v14, v78, v94
  v_mul_f32 v15, v79, v95
  v_add_f32 v8, 1.0, v8
  v_add_f32 v9, 1.0, v9
  v_add_f32 v10, 1.0, v10
  v_add_f32 v11, 1.0, v11
  v_rcp_f32 v8, v8
  v_rcp_f32 v9, v9
  v_rcp_f32 v10, v10
  v_rcp_f32 v11, v11
  v_mul_f32 v12, v12, v8
  v_mul_f32 v13, v13, v9
  v_mul_f32 v14, v14, v10
  v_mul_f32 v15, v15, v11
  v_cvt_pk_bf16_f32 v22, v12, v13
  v_cvt_pk_bf16_f32 v23, v14, v15
  ds_write_b64 v3, v[22:23] offset:3072
  s_waitcnt lgkmcnt(0)
  s_barrier
  ds_read_b128 v[224:227], v41 offset:8192
  ds_read_b128 v[228:231], v41 offset:9216
  ds_read_b128 v[232:235], v41 offset:10240
  ds_read_b128 v[236:239], v41 offset:11264
  ds_read_b128 v[240:243], v41 offset:12288
  ds_read_b128 v[244:247], v41 offset:13312
  ds_read_b128 v[248:251], v41 offset:14336
  ds_read_b128 v[252:255], v41 offset:15360
  s_waitcnt lgkmcnt(0)
  v_mfma_f32_16x16x32_bf16 v[96:99], v[144:147], v[224:227], v[96:99]
  buffer_load_dwordx4 v[140:143], v2, s[8:11], s40 offen offset:1024 sc1
  s_add_u32 s40, s40, 2048
  v_mfma_f32_16x16x32_bf16 v[100:103], v[144:147], v[228:231], v[100:103]
  v_mfma_f32_16x16x32_bf16 v[104:107], v[144:147], v[232:235], v[104:107]
  v_mfma_f32_16x16x32_bf16 v[108:111], v[144:147], v[236:239], v[108:111]
  s_waitcnt vmcnt(22)
  v_mfma_f32_16x16x32_bf16 v[96:99], v[148:151], v[240:243], v[96:99]
  buffer_load_dwordx4 v[144:147], v2, s[8:11], s40 offen offset:0 sc1
  v_mfma_f32_16x16x32_bf16 v[100:103], v[148:151], v[244:247], v[100:103]
  v_mfma_f32_16x16x32_bf16 v[104:107], v[148:151], v[248:251], v[104:107]
  v_mfma_f32_16x16x32_bf16 v[108:111], v[148:151], v[252:255], v[108:111]
  s_waitcnt vmcnt(22)
  v_mfma_f32_16x16x32_bf16 v[112:115], v[152:155], a[0:3], 0
  buffer_load_dwordx4 v[148:151], v2, s[8:11], s40 offen offset:1024 sc1
  s_add_u32 s40, s40, 2048
  v_mfma_f32_16x16x32_bf16 v[116:119], v[152:155], a[4:7], 0
  v_mfma_f32_16x16x32_bf16 v[120:123], v[152:155], a[8:11], 0
  v_mfma_f32_16x16x32_bf16 v[124:127], v[152:155], a[12:15], 0
  s_waitcnt vmcnt(22)
  v_mfma_f32_16x16x32_bf16 v[112:115], v[156:159], a[16:19], v[112:115]
  buffer_load_dwordx4 v[152:155], v2, s[8:11], s40 offen offset:0 sc1
  v_mfma_f32_16x16x32_bf16 v[116:119], v[156:159], a[20:23], v[116:119]
  v_mfma_f32_16x16x32_bf16 v[120:123], v[156:159], a[24:27], v[120:123]
  v_mfma_f32_16x16x32_bf16 v[124:127], v[156:159], a[28:31], v[124:127]
  s_waitcnt vmcnt(22)
  v_mfma_f32_16x16x32_bf16 v[112:115], v[160:163], a[32:35], v[112:115]
  buffer_load_dwordx4 v[156:159], v2, s[8:11], s40 offen offset:1024 sc1
  s_add_u32 s40, s40, 2048
  v_mfma_f32_16x16x32_bf16 v[116:119], v[160:163], a[36:39], v[116:119]
  v_mfma_f32_16x16x32_bf16 v[120:123], v[160:163], a[40:43], v[120:123]
  v_mfma_f32_16x16x32_bf16 v[124:127], v[160:163], a[44:47], v[124:127]
  s_waitcnt vmcnt(22)
  v_mfma_f32_16x16x32_bf16 v[112:115], v[164:167], a[48:51], v[112:115]
  buffer_load_dwordx4 v[160:163], v2, s[8:11], s40 offen offset:0 sc1
  v_mfma_f32_16x16x32_bf16 v[116:119], v[164:167], a[52:55], v[116:119]
  v_mfma_f32_16x16x32_bf16 v[120:123], v[164:167], a[56:59], v[120:123]
  v_mfma_f32_16x16x32_bf16 v[124:127], v[164:167], a[60:63], v[124:127]
  s_waitcnt vmcnt(22)
  v_mfma_f32_16x16x32_bf16 v[112:115], v[168:171], a[64:67], v[112:115]
  buffer_load_dwordx4 v[164:167], v2, s[8:11], s40 offen offset:1024 sc1
  s_add_u32 s40, s40, 2048
  v_mfma_f32_16x16x32_bf16 v[116:119], v[168:171], a[68:71], v[116:119]
  v_mfma_f32_16x16x32_bf16 v[120:123], v[168:171], a[72:75], v[120:123]
  v_mfma_f32_16x16x32_bf16 v[124:127], v[168:171], a[76:79], v[124:127]
  s_waitcnt vmcnt(22)
  v_mfma_f32_16x16x32_bf16 v[112:115], v[172:175], a[80:83], v[112:115]
  buffer_load_dwordx4 v[168:171], v2, s[8:11], s40 offen offset:0 sc1
  s_add_u32 s44, s64, 65536
  v_mfma_f32_16x16x32_bf16 v[116:119], v[172:175], a[84:87], v[116:119]
  v_mfma_f32_16x16x32_bf16 v[120:123], v[172:175], a[88:91], v[120:123]
  v_mfma_f32_16x16x32_bf16 v[124:127], v[172:175], a[92:95], v[124:127]
  v_cvt_pk_bf16_f32 v32, v96, v97
  s_waitcnt vmcnt(22)
  v_mfma_f32_16x16x32_bf16 v[112:115], v[176:179], a[96:99], v[112:115]
  buffer_load_dwordx4 v[172:175], v2, s[8:11], s40 offen offset:1024 sc1
  s_add_u32 s40, s40, 2048
  v_mfma_f32_16x16x32_bf16 v[116:119], v[176:179], a[100:103], v[116:119]
  v_mfma_f32_16x16x32_bf16 v[120:123], v[176:179], a[104:107], v[120:123]
  v_cvt_pk_bf16_f32 v33, v98, v99
  v_mfma_f32_16x16x32_bf16 v[124:127], v[176:179], a[108:111], v[124:127]
  s_waitcnt vmcnt(22)
  v_mfma_f32_16x16x32_bf16 v[112:115], v[180:183], a[112:115], v[112:115]
  buffer_load_dwordx4 v[176:179], v2, s[8:11], s40 offen offset:0 sc1
  v_mfma_f32_16x16x32_bf16 v[116:119], v[180:183], a[116:119], v[116:119]
  v_cvt_pk_bf16_f32 v34, v100, v101
  v_mfma_f32_16x16x32_bf16 v[120:123], v[180:183], a[120:123], v[120:123]
  v_mfma_f32_16x16x32_bf16 v[124:127], v[180:183], a[124:127], v[124:127]
  s_waitcnt vmcnt(22)
  v_mfma_f32_16x16x32_bf16 v[112:115], v[184:187], a[128:131], v[112:115]
  buffer_load_dwordx4 v[180:183], v2, s[8:11], s40 offen offset:1024 sc1
  s_add_u32 s40, s40, 2048
  v_mfma_f32_16x16x32_bf16 v[116:119], v[184:187], a[132:135], v[116:119]
  v_cvt_pk_bf16_f32 v35, v102, v103
  v_mfma_f32_16x16x32_bf16 v[120:123], v[184:187], a[136:139], v[120:123]
  v_mfma_f32_16x16x32_bf16 v[124:127], v[184:187], a[140:143], v[124:127]
  v_cvt_pk_bf16_f32 v36, v104, v105
  s_waitcnt vmcnt(22)
  v_mfma_f32_16x16x32_bf16 v[112:115], v[188:191], a[144:147], v[112:115]
  buffer_load_dwordx4 v[184:187], v2, s[8:11], s40 offen offset:0 sc1
  v_mfma_f32_16x16x32_bf16 v[116:119], v[188:191], a[148:151], v[116:119]
  v_mfma_f32_16x16x32_bf16 v[120:123], v[188:191], a[152:155], v[120:123]
  v_cvt_pk_bf16_f32 v37, v106, v107
  v_mfma_f32_16x16x32_bf16 v[124:127], v[188:191], a[156:159], v[124:127]
  s_waitcnt vmcnt(22)
  v_mfma_f32_16x16x32_bf16 v[112:115], v[192:195], a[160:163], v[112:115]
  buffer_load_dwordx4 v[188:191], v2, s[8:11], s40 offen offset:1024 sc1
  s_add_u32 s40, s40, 2048
  v_mfma_f32_16x16x32_bf16 v[116:119], v[192:195], a[164:167], v[116:119]
  v_cvt_pk_bf16_f32 v38, v108, v109
  v_mfma_f32_16x16x32_bf16 v[120:123], v[192:195], a[168:171], v[120:123]
  v_mfma_f32_16x16x32_bf16 v[124:127], v[192:195], a[172:175], v[124:127]
  s_waitcnt vmcnt(22)
  v_mfma_f32_16x16x32_bf16 v[112:115], v[196:199], a[176:179], v[112:115]
  buffer_load_dwordx4 v[192:195], v2, s[8:11], s40 offen offset:0 sc1
  v_cvt_pk_bf16_f32 v39, v110, v111
  v_mfma_f32_16x16x32_bf16 v[116:119], v[196:199], a[180:183], v[116:119]
  v_mfma_f32_16x16x32_bf16 v[120:123], v[196:199], a[184:187], v[120:123]
  v_mfma_f32_16x16x32_bf16 v[124:127], v[196:199], a[188:191], v[124:127]
  buffer_store_dwordx4 v[32:35], v2, s[16:19], s44 offen offset:0 sc1
  s_waitcnt vmcnt(23)
  v_mfma_f32_16x16x32_bf16 v[112:115], v[200:203], a[192:195], v[112:115]
  buffer_load_dwordx4 v[196:199], v2, s[8:11], s40 offen offset:1024 sc1
  s_add_u32 s40, s40, 2048
  v_mfma_f32_16x16x32_bf16 v[116:119], v[200:203], a[196:199], v[116:119]
  buffer_store_dwordx4 v[36:39], v2, s[16:19], s44 offen offset:1024 sc1
  v_mfma_f32_16x16x32_bf16 v[120:123], v[200:203], a[200:203], v[120:123]
  v_mfma_f32_16x16x32_bf16 v[124:127], v[200:203], a[204:207], v[124:127]
  s_waitcnt vmcnt(24)
  v_mfma_f32_16x16x32_bf16 v[112:115], v[204:207], a[208:211], v[112:115]
  s_add_u32 s65, s28, 3
  s_and_b32 s65, s65, 7
  s_mul_i32 s65, s65, 18432
  s_add_u32 s40, s65, 331776
  buffer_load_dwordx4 v[200:203], v2, s[8:11], s40 offen offset:0 sc1
  v_mfma_f32_16x16x32_bf16 v[116:119], v[204:207], a[212:215], v[116:119]
  v_mfma_f32_16x16x32_bf16 v[120:123], v[204:207], a[216:219], v[120:123]
  v_mfma_f32_16x16x32_bf16 v[124:127], v[204:207], a[220:223], v[124:127]
  s_waitcnt vmcnt(24)
  v_mfma_f32_16x16x32_bf16 v[112:115], v[208:211], a[224:227], v[112:115]
  buffer_load_dwordx4 v[204:207], v2, s[8:11], s40 offen offset:1024 sc1
  s_add_u32 s40, s40, 2048
  v_mfma_f32_16x16x32_bf16 v[116:119], v[208:211], a[228:231], v[116:119]
  v_mfma_f32_16x16x32_bf16 v[120:123], v[208:211], a[232:235], v[120:123]
  v_mfma_f32_16x16x32_bf16 v[124:127], v[208:211], a[236:239], v[124:127]
  s_waitcnt vmcnt(24)
  v_mfma_f32_16x16x32_bf16 v[112:115], v[212:215], a[240:243], v[112:115]
  buffer_load_dwordx4 v[208:211], v2, s[8:11], s40 offen offset:0 sc1
  v_mfma_f32_16x16x32_bf16 v[116:119], v[212:215], a[244:247], v[116:119]
  v_mfma_f32_16x16x32_bf16 v[120:123], v[212:215], a[248:251], v[120:123]
  v_mfma_f32_16x16x32_bf16 v[124:127], v[212:215], a[252:255], v[124:127]
  s_waitcnt vmcnt(24)
  v_mfma_f32_16x16x32_bf16 v[112:115], v[216:219], v[224:227], v[112:115]
  buffer_load_dwordx4 v[212:215], v2, s[8:11], s40 offen offset:1024 sc1
  s_add_u32 s40, s40, 2048
  v_mfma_f32_16x16x32_bf16 v[116:119], v[216:219], v[228:231], v[116:119]
  v_mfma_f32_16x16x32_bf16 v[120:123], v[216:219], v[232:235], v[120:123]
  v_mfma_f32_16x16x32_bf16 v[124:127], v[216:219], v[236:239], v[124:127]
  s_waitcnt vmcnt(24)
  v_mfma_f32_16x16x32_bf16 v[112:115], v[220:223], v[240:243], v[112:115]
  buffer_load_dwordx4 v[216:219], v2, s[8:11], s40 offen offset:0 sc1
  v_mfma_f32_16x16x32_bf16 v[116:119], v[220:223], v[244:247], v[116:119]
  v_mfma_f32_16x16x32_bf16 v[120:123], v[220:223], v[248:251], v[120:123]
  v_mfma_f32_16x16x32_bf16 v[124:127], v[220:223], v[252:255], v[124:127]
  s_waitcnt vmcnt(24)
  v_mfma_f32_16x16x32_bf16 v[96:99], v[128:131], a[0:3], 0
  buffer_load_dwordx4 v[220:223], v2, s[8:11], s40 offen offset:1024 sc1
  s_add_u32 s40, s40, 2048
  v_mfma_f32_16x16x32_bf16 v[100:103], v[128:131], a[4:7], 0
  v_mfma_f32_16x16x32_bf16 v[104:107], v[128:131], a[8:11], 0
  v_mfma_f32_16x16x32_bf16 v[108:111], v[128:131], a[12:15], 0
  s_waitcnt vmcnt(24)
  v_mfma_f32_16x16x32_bf16 v[96:99], v[132:135], a[16:19], v[96:99]
  buffer_load_dwordx4 v[128:131], v2, s[8:11], s40 offen offset:0 sc1
  v_mfma_f32_16x16x32_bf16 v[100:103], v[132:135], a[20:23], v[100:103]
  v_mfma_f32_16x16x32_bf16 v[104:107], v[132:135], a[24:27], v[104:107]
  v_mfma_f32_16x16x32_bf16 v[108:111], v[132:135], a[28:31], v[108:111]
  s_waitcnt vmcnt(24)
  v_mfma_f32_16x16x32_bf16 v[96:99], v[136:139], a[32:35], v[96:99]
  buffer_load_dwordx4 v[132:135], v2, s[8:11], s40 offen offset:1024 sc1
  s_add_u32 s40, s40, 2048
  v_mfma_f32_16x16x32_bf16 v[100:103], v[136:139], a[36:39], v[100:103]
  v_mfma_f32_16x16x32_bf16 v[104:107], v[136:139], a[40:43], v[104:107]
  v_mfma_f32_16x16x32_bf16 v[108:111], v[136:139], a[44:47], v[108:111]
  s_waitcnt vmcnt(24)
  v_mfma_f32_16x16x32_bf16 v[96:99], v[140:143], a[48:51], v[96:99]
  buffer_load_dwordx4 v[136:139], v2, s[8:11], s40 offen offset:0 sc1
  v_mfma_f32_16x16x32_bf16 v[100:103], v[140:143], a[52:55], v[100:103]
  v_mfma_f32_16x16x32_bf16 v[104:107], v[140:143], a[56:59], v[104:107]
  v_mfma_f32_16x16x32_bf16 v[108:111], v[140:143], a[60:63], v[108:111]
  s_waitcnt vmcnt(24)
  v_mfma_f32_16x16x32_bf16 v[96:99], v[144:147], a[64:67], v[96:99]
  buffer_load_dwordx4 v[140:143], v2, s[8:11], s40 offen offset:1024 sc1
  s_add_u32 s40, s40, 2048
  v_mfma_f32_16x16x32_bf16 v[100:103], v[144:147], a[68:71], v[100:103]
  s_add_u32 s69, s28, 1
  v_mfma_f32_16x16x32_bf16 v[104:107], v[144:147], a[72:75], v[104:107]
  v_mfma_f32_16x16x32_bf16 v[108:111], v[144:147], a[76:79], v[108:111]
  s_and_b32 s69, s69, 7
  s_waitcnt vmcnt(24)
  v_mfma_f32_16x16x32_bf16 v[96:99], v[148:151], a[80:83], v[96:99]
  buffer_load_dwordx4 v[144:147], v2, s[8:11], s40 offen offset:0 sc1
  v_mfma_f32_16x16x32_bf16 v[100:103], v[148:151], a[84:87], v[100:103]
  v_mfma_f32_16x16x32_bf16 v[104:107], v[148:151], a[88:91], v[104:107]
  s_lshl_b32 s69, s69, 13
  v_mfma_f32_16x16x32_bf16 v[108:111], v[148:151], a[92:95], v[108:111]
  s_waitcnt vmcnt(24)
  v_mfma_f32_16x16x32_bf16 v[96:99], v[152:155], a[96:99], v[96:99]
  buffer_load_dwordx4 v[148:151], v2, s[8:11], s40 offen offset:1024 sc1
  s_add_u32 s40, s40, 2048
  v_mfma_f32_16x16x32_bf16 v[100:103], v[152:155], a[100:103], v[100:103]
  s_add_u32 s44, s64, s69
  v_mfma_f32_16x16x32_bf16 v[104:107], v[152:155], a[104:107], v[104:107]
  v_mfma_f32_16x16x32_bf16 v[108:111], v[152:155], a[108:111], v[108:111]
  v_cvt_pk_bf16_f32 v24, v112, v113
  s_waitcnt vmcnt(24)
  v_mfma_f32_16x16x32_bf16 v[96:99], v[156:159], a[112:115], v[96:99]
  buffer_load_dwordx4 v[152:155], v2, s[8:11], s40 offen offset:0 sc1
  v_mfma_f32_16x16x32_bf16 v[100:103], v[156:159], a[116:119], v[100:103]
  v_cvt_pk_bf16_f32 v25, v114, v115
  v_mfma_f32_16x16x32_bf16 v[104:107], v[156:159], a[120:123], v[104:107]
  v_mfma_f32_16x16x32_bf16 v[108:111], v[156:159], a[124:127], v[108:111]
  s_waitcnt vmcnt(24)
  v_mfma_f32_16x16x32_bf16 v[96:99], v[160:163], a[128:131], v[96:99]
  buffer_load_dwordx4 v[156:159], v2, s[8:11], s40 offen offset:1024 sc1
  s_add_u32 s40, s40, 2048
  v_mfma_f32_16x16x32_bf16 v[100:103], v[160:163], a[132:135], v[100:103]
  v_cvt_pk_bf16_f32 v26, v116, v117
  v_mfma_f32_16x16x32_bf16 v[104:107], v[160:163], a[136:139], v[104:107]
  v_cvt_pk_bf16_f32 v27, v118, v119
  v_mfma_f32_16x16x32_bf16 v[108:111], v[160:163], a[140:143], v[108:111]
  s_waitcnt vmcnt(24)
  v_mfma_f32_16x16x32_bf16 v[96:99], v[164:167], a[144:147], v[96:99]
  buffer_load_dwordx4 v[160:163], v2, s[8:11], s40 offen offset:0 sc1
  v_mfma_f32_16x16x32_bf16 v[100:103], v[164:167], a[148:151], v[100:103]
  v_cvt_pk_bf16_f32 v28, v120, v121
  v_mfma_f32_16x16x32_bf16 v[104:107], v[164:167], a[152:155], v[104:107]
  v_mfma_f32_16x16x32_bf16 v[108:111], v[164:167], a[156:159], v[108:111]
  v_cvt_pk_bf16_f32 v29, v122, v123
  s_waitcnt vmcnt(24)
  v_mfma_f32_16x16x32_bf16 v[96:99], v[168:171], a[160:163], v[96:99]
  buffer_load_dwordx4 v[164:167], v2, s[8:11], s40 offen offset:1024 sc1
  s_add_u32 s40, s40, 2048
  v_mfma_f32_16x16x32_bf16 v[100:103], v[168:171], a[164:167], v[100:103]
  v_mfma_f32_16x16x32_bf16 v[104:107], v[168:171], a[168:171], v[104:107]
  v_cvt_pk_bf16_f32 v30, v124, v125
  v_mfma_f32_16x16x32_bf16 v[108:111], v[168:171], a[172:175], v[108:111]
  s_waitcnt vmcnt(24)
  v_mfma_f32_16x16x32_bf16 v[96:99], v[172:175], a[176:179], v[96:99]
  buffer_load_dwordx4 v[168:171], v2, s[8:11], s40 offen offset:0 sc1
  v_cvt_pk_bf16_f32 v31, v126, v127
  v_mfma_f32_16x16x32_bf16 v[100:103], v[172:175], a[180:183], v[100:103]
  v_mfma_f32_16x16x32_bf16 v[104:107], v[172:175], a[184:187], v[104:107]
  v_mfma_f32_16x16x32_bf16 v[108:111], v[172:175], a[188:191], v[108:111]
  buffer_store_dwordx4 v[24:27], v2, s[16:19], s44 offen offset:0 sc1
  s_waitcnt vmcnt(25)
  v_mfma_f32_16x16x32_bf16 v[96:99], v[176:179], a[192:195], v[96:99]
  buffer_load_dwordx4 v[172:175], v2, s[8:11], s40 offen offset:1024 sc1
  s_add_u32 s40, s40, 2048
  v_mfma_f32_16x16x32_bf16 v[100:103], v[176:179], a[196:199], v[100:103]
  buffer_store_dwordx4 v[28:31], v2, s[16:19], s44 offen offset:1024 sc1
  v_mfma_f32_16x16x32_bf16 v[104:107], v[176:179], a[200:203], v[104:107]
  v_mfma_f32_16x16x32_bf16 v[108:111], v[176:179], a[204:207], v[108:111]
  s_waitcnt vmcnt(26)
  v_mfma_f32_16x16x32_bf16 v[96:99], v[180:183], a[208:211], v[96:99]
  s_add_u32 s65, s28, 4
  s_and_b32 s65, s65, 7
  s_mul_i32 s65, s65, 18432
  s_add_u32 s40, s65, 331776
  buffer_load_dwordx4 v[176:179], v2, s[8:11], s40 offen offset:0 sc1
  v_mfma_f32_16x16x32_bf16 v[100:103], v[180:183], a[212:215], v[100:103]
  v_mfma_f32_16x16x32_bf16 v[104:107], v[180:183], a[216:219], v[104:107]
  v_mfma_f32_16x16x32_bf16 v[108:111], v[180:183], a[220:223], v[108:111]
  s_waitcnt vmcnt(26)
  v_mfma_f32_16x16x32_bf16 v[96:99], v[184:187], a[224:227], v[96:99]
  buffer_load_dwordx4 v[180:183], v2, s[8:11], s40 offen offset:1024 sc1
  s_add_u32 s40, s40, 2048
  v_mfma_f32_16x16x32_bf16 v[100:103], v[184:187], a[228:231], v[100:103]
  v_mfma_f32_16x16x32_bf16 v[104:107], v[184:187], a[232:235], v[104:107]
  v_mfma_f32_16x16x32_bf16 v[108:111], v[184:187], a[236:239], v[108:111]
  s_waitcnt vmcnt(26)
  v_mfma_f32_16x16x32_bf16 v[96:99], v[188:191], a[240:243], v[96:99]
  buffer_load_dwordx4 v[184:187], v2, s[8:11], s40 offen offset:0 sc1
  v_mfma_f32_16x16x32_bf16 v[100:103], v[188:191], a[244:247], v[100:103]
  v_mfma_f32_16x16x32_bf16 v[104:107], v[188:191], a[248:251], v[104:107]
  v_mfma_f32_16x16x32_bf16 v[108:111], v[188:191], a[252:255], v[108:111]
  s_waitcnt vmcnt(26)
  v_mfma_f32_16x16x32_bf16 v[96:99], v[192:195], v[224:227], v[96:99]
  buffer_load_dwordx4 v[188:191], v2, s[8:11], s40 offen offset:1024 sc1
  s_add_u32 s40, s40, 2048
  v_mfma_f32_16x16x32_bf16 v[100:103], v[192:195], v[228:231], v[100:103]
  v_mfma_f32_16x16x32_bf16 v[104:107], v[192:195], v[232:235], v[104:107]
  v_mfma_f32_16x16x32_bf16 v[108:111], v[192:195], v[236:239], v[108:111]
  s_waitcnt vmcnt(25)
  v_mfma_f32_16x16x32_bf16 v[96:99], v[196:199], v[240:243], v[96:99]
  buffer_load_dwordx4 v[192:195], v2, s[8:11], s40 offen offset:0 sc1
  v_mfma_f32_16x16x32_bf16 v[100:103], v[196:199], v[244:247], v[100:103]
  v_mfma_f32_16x16x32_bf16 v[104:107], v[196:199], v[248:251], v[104:107]
  v_mfma_f32_16x16x32_bf16 v[108:111], v[196:199], v[252:255], v[108:111]
  s_waitcnt vmcnt(24)
  v_mfma_f32_16x16x32_bf16 v[112:115], v[200:203], a[0:3], 0
  buffer_load_dwordx4 v[196:199], v2, s[8:11], s40 offen offset:1024 sc1
  s_add_u32 s40, s40, 2048
  v_mfma_f32_16x16x32_bf16 v[116:119], v[200:203], a[4:7], 0
  v_mfma_f32_16x16x32_bf16 v[120:123], v[200:203], a[8:11], 0
  v_mfma_f32_16x16x32_bf16 v[124:127], v[200:203], a[12:15], 0
  s_waitcnt vmcnt(24)
  v_mfma_f32_16x16x32_bf16 v[112:115], v[204:207], a[16:19], v[112:115]
  buffer_load_dwordx4 v[200:203], v2, s[8:11], s40 offen offset:0 sc1
  v_mfma_f32_16x16x32_bf16 v[116:119], v[204:207], a[20:23], v[116:119]
  v_mfma_f32_16x16x32_bf16 v[120:123], v[204:207], a[24:27], v[120:123]
  v_mfma_f32_16x16x32_bf16 v[124:127], v[204:207], a[28:31], v[124:127]
  s_waitcnt vmcnt(24)
  v_mfma_f32_16x16x32_bf16 v[112:115], v[208:211], a[32:35], v[112:115]
  buffer_load_dwordx4 v[204:207], v2, s[8:11], s40 offen offset:1024 sc1
  s_add_u32 s40, s40, 2048
  v_mfma_f32_16x16x32_bf16 v[116:119], v[208:211], a[36:39], v[116:119]
  v_mfma_f32_16x16x32_bf16 v[120:123], v[208:211], a[40:43], v[120:123]
  v_mfma_f32_16x16x32_bf16 v[124:127], v[208:211], a[44:47], v[124:127]
  s_waitcnt vmcnt(24)
  v_mfma_f32_16x16x32_bf16 v[112:115], v[212:215], a[48:51], v[112:115]
  buffer_load_dwordx4 v[208:211], v2, s[8:11], s40 offen offset:0 sc1
  v_mfma_f32_16x16x32_bf16 v[116:119], v[212:215], a[52:55], v[116:119]
  v_mfma_f32_16x16x32_bf16 v[120:123], v[212:215], a[56:59], v[120:123]
  v_mfma_f32_16x16x32_bf16 v[124:127], v[212:215], a[60:63], v[124:127]
  s_waitcnt vmcnt(24)
  v_mfma_f32_16x16x32_bf16 v[112:115], v[216:219], a[64:67], v[112:115]
  buffer_load_dwordx4 v[212:215], v2, s[8:11], s40 offen offset:1024 sc1
  s_add_u32 s40, s40, 2048
  v_mfma_f32_16x16x32_bf16 v[116:119], v[216:219], a[68:71], v[116:119]
  s_add_u32 s69, s28, 2
  v_mfma_f32_16x16x32_bf16 v[120:123], v[216:219], a[72:75], v[120:123]
  v_mfma_f32_16x16x32_bf16 v[124:127], v[216:219], a[76:79], v[124:127]
  s_and_b32 s69, s69, 7
  s_waitcnt vmcnt(24)
  v_mfma_f32_16x16x32_bf16 v[112:115], v[220:223], a[80:83], v[112:115]
  buffer_load_dwordx4 v[216:219], v2, s[8:11], s40 offen offset:0 sc1
  v_mfma_f32_16x16x32_bf16 v[116:119], v[220:223], a[84:87], v[116:119]
  v_mfma_f32_16x16x32_bf16 v[120:123], v[220:223], a[88:91], v[120:123]
  s_lshl_b32 s69, s69, 13
  v_mfma_f32_16x16x32_bf16 v[124:127], v[220:223], a[92:95], v[124:127]
  s_waitcnt vmcnt(24)
  v_mfma_f32_16x16x32_bf16 v[112:115], v[128:131], a[96:99], v[112:115]
  buffer_load_dwordx4 v[220:223], v2, s[8:11], s40 offen offset:1024 sc1
  s_add_u32 s40, s40, 2048
  v_mfma_f32_16x16x32_bf16 v[116:119], v[128:131], a[100:103], v[116:119]
  s_add_u32 s44, s64, s69
  v_mfma_f32_16x16x32_bf16 v[120:123], v[128:131], a[104:107], v[120:123]
  v_mfma_f32_16x16x32_bf16 v[124:127], v[128:131], a[108:111], v[124:127]
  v_cvt_pk_bf16_f32 v32, v96, v97
  s_waitcnt vmcnt(24)
  v_mfma_f32_16x16x32_bf16 v[112:115], v[132:135], a[112:115], v[112:115]
  buffer_load_dwordx4 v[128:131], v2, s[8:11], s40 offen offset:0 sc1
  v_mfma_f32_16x16x32_bf16 v[116:119], v[132:135], a[116:119], v[116:119]
  v_cvt_pk_bf16_f32 v33, v98, v99
  v_mfma_f32_16x16x32_bf16 v[120:123], v[132:135], a[120:123], v[120:123]
  v_mfma_f32_16x16x32_bf16 v[124:127], v[132:135], a[124:127], v[124:127]
  s_waitcnt vmcnt(24)
  v_mfma_f32_16x16x32_bf16 v[112:115], v[136:139], a[128:131], v[112:115]
  buffer_load_dwordx4 v[132:135], v2, s[8:11], s40 offen offset:1024 sc1
  s_add_u32 s40, s40, 2048
  v_mfma_f32_16x16x32_bf16 v[116:119], v[136:139], a[132:135], v[116:119]
  v_cvt_pk_bf16_f32 v34, v100, v101
  v_mfma_f32_16x16x32_bf16 v[120:123], v[136:139], a[136:139], v[120:123]
  v_cvt_pk_bf16_f32 v35, v102, v103
  v_mfma_f32_16x16x32_bf16 v[124:127], v[136:139], a[140:143], v[124:127]
  s_waitcnt vmcnt(24)
  v_mfma_f32_16x16x32_bf16 v[112:115], v[140:143], a[144:147], v[112:115]
  buffer_load_dwordx4 v[136:139], v2, s[8:11], s40 offen offset:0 sc1
  v_mfma_f32_16x16x32_bf16 v[116:119], v[140:143], a[148:151], v[116:119]
  v_cvt_pk_bf16_f32 v36, v104, v105
  v_mfma_f32_16x16x32_bf16 v[120:123], v[140:143], a[152:155], v[120:123]
  v_mfma_f32_16x16x32_bf16 v[124:127], v[140:143], a[156:159], v[124:127]
  v_cvt_pk_bf16_f32 v37, v106, v107
  s_waitcnt vmcnt(24)
  v_mfma_f32_16x16x32_bf16 v[112:115], v[144:147], a[160:163], v[112:115]
  buffer_load_dwordx4 v[140:143], v2, s[8:11], s40 offen offset:1024 sc1
  s_add_u32 s40, s40, 2048
  v_mfma_f32_16x16x32_bf16 v[116:119], v[144:147], a[164:167], v[116:119]
  v_mfma_f32_16x16x32_bf16 v[120:123], v[144:147], a[168:171], v[120:123]
  v_cvt_pk_bf16_f32 v38, v108, v109
  v_mfma_f32_16x16x32_bf16 v[124:127], v[144:147], a[172:175], v[124:127]
  s_waitcnt vmcnt(24)
  v_mfma_f32_16x16x32_bf16 v[112:115], v[148:151], a[176:179], v[112:115]
  buffer_load_dwordx4 v[144:147], v2, s[8:11], s40 offen offset:0 sc1
  v_cvt_pk_bf16_f32 v39, v110, v111
  v_mfma_f32_16x16x32_bf16 v[116:119], v[148:151], a[180:183], v[116:119]
  v_mfma_f32_16x16x32_bf16 v[120:123], v[148:151], a[184:187], v[120:123]
  v_mfma_f32_16x16x32_bf16 v[124:127], v[148:151], a[188:191], v[124:127]
  buffer_store_dwordx4 v[32:35], v2, s[16:19], s44 offen offset:0 sc1
  s_waitcnt vmcnt(25)
  v_mfma_f32_16x16x32_bf16 v[112:115], v[152:155], a[192:195], v[112:115]
  buffer_load_dwordx4 v[148:151], v2, s[8:11], s40 offen offset:1024 sc1
  s_add_u32 s40, s40, 2048
  v_mfma_f32_16x16x32_bf16 v[116:119], v[152:155], a[196:199], v[116:119]
  buffer_store_dwordx4 v[36:39], v2, s[16:19], s44 offen offset:1024 sc1
  v_mfma_f32_16x16x32_bf16 v[120:123], v[152:155], a[200:203], v[120:123]
  v_mfma_f32_16x16x32_bf16 v[124:127], v[152:155], a[204:207], v[124:127]
  s_waitcnt vmcnt(26)
  v_mfma_f32_16x16x32_bf16 v[112:115], v[156:159], a[208:211], v[112:115]
  s_add_u32 s65, s28, 5
  s_and_b32 s65, s65, 7
  s_mul_i32 s65, s65, 18432
  s_add_u32 s40, s65, 331776
  buffer_load_dwordx4 v[152:155], v2, s[8:11], s40 offen offset:0 sc1
  v_mfma_f32_16x16x32_bf16 v[116:119], v[156:159], a[212:215], v[116:119]
  v_mfma_f32_16x16x32_bf16 v[120:123], v[156:159], a[216:219], v[120:123]
  v_mfma_f32_16x16x32_bf16 v[124:127], v[156:159], a[220:223], v[124:127]
  s_waitcnt vmcnt(26)
  v_mfma_f32_16x16x32_bf16 v[112:115], v[160:163], a[224:227], v[112:115]
  buffer_load_dwordx4 v[156:159], v2, s[8:11], s40 offen offset:1024 sc1
  s_add_u32 s40, s40, 2048
  v_mfma_f32_16x16x32_bf16 v[116:119], v[160:163], a[228:231], v[116:119]
  v_mfma_f32_16x16x32_bf16 v[120:123], v[160:163], a[232:235], v[120:123]
  v_mfma_f32_16x16x32_bf16 v[124:127], v[160:163], a[236:239], v[124:127]
  s_waitcnt vmcnt(26)
  v_mfma_f32_16x16x32_bf16 v[112:115], v[164:167], a[240:243], v[112:115]
  buffer_load_dwordx4 v[160:163], v2, s[8:11], s40 offen offset:0 sc1
  v_mfma_f32_16x16x32_bf16 v[116:119], v[164:167], a[244:247], v[116:119]
  v_mfma_f32_16x16x32_bf16 v[120:123], v[164:167], a[248:251], v[120:123]
  v_mfma_f32_16x16x32_bf16 v[124:127], v[164:167], a[252:255], v[124:127]
  s_waitcnt vmcnt(26)
  v_mfma_f32_16x16x32_bf16 v[112:115], v[168:171], v[224:227], v[112:115]
  buffer_load_dwordx4 v[164:167], v2, s[8:11], s40 offen offset:1024 sc1
  s_add_u32 s40, s40, 2048
  v_mfma_f32_16x16x32_bf16 v[116:119], v[168:171], v[228:231], v[116:119]
  v_mfma_f32_16x16x32_bf16 v[120:123], v[168:171], v[232:235], v[120:123]
  v_mfma_f32_16x16x32_bf16 v[124:127], v[168:171], v[236:239], v[124:127]
  s_waitcnt vmcnt(25)
  v_mfma_f32_16x16x32_bf16 v[112:115], v[172:175], v[240:243], v[112:115]
  buffer_load_dwordx4 v[168:171], v2, s[8:11], s40 offen offset:0 sc1
  v_mfma_f32_16x16x32_bf16 v[116:119], v[172:175], v[244:247], v[116:119]
  v_mfma_f32_16x16x32_bf16 v[120:123], v[172:175], v[248:251], v[120:123]
  v_mfma_f32_16x16x32_bf16 v[124:127], v[172:175], v[252:255], v[124:127]
  s_waitcnt vmcnt(24)
  v_mfma_f32_16x16x32_bf16 v[96:99], v[176:179], a[0:3], 0
  buffer_load_dwordx4 v[172:175], v2, s[8:11], s40 offen offset:1024 sc1
  s_add_u32 s40, s40, 2048
  v_mfma_f32_16x16x32_bf16 v[100:103], v[176:179], a[4:7], 0
  v_mfma_f32_16x16x32_bf16 v[104:107], v[176:179], a[8:11], 0
  v_mfma_f32_16x16x32_bf16 v[108:111], v[176:179], a[12:15], 0
  s_waitcnt vmcnt(24)
  v_mfma_f32_16x16x32_bf16 v[96:99], v[180:183], a[16:19], v[96:99]
  buffer_load_dwordx4 v[176:179], v2, s[8:11], s40 offen offset:0 sc1
  v_mfma_f32_16x16x32_bf16 v[100:103], v[180:183], a[20:23], v[100:103]
  v_mfma_f32_16x16x32_bf16 v[104:107], v[180:183], a[24:27], v[104:107]
  v_mfma_f32_16x16x32_bf16 v[108:111], v[180:183], a[28:31], v[108:111]
  s_waitcnt vmcnt(24)
  v_mfma_f32_16x16x32_bf16 v[96:99], v[184:187], a[32:35], v[96:99]
  buffer_load_dwordx4 v[180:183], v2, s[8:11], s40 offen offset:1024 sc1
  s_add_u32 s40, s40, 2048
  v_mfma_f32_16x16x32_bf16 v[100:103], v[184:187], a[36:39], v[100:103]
  v_mfma_f32_16x16x32_bf16 v[104:107], v[184:187], a[40:43], v[104:107]
  v_mfma_f32_16x16x32_bf16 v[108:111], v[184:187], a[44:47], v[108:111]
  s_waitcnt vmcnt(24)
  v_mfma_f32_16x16x32_bf16 v[96:99], v[188:191], a[48:51], v[96:99]
  buffer_load_dwordx4 v[184:187], v2, s[8:11], s40 offen offset:0 sc1
  v_mfma_f32_16x16x32_bf16 v[100:103], v[188:191], a[52:55], v[100:103]
  v_mfma_f32_16x16x32_bf16 v[104:107], v[188:191], a[56:59], v[104:107]
  v_mfma_f32_16x16x32_bf16 v[108:111], v[188:191], a[60:63], v[108:111]
  s_waitcnt vmcnt(24)
  v_mfma_f32_16x16x32_bf16 v[96:99], v[192:195], a[64:67], v[96:99]
  buffer_load_dwordx4 v[188:191], v2, s[8:11], s40 offen offset:1024 sc1
  s_add_u32 s40, s40, 2048
  v_mfma_f32_16x16x32_bf16 v[100:103], v[192:195], a[68:71], v[100:103]
  s_add_u32 s69, s28, 3
  v_mfma_f32_16x16x32_bf16 v[104:107], v[192:195], a[72:75], v[104:107]
  v_mfma_f32_16x16x32_bf16 v[108:111], v[192:195], a[76:79], v[108:111]
  s_and_b32 s69, s69, 7
  s_waitcnt vmcnt(24)
  v_mfma_f32_16x16x32_bf16 v[96:99], v[196:199], a[80:83], v[96:99]
  buffer_load_dwordx4 v[192:195], v2, s[8:11], s40 offen offset:0 sc1
  v_mfma_f32_16x16x32_bf16 v[100:103], v[196:199], a[84:87], v[100:103]
  v_mfma_f32_16x16x32_bf16 v[104:107], v[196:199], a[88:91], v[104:107]
  s_lshl_b32 s69, s69, 13
  v_mfma_f32_16x16x32_bf16 v[108:111], v[196:199], a[92:95], v[108:111]
  s_waitcnt vmcnt(24)
  v_mfma_f32_16x16x32_bf16 v[96:99], v[200:203], a[96:99], v[96:99]
  buffer_load_dwordx4 v[196:199], v2, s[8:11], s40 offen offset:1024 sc1
  s_add_u32 s40, s40, 2048
  v_mfma_f32_16x16x32_bf16 v[100:103], v[200:203], a[100:103], v[100:103]
  s_add_u32 s44, s64, s69
  v_mfma_f32_16x16x32_bf16 v[104:107], v[200:203], a[104:107], v[104:107]
  v_mfma_f32_16x16x32_bf16 v[108:111], v[200:203], a[108:111], v[108:111]
  v_cvt_pk_bf16_f32 v24, v112, v113
  s_waitcnt vmcnt(24)
  v_mfma_f32_16x16x32_bf16 v[96:99], v[204:207], a[112:115], v[96:99]
  buffer_load_dwordx4 v[200:203], v2, s[8:11], s40 offen offset:0 sc1
  v_mfma_f32_16x16x32_bf16 v[100:103], v[204:207], a[116:119], v[100:103]
  v_cvt_pk_bf16_f32 v25, v114, v115
  v_mfma_f32_16x16x32_bf16 v[104:107], v[204:207], a[120:123], v[104:107]
  v_mfma_f32_16x16x32_bf16 v[108:111], v[204:207], a[124:127], v[108:111]
  s_waitcnt vmcnt(24)
  v_mfma_f32_16x16x32_bf16 v[96:99], v[208:211], a[128:131], v[96:99]
  buffer_load_dwordx4 v[204:207], v2, s[8:11], s40 offen offset:1024 sc1
  s_add_u32 s40, s40, 2048
  v_mfma_f32_16x16x32_bf16 v[100:103], v[208:211], a[132:135], v[100:103]
  v_cvt_pk_bf16_f32 v26, v116, v117
  v_mfma_f32_16x16x32_bf16 v[104:107], v[208:211], a[136:139], v[104:107]
  v_cvt_pk_bf16_f32 v27, v118, v119
  v_mfma_f32_16x16x32_bf16 v[108:111], v[208:211], a[140:143], v[108:111]
  s_waitcnt vmcnt(24)
  v_mfma_f32_16x16x32_bf16 v[96:99], v[212:215], a[144:147], v[96:99]
  buffer_load_dwordx4 v[208:211], v2, s[8:11], s40 offen offset:0 sc1
  v_mfma_f32_16x16x32_bf16 v[100:103], v[212:215], a[148:151], v[100:103]
  v_cvt_pk_bf16_f32 v28, v120, v121
  v_mfma_f32_16x16x32_bf16 v[104:107], v[212:215], a[152:155], v[104:107]
  v_mfma_f32_16x16x32_bf16 v[108:111], v[212:215], a[156:159], v[108:111]
  v_cvt_pk_bf16_f32 v29, v122, v123
  s_waitcnt vmcnt(24)
  v_mfma_f32_16x16x32_bf16 v[96:99], v[216:219], a[160:163], v[96:99]
  buffer_load_dwordx4 v[212:215], v2, s[8:11], s40 offen offset:1024 sc1
  s_add_u32 s40, s40, 2048
  v_mfma_f32_16x16x32_bf16 v[100:103], v[216:219], a[164:167], v[100:103]
  v_mfma_f32_16x16x32_bf16 v[104:107], v[216:219], a[168:171], v[104:107]
  v_cvt_pk_bf16_f32 v30, v124, v125
  v_mfma_f32_16x16x32_bf16 v[108:111], v[216:219], a[172:175], v[108:111]
  s_waitcnt vmcnt(24)
  v_mfma_f32_16x16x32_bf16 v[96:99], v[220:223], a[176:179], v[96:99]
  buffer_load_dwordx4 v[216:219], v2, s[8:11], s40 offen offset:0 sc1
  v_cvt_pk_bf16_f32 v31, v126, v127
  v_mfma_f32_16x16x32_bf16 v[100:103], v[220:223], a[180:183], v[100:103]
  v_mfma_f32_16x16x32_bf16 v[104:107], v[220:223], a[184:187], v[104:107]
  v_mfma_f32_16x16x32_bf16 v[108:111], v[220:223], a[188:191], v[108:111]
  buffer_store_dwordx4 v[24:27], v2, s[16:19], s44 offen offset:0 sc1
  s_waitcnt vmcnt(25)
  v_mfma_f32_16x16x32_bf16 v[96:99], v[128:131], a[192:195], v[96:99]
  buffer_load_dwordx4 v[220:223], v2, s[8:11], s40 offen offset:1024 sc1
  s_add_u32 s40, s40, 2048
  v_mfma_f32_16x16x32_bf16 v[100:103], v[128:131], a[196:199], v[100:103]
  buffer_store_dwordx4 v[28:31], v2, s[16:19], s44 offen offset:1024 sc1
  v_mfma_f32_16x16x32_bf16 v[104:107], v[128:131], a[200:203], v[104:107]
  v_mfma_f32_16x16x32_bf16 v[108:111], v[128:131], a[204:207], v[108:111]
  s_waitcnt vmcnt(26)
  v_mfma_f32_16x16x32_bf16 v[96:99], v[132:135], a[208:211], v[96:99]
  s_add_u32 s65, s28, 6
  s_and_b32 s65, s65, 7
  s_mul_i32 s65, s65, 18432
  s_add_u32 s40, s65, 331776
  buffer_load_dwordx4 v[128:131], v2, s[8:11], s40 offen offset:0 sc1
  v_mfma_f32_16x16x32_bf16 v[100:103], v[132:135], a[212:215], v[100:103]
  v_mfma_f32_16x16x32_bf16 v[104:107], v[132:135], a[216:219], v[104:107]
  v_mfma_f32_16x16x32_bf16 v[108:111], v[132:135], a[220:223], v[108:111]
  s_waitcnt vmcnt(26)
  v_mfma_f32_16x16x32_bf16 v[96:99], v[136:139], a[224:227], v[96:99]
  buffer_load_dwordx4 v[132:135], v2, s[8:11], s40 offen offset:1024 sc1
  s_add_u32 s40, s40, 2048
  v_mfma_f32_16x16x32_bf16 v[100:103], v[136:139], a[228:231], v[100:103]
  v_mfma_f32_16x16x32_bf16 v[104:107], v[136:139], a[232:235], v[104:107]
  v_mfma_f32_16x16x32_bf16 v[108:111], v[136:139], a[236:239], v[108:111]
  s_waitcnt vmcnt(26)
  v_mfma_f32_16x16x32_bf16 v[96:99], v[140:143], a[240:243], v[96:99]
  buffer_load_dwordx4 v[136:139], v2, s[8:11], s40 offen offset:0 sc1
  v_mfma_f32_16x16x32_bf16 v[100:103], v[140:143], a[244:247], v[100:103]
  v_mfma_f32_16x16x32_bf16 v[104:107], v[140:143], a[248:251], v[104:107]
  v_mfma_f32_16x16x32_bf16 v[108:111], v[140:143], a[252:255], v[108:111]
  s_waitcnt vmcnt(26)
  v_mfma_f32_16x16x32_bf16 v[96:99], v[144:147], v[224:227], v[96:99]
  buffer_load_dwordx4 v[140:143], v2, s[8:11], s40 offen offset:1024 sc1
  s_add_u32 s40, s40, 2048
  v_mfma_f32_16x16x32_bf16 v[100:103], v[144:147], v[228:231], v[100:103]
  v_mfma_f32_16x16x32_bf16 v[104:107], v[144:147], v[232:235], v[104:107]
  v_mfma_f32_16x16x32_bf16 v[108:111], v[144:147], v[236:239], v[108:111]
  s_waitcnt vmcnt(25)
  v_mfma_f32_16x16x32_bf16 v[96:99], v[148:151], v[240:243], v[96:99]
  buffer_load_dwordx4 v[144:147], v2, s[8:11], s40 offen offset:0 sc1
  v_mfma_f32_16x16x32_bf16 v[100:103], v[148:151], v[244:247], v[100:103]
  v_mfma_f32_16x16x32_bf16 v[104:107], v[148:151], v[248:251], v[104:107]
  v_mfma_f32_16x16x32_bf16 v[108:111], v[148:151], v[252:255], v[108:111]
  s_waitcnt vmcnt(24)
  v_mfma_f32_16x16x32_bf16 v[112:115], v[152:155], a[0:3], 0
  buffer_load_dwordx4 v[148:151], v2, s[8:11], s40 offen offset:1024 sc1
  s_add_u32 s40, s40, 2048
  v_mfma_f32_16x16x32_bf16 v[116:119], v[152:155], a[4:7], 0
  v_mfma_f32_16x16x32_bf16 v[120:123], v[152:155], a[8:11], 0
  v_mfma_f32_16x16x32_bf16 v[124:127], v[152:155], a[12:15], 0
  s_waitcnt vmcnt(24)
  v_mfma_f32_16x16x32_bf16 v[112:115], v[156:159], a[16:19], v[112:115]
  buffer_load_dwordx4 v[152:155], v2, s[8:11], s40 offen offset:0 sc1
  v_mfma_f32_16x16x32_bf16 v[116:119], v[156:159], a[20:23], v[116:119]
  v_mfma_f32_16x16x32_bf16 v[120:123], v[156:159], a[24:27], v[120:123]
  v_mfma_f32_16x16x32_bf16 v[124:127], v[156:159], a[28:31], v[124:127]
  s_waitcnt vmcnt(24)
  v_mfma_f32_16x16x32_bf16 v[112:115], v[160:163], a[32:35], v[112:115]
  buffer_load_dwordx4 v[156:159], v2, s[8:11], s40 offen offset:1024 sc1
  s_add_u32 s40, s40, 2048
  v_mfma_f32_16x16x32_bf16 v[116:119], v[160:163], a[36:39], v[116:119]
  v_mfma_f32_16x16x32_bf16 v[120:123], v[160:163], a[40:43], v[120:123]
  v_mfma_f32_16x16x32_bf16 v[124:127], v[160:163], a[44:47], v[124:127]
  s_waitcnt vmcnt(24)
  v_mfma_f32_16x16x32_bf16 v[112:115], v[164:167], a[48:51], v[112:115]
  buffer_load_dwordx4 v[160:163], v2, s[8:11], s40 offen offset:0 sc1
  v_mfma_f32_16x16x32_bf16 v[116:119], v[164:167], a[52:55], v[116:119]
  v_mfma_f32_16x16x32_bf16 v[120:123], v[164:167], a[56:59], v[120:123]
  v_mfma_f32_16x16x32_bf16 v[124:127], v[164:167], a[60:63], v[124:127]
  s_waitcnt vmcnt(24)
  v_mfma_f32_16x16x32_bf16 v[112:115], v[168:171], a[64:67], v[112:115]
  buffer_load_dwordx4 v[164:167], v2, s[8:11], s40 offen offset:1024 sc1
  s_add_u32 s40, s40, 2048
  v_mfma_f32_16x16x32_bf16 v[116:119], v[168:171], a[68:71], v[116:119]
  s_add_u32 s69, s28, 4
  v_mfma_f32_16x16x32_bf16 v[120:123], v[168:171], a[72:75], v[120:123]
  v_mfma_f32_16x16x32_bf16 v[124:127], v[168:171], a[76:79], v[124:127]
  s_and_b32 s69, s69, 7
  s_waitcnt vmcnt(24)
  v_mfma_f32_16x16x32_bf16 v[112:115], v[172:175], a[80:83], v[112:115]
  buffer_load_dwordx4 v[168:171], v2, s[8:11], s40 offen offset:0 sc1
  v_mfma_f32_16x16x32_bf16 v[116:119], v[172:175], a[84:87], v[116:119]
  v_mfma_f32_16x16x32_bf16 v[120:123], v[172:175], a[88:91], v[120:123]
  s_lshl_b32 s69, s69, 13
  v_mfma_f32_16x16x32_bf16 v[124:127], v[172:175], a[92:95], v[124:127]
  s_waitcnt vmcnt(24)
  v_mfma_f32_16x16x32_bf16 v[112:115], v[176:179], a[96:99], v[112:115]
  buffer_load_dwordx4 v[172:175], v2, s[8:11], s40 offen offset:1024 sc1
  s_add_u32 s40, s40, 2048
  v_mfma_f32_16x16x32_bf16 v[116:119], v[176:179], a[100:103], v[116:119]
  s_add_u32 s44, s64, s69
  v_mfma_f32_16x16x32_bf16 v[120:123], v[176:179], a[104:107], v[120:123]
  v_mfma_f32_16x16x32_bf16 v[124:127], v[176:179], a[108:111], v[124:127]
  v_cvt_pk_bf16_f32 v32, v96, v97
  s_waitcnt vmcnt(24)
  v_mfma_f32_16x16x32_bf16 v[112:115], v[180:183], a[112:115], v[112:115]
  buffer_load_dwordx4 v[176:179], v2, s[8:11], s40 offen offset:0 sc1
  v_mfma_f32_16x16x32_bf16 v[116:119], v[180:183], a[116:119], v[116:119]
  v_cvt_pk_bf16_f32 v33, v98, v99
  v_mfma_f32_16x16x32_bf16 v[120:123], v[180:183], a[120:123], v[120:123]
  v_mfma_f32_16x16x32_bf16 v[124:127], v[180:183], a[124:127], v[124:127]
  s_waitcnt vmcnt(24)
  v_mfma_f32_16x16x32_bf16 v[112:115], v[184:187], a[128:131], v[112:115]
  buffer_load_dwordx4 v[180:183], v2, s[8:11], s40 offen offset:1024 sc1
  s_add_u32 s40, s40, 2048
  v_mfma_f32_16x16x32_bf16 v[116:119], v[184:187], a[132:135], v[116:119]
  v_cvt_pk_bf16_f32 v34, v100, v101
  v_mfma_f32_16x16x32_bf16 v[120:123], v[184:187], a[136:139], v[120:123]
  v_cvt_pk_bf16_f32 v35, v102, v103
  v_mfma_f32_16x16x32_bf16 v[124:127], v[184:187], a[140:143], v[124:127]
  s_waitcnt vmcnt(24)
  v_mfma_f32_16x16x32_bf16 v[112:115], v[188:191], a[144:147], v[112:115]
  buffer_load_dwordx4 v[184:187], v2, s[8:11], s40 offen offset:0 sc1
  v_mfma_f32_16x16x32_bf16 v[116:119], v[188:191], a[148:151], v[116:119]
  v_cvt_pk_bf16_f32 v36, v104, v105
  v_mfma_f32_16x16x32_bf16 v[120:123], v[188:191], a[152:155], v[120:123]
  v_mfma_f32_16x16x32_bf16 v[124:127], v[188:191], a[156:159], v[124:127]
  v_cvt_pk_bf16_f32 v37, v106, v107
  s_waitcnt vmcnt(24)
  v_mfma_f32_16x16x32_bf16 v[112:115], v[192:195], a[160:163], v[112:115]
  buffer_load_dwordx4 v[188:191], v2, s[8:11], s40 offen offset:1024 sc1
  s_add_u32 s40, s40, 2048
  v_mfma_f32_16x16x32_bf16 v[116:119], v[192:195], a[164:167], v[116:119]
  v_mfma_f32_16x16x32_bf16 v[120:123], v[192:195], a[168:171], v[120:123]
  v_cvt_pk_bf16_f32 v38, v108, v109
  v_mfma_f32_16x16x32_bf16 v[124:127], v[192:195], a[172:175], v[124:127]
  s_waitcnt vmcnt(24)
  v_mfma_f32_16x16x32_bf16 v[112:115], v[196:199], a[176:179], v[112:115]
  buffer_load_dwordx4 v[192:195], v2, s[8:11], s40 offen offset:0 sc1
  v_cvt_pk_bf16_f32 v39, v110, v111
  v_mfma_f32_16x16x32_bf16 v[116:119], v[196:199], a[180:183], v[116:119]
  v_mfma_f32_16x16x32_bf16 v[120:123], v[196:199], a[184:187], v[120:123]
  v_mfma_f32_16x16x32_bf16 v[124:127], v[196:199], a[188:191], v[124:127]
  buffer_store_dwordx4 v[32:35], v2, s[16:19], s44 offen offset:0 sc1
  s_waitcnt vmcnt(25)
  v_mfma_f32_16x16x32_bf16 v[112:115], v[200:203], a[192:195], v[112:115]
  buffer_load_dwordx4 v[196:199], v2, s[8:11], s40 offen offset:1024 sc1
  s_add_u32 s40, s40, 2048
  v_mfma_f32_16x16x32_bf16 v[116:119], v[200:203], a[196:199], v[116:119]
  buffer_store_dwordx4 v[36:39], v2, s[16:19], s44 offen offset:1024 sc1
  v_mfma_f32_16x16x32_bf16 v[120:123], v[200:203], a[200:203], v[120:123]
  v_mfma_f32_16x16x32_bf16 v[124:127], v[200:203], a[204:207], v[124:127]
  s_waitcnt vmcnt(26)
  v_mfma_f32_16x16x32_bf16 v[112:115], v[204:207], a[208:211], v[112:115]
  s_add_u32 s65, s28, 7
  s_and_b32 s65, s65, 7
  s_mul_i32 s65, s65, 18432
  s_add_u32 s40, s65, 331776
  buffer_load_dwordx4 v[200:203], v2, s[8:11], s40 offen offset:0 sc1
  v_mfma_f32_16x16x32_bf16 v[116:119], v[204:207], a[212:215], v[116:119]
  v_mfma_f32_16x16x32_bf16 v[120:123], v[204:207], a[216:219], v[120:123]
  v_mfma_f32_16x16x32_bf16 v[124:127], v[204:207], a[220:223], v[124:127]
  s_waitcnt vmcnt(26)
  v_mfma_f32_16x16x32_bf16 v[112:115], v[208:211], a[224:227], v[112:115]
  buffer_load_dwordx4 v[204:207], v2, s[8:11], s40 offen offset:1024 sc1
  s_add_u32 s40, s40, 2048
  v_mfma_f32_16x16x32_bf16 v[116:119], v[208:211], a[228:231], v[116:119]
  v_mfma_f32_16x16x32_bf16 v[120:123], v[208:211], a[232:235], v[120:123]
  v_mfma_f32_16x16x32_bf16 v[124:127], v[208:211], a[236:239], v[124:127]
  s_waitcnt vmcnt(26)
  v_mfma_f32_16x16x32_bf16 v[112:115], v[212:215], a[240:243], v[112:115]
  buffer_load_dwordx4 v[208:211], v2, s[8:11], s40 offen offset:0 sc1
  v_mfma_f32_16x16x32_bf16 v[116:119], v[212:215], a[244:247], v[116:119]
  v_mfma_f32_16x16x32_bf16 v[120:123], v[212:215], a[248:251], v[120:123]
  v_mfma_f32_16x16x32_bf16 v[124:127], v[212:215], a[252:255], v[124:127]
  s_waitcnt vmcnt(26)
  v_mfma_f32_16x16x32_bf16 v[112:115], v[216:219], v[224:227], v[112:115]
  buffer_load_dwordx4 v[212:215], v2, s[8:11], s40 offen offset:1024 sc1
  s_add_u32 s40, s40, 2048
  v_mfma_f32_16x16x32_bf16 v[116:119], v[216:219], v[228:231], v[116:119]
  v_mfma_f32_16x16x32_bf16 v[120:123], v[216:219], v[232:235], v[120:123]
  v_mfma_f32_16x16x32_bf16 v[124:127], v[216:219], v[236:239], v[124:127]
  s_waitcnt vmcnt(25)
  v_mfma_f32_16x16x32_bf16 v[112:115], v[220:223], v[240:243], v[112:115]
  buffer_load_dwordx4 v[216:219], v2, s[8:11], s40 offen offset:0 sc1
  v_mfma_f32_16x16x32_bf16 v[116:119], v[220:223], v[244:247], v[116:119]
  v_mfma_f32_16x16x32_bf16 v[120:123], v[220:223], v[248:251], v[120:123]
  v_mfma_f32_16x16x32_bf16 v[124:127], v[220:223], v[252:255], v[124:127]
  s_waitcnt vmcnt(24)
  v_mfma_f32_16x16x32_bf16 v[96:99], v[128:131], a[0:3], 0
  buffer_load_dwordx4 v[220:223], v2, s[8:11], s40 offen offset:1024 sc1
  s_add_u32 s40, s40, 2048
  v_mfma_f32_16x16x32_bf16 v[100:103], v[128:131], a[4:7], 0
  v_mfma_f32_16x16x32_bf16 v[104:107], v[128:131], a[8:11], 0
  v_mfma_f32_16x16x32_bf16 v[108:111], v[128:131], a[12:15], 0
  s_waitcnt vmcnt(24)
  v_mfma_f32_16x16x32_bf16 v[96:99], v[132:135], a[16:19], v[96:99]
  buffer_load_dwordx4 v[128:131], v2, s[8:11], s40 offen offset:0 sc1
  v_mfma_f32_16x16x32_bf16 v[100:103], v[132:135], a[20:23], v[100:103]
  v_mfma_f32_16x16x32_bf16 v[104:107], v[132:135], a[24:27], v[104:107]
  v_mfma_f32_16x16x32_bf16 v[108:111], v[132:135], a[28:31], v[108:111]
  s_waitcnt vmcnt(24)
  v_mfma_f32_16x16x32_bf16 v[96:99], v[136:139], a[32:35], v[96:99]
  buffer_load_dwordx4 v[132:135], v2, s[8:11], s40 offen offset:1024 sc1
  s_add_u32 s40, s40, 2048
  v_mfma_f32_16x16x32_bf16 v[100:103], v[136:139], a[36:39], v[100:103]
  v_mfma_f32_16x16x32_bf16 v[104:107], v[136:139], a[40:43], v[104:107]
  v_mfma_f32_16x16x32_bf16 v[108:111], v[136:139], a[44:47], v[108:111]
  s_waitcnt vmcnt(24)
  v_mfma_f32_16x16x32_bf16 v[96:99], v[140:143], a[48:51], v[96:99]
  buffer_load_dwordx4 v[136:139], v2, s[8:11], s40 offen offset:0 sc1
  v_mfma_f32_16x16x32_bf16 v[100:103], v[140:143], a[52:55], v[100:103]
  v_mfma_f32_16x16x32_bf16 v[104:107], v[140:143], a[56:59], v[104:107]
  v_mfma_f32_16x16x32_bf16 v[108:111], v[140:143], a[60:63], v[108:111]
  s_waitcnt vmcnt(24)
  v_mfma_f32_16x16x32_bf16 v[96:99], v[144:147], a[64:67], v[96:99]
  buffer_load_dwordx4 v[140:143], v2, s[8:11], s40 offen offset:1024 sc1
  s_add_u32 s40, s40, 2048
  v_mfma_f32_16x16x32_bf16 v[100:103], v[144:147], a[68:71], v[100:103]
  s_add_u32 s69, s28, 5
  v_mfma_f32_16x16x32_bf16 v[104:107], v[144:147], a[72:75], v[104:107]
  v_mfma_f32_16x16x32_bf16 v[108:111], v[144:147], a[76:79], v[108:111]
  s_and_b32 s69, s69, 7
  s_waitcnt vmcnt(24)
  v_mfma_f32_16x16x32_bf16 v[96:99], v[148:151], a[80:83], v[96:99]
  buffer_load_dwordx4 v[144:147], v2, s[8:11], s40 offen offset:0 sc1
  v_mfma_f32_16x16x32_bf16 v[100:103], v[148:151], a[84:87], v[100:103]
  v_mfma_f32_16x16x32_bf16 v[104:107], v[148:151], a[88:91], v[104:107]
  s_lshl_b32 s69, s69, 13
  v_mfma_f32_16x16x32_bf16 v[108:111], v[148:151], a[92:95], v[108:111]
  s_waitcnt vmcnt(24)
  v_mfma_f32_16x16x32_bf16 v[96:99], v[152:155], a[96:99], v[96:99]
  buffer_load_dwordx4 v[148:151], v2, s[8:11], s40 offen offset:1024 sc1
  s_add_u32 s40, s40, 2048
  v_mfma_f32_16x16x32_bf16 v[100:103], v[152:155], a[100:103], v[100:103]
  s_add_u32 s44, s64, s69
  v_mfma_f32_16x16x32_bf16 v[104:107], v[152:155], a[104:107], v[104:107]
  v_mfma_f32_16x16x32_bf16 v[108:111], v[152:155], a[108:111], v[108:111]
  v_cvt_pk_bf16_f32 v24, v112, v113
  s_waitcnt vmcnt(24)
  v_mfma_f32_16x16x32_bf16 v[96:99], v[156:159], a[112:115], v[96:99]
  buffer_load_dwordx4 v[152:155], v2, s[8:11], s40 offen offset:0 sc1
  v_mfma_f32_16x16x32_bf16 v[100:103], v[156:159], a[116:119], v[100:103]
  v_cvt_pk_bf16_f32 v25, v114, v115
  v_mfma_f32_16x16x32_bf16 v[104:107], v[156:159], a[120:123], v[104:107]
  v_mfma_f32_16x16x32_bf16 v[108:111], v[156:159], a[124:127], v[108:111]
  s_waitcnt vmcnt(24)
  v_mfma_f32_16x16x32_bf16 v[96:99], v[160:163], a[128:131], v[96:99]
  buffer_load_dwordx4 v[156:159], v2, s[8:11], s40 offen offset:1024 sc1
  s_add_u32 s40, s40, 2048
  v_mfma_f32_16x16x32_bf16 v[100:103], v[160:163], a[132:135], v[100:103]
  v_cvt_pk_bf16_f32 v26, v116, v117
  v_mfma_f32_16x16x32_bf16 v[104:107], v[160:163], a[136:139], v[104:107]
  v_cvt_pk_bf16_f32 v27, v118, v119
  v_mfma_f32_16x16x32_bf16 v[108:111], v[160:163], a[140:143], v[108:111]
  s_waitcnt vmcnt(24)
  v_mfma_f32_16x16x32_bf16 v[96:99], v[164:167], a[144:147], v[96:99]
  buffer_load_dwordx4 v[160:163], v2, s[8:11], s40 offen offset:0 sc1
  v_mfma_f32_16x16x32_bf16 v[100:103], v[164:167], a[148:151], v[100:103]
  v_cvt_pk_bf16_f32 v28, v120, v121
  v_mfma_f32_16x16x32_bf16 v[104:107], v[164:167], a[152:155], v[104:107]
  v_mfma_f32_16x16x32_bf16 v[108:111], v[164:167], a[156:159], v[108:111]
  v_cvt_pk_bf16_f32 v29, v122, v123
  s_waitcnt vmcnt(24)
  v_mfma_f32_16x16x32_bf16 v[96:99], v[168:171], a[160:163], v[96:99]
  buffer_load_dwordx4 v[164:167], v2, s[8:11], s40 offen offset:1024 sc1
  s_add_u32 s40, s40, 2048
  v_mfma_f32_16x16x32_bf16 v[100:103], v[168:171], a[164:167], v[100:103]
  v_mfma_f32_16x16x32_bf16 v[104:107], v[168:171], a[168:171], v[104:107]
  v_cvt_pk_bf16_f32 v30, v124, v125
  v_mfma_f32_16x16x32_bf16 v[108:111], v[168:171], a[172:175], v[108:111]
  s_waitcnt vmcnt(24)
  v_mfma_f32_16x16x32_bf16 v[96:99], v[172:175], a[176:179], v[96:99]
  buffer_load_dwordx4 v[168:171], v2, s[8:11], s40 offen offset:0 sc1
  v_cvt_pk_bf16_f32 v31, v126, v127
  v_mfma_f32_16x16x32_bf16 v[100:103], v[172:175], a[180:183], v[100:103]
  v_mfma_f32_16x16x32_bf16 v[104:107], v[172:175], a[184:187], v[104:107]
  v_mfma_f32_16x16x32_bf16 v[108:111], v[172:175], a[188:191], v[108:111]
  buffer_store_dwordx4 v[24:27], v2, s[16:19], s44 offen offset:0 sc1
  s_waitcnt vmcnt(25)
  s_waitcnt vmcnt(18)
  s_add_u32 s69, s67, 229376
  v_mov_b32 v42, s69
  v_mov_b32 v43, s100
  v_cmp_eq_u32 vcc, 0, v1
  s_and_saveexec_b64 s[90:91], vcc
  buffer_store_dword v43, v42, s[52:55], 0 offen sc1
  s_mov_b64 exec, s[90:91]
  v_mfma_f32_16x16x32_bf16 v[96:99], v[176:179], a[192:195], v[96:99]
  buffer_load_dwordx4 v[172:175], v2, s[8:11], s40 offen offset:1024 sc1
  s_add_u32 s40, s40, 2048
  v_mfma_f32_16x16x32_bf16 v[100:103], v[176:179], a[196:199], v[100:103]
  buffer_store_dwordx4 v[28:31], v2, s[16:19], s44 offen offset:1024 sc1
  v_mfma_f32_16x16x32_bf16 v[104:107], v[176:179], a[200:203], v[104:107]
  v_mfma_f32_16x16x32_bf16 v[108:111], v[176:179], a[204:207], v[108:111]
  v_mfma_f32_16x16x32_bf16 v[96:99], v[180:183], a[208:211], v[96:99]
  s_add_u32 s65, s28, 8
  s_and_b32 s65, s65, 7
  s_mul_i32 s65, s65, 18432
  s_add_u32 s40, s65, 331776
  buffer_load_dwordx4 v[176:179], v2, s[8:11], s40 offen offset:0 sc1
  v_mfma_f32_16x16x32_bf16 v[100:103], v[180:183], a[212:215], v[100:103]
  v_mfma_f32_16x16x32_bf16 v[104:107], v[180:183], a[216:219], v[104:107]
  v_mfma_f32_16x16x32_bf16 v[108:111], v[180:183], a[220:223], v[108:111]
  v_mfma_f32_16x16x32_bf16 v[96:99], v[184:187], a[224:227], v[96:99]
  buffer_load_dwordx4 v[180:183], v2, s[8:11], s40 offen offset:1024 sc1
  s_add_u32 s40, s40, 2048
  v_mfma_f32_16x16x32_bf16 v[100:103], v[184:187], a[228:231], v[100:103]
  v_mfma_f32_16x16x32_bf16 v[104:107], v[184:187], a[232:235], v[104:107]
  v_mfma_f32_16x16x32_bf16 v[108:111], v[184:187], a[236:239], v[108:111]
  v_mfma_f32_16x16x32_bf16 v[96:99], v[188:191], a[240:243], v[96:99]
  buffer_load_dwordx4 v[184:187], v2, s[8:11], s40 offen offset:0 sc1
  v_mfma_f32_16x16x32_bf16 v[100:103], v[188:191], a[244:247], v[100:103]
  v_mfma_f32_16x16x32_bf16 v[104:107], v[188:191], a[248:251], v[104:107]
  v_mfma_f32_16x16x32_bf16 v[108:111], v[188:191], a[252:255], v[108:111]
  v_mfma_f32_16x16x32_bf16 v[96:99], v[192:195], v[224:227], v[96:99]
  buffer_load_dwordx4 v[188:191], v2, s[8:11], s40 offen offset:1024 sc1
  s_add_u32 s40, s40, 2048
  v_mfma_f32_16x16x32_bf16 v[100:103], v[192:195], v[228:231], v[100:103]
  v_mfma_f32_16x16x32_bf16 v[104:107], v[192:195], v[232:235], v[104:107]
  v_mfma_f32_16x16x32_bf16 v[108:111], v[192:195], v[236:239], v[108:111]
  v_mfma_f32_16x16x32_bf16 v[96:99], v[196:199], v[240:243], v[96:99]
  buffer_load_dwordx4 v[192:195], v2, s[8:11], s40 offen offset:0 sc1
  v_mfma_f32_16x16x32_bf16 v[100:103], v[196:199], v[244:247], v[100:103]
  v_mfma_f32_16x16x32_bf16 v[104:107], v[196:199], v[248:251], v[104:107]
  v_mfma_f32_16x16x32_bf16 v[108:111], v[196:199], v[252:255], v[108:111]
  s_waitcnt vmcnt(25)
  v_mfma_f32_16x16x32_bf16 v[112:115], v[200:203], a[0:3], 0
  buffer_load_dwordx4 v[196:199], v2, s[8:11], s40 offen offset:1024 sc1
  s_add_u32 s40, s40, 2048
  v_mfma_f32_16x16x32_bf16 v[116:119], v[200:203], a[4:7], 0
  v_mfma_f32_16x16x32_bf16 v[120:123], v[200:203], a[8:11], 0
  v_mfma_f32_16x16x32_bf16 v[124:127], v[200:203], a[12:15], 0
  s_waitcnt vmcnt(25)
  v_mfma_f32_16x16x32_bf16 v[112:115], v[204:207], a[16:19], v[112:115]
  buffer_load_dwordx4 v[200:203], v2, s[8:11], s40 offen offset:0 sc1
  v_mfma_f32_16x16x32_bf16 v[116:119], v[204:207], a[20:23], v[116:119]
  v_mfma_f32_16x16x32_bf16 v[120:123], v[204:207], a[24:27], v[120:123]
  v_mfma_f32_16x16x32_bf16 v[124:127], v[204:207], a[28:31], v[124:127]
  s_waitcnt vmcnt(25)
  v_mfma_f32_16x16x32_bf16 v[112:115], v[208:211], a[32:35], v[112:115]
  buffer_load_dwordx4 v[204:207], v2, s[8:11], s40 offen offset:1024 sc1
  s_add_u32 s40, s40, 2048
  v_mfma_f32_16x16x32_bf16 v[116:119], v[208:211], a[36:39], v[116:119]
  v_mfma_f32_16x16x32_bf16 v[120:123], v[208:211], a[40:43], v[120:123]
  v_mfma_f32_16x16x32_bf16 v[124:127], v[208:211], a[44:47], v[124:127]
  s_waitcnt vmcnt(25)
  v_mfma_f32_16x16x32_bf16 v[112:115], v[212:215], a[48:51], v[112:115]
  buffer_load_dwordx4 v[208:211], v2, s[8:11], s40 offen offset:0 sc1
  v_mfma_f32_16x16x32_bf16 v[116:119], v[212:215], a[52:55], v[116:119]
  v_mfma_f32_16x16x32_bf16 v[120:123], v[212:215], a[56:59], v[120:123]
  v_mfma_f32_16x16x32_bf16 v[124:127], v[212:215], a[60:63], v[124:127]
  s_waitcnt vmcnt(25)
  v_mfma_f32_16x16x32_bf16 v[112:115], v[216:219], a[64:67], v[112:115]
  buffer_load_dwordx4 v[212:215], v2, s[8:11], s40 offen offset:1024 sc1
  s_add_u32 s40, s40, 2048
  v_mfma_f32_16x16x32_bf16 v[116:119], v[216:219], a[68:71], v[116:119]
  s_add_u32 s69, s28, 6
  v_mfma_f32_16x16x32_bf16 v[120:123], v[216:219], a[72:75], v[120:123]
  v_mfma_f32_16x16x32_bf16 v[124:127], v[216:219], a[76:79], v[124:127]
  s_and_b32 s69, s69, 7
  s_waitcnt vmcnt(25)
  v_mfma_f32_16x16x32_bf16 v[112:115], v[220:223], a[80:83], v[112:115]
  buffer_load_dwordx4 v[216:219], v2, s[8:11], s40 offen offset:0 sc1
  v_mfma_f32_16x16x32_bf16 v[116:119], v[220:223], a[84:87], v[116:119]
  v_mfma_f32_16x16x32_bf16 v[120:123], v[220:223], a[88:91], v[120:123]
  s_lshl_b32 s69, s69, 13
  v_mfma_f32_16x16x32_bf16 v[124:127], v[220:223], a[92:95], v[124:127]
  s_waitcnt vmcnt(25)
  buffer_load_dword v44, v46, s[52:55], 0 offen sc1
  v_mfma_f32_16x16x32_bf16 v[112:115], v[128:131], a[96:99], v[112:115]
  buffer_load_dwordx4 v[220:223], v2, s[8:11], s40 offen offset:1024 sc1
  s_add_u32 s40, s40, 2048
  v_mfma_f32_16x16x32_bf16 v[116:119], v[128:131], a[100:103], v[116:119]
  s_add_u32 s44, s64, s69
  v_mfma_f32_16x16x32_bf16 v[120:123], v[128:131], a[104:107], v[120:123]
  v_mfma_f32_16x16x32_bf16 v[124:127], v[128:131], a[108:111], v[124:127]
  v_cvt_pk_bf16_f32 v32, v96, v97
  s_waitcnt vmcnt(26)
  v_mfma_f32_16x16x32_bf16 v[112:115], v[132:135], a[112:115], v[112:115]
  buffer_load_dwordx4 v[128:131], v2, s[8:11], s40 offen offset:0 sc1
  v_mfma_f32_16x16x32_bf16 v[116:119], v[132:135], a[116:119], v[116:119]
  v_cvt_pk_bf16_f32 v33, v98, v99
  v_mfma_f32_16x16x32_bf16 v[120:123], v[132:135], a[120:123], v[120:123]
  v_mfma_f32_16x16x32_bf16 v[124:127], v[132:135], a[124:127], v[124:127]
  s_waitcnt vmcnt(26)
  v_mfma_f32_16x16x32_bf16 v[112:115], v[136:139], a[128:131], v[112:115]
  buffer_load_dwordx4 v[132:135], v2, s[8:11], s40 offen offset:1024 sc1
  s_add_u32 s40, s40, 2048
  v_mfma_f32_16x16x32_bf16 v[116:119], v[136:139], a[132:135], v[116:119]
  v_cvt_pk_bf16_f32 v34, v100, v101
  v_mfma_f32_16x16x32_bf16 v[120:123], v[136:139], a[136:139], v[120:123]
  v_cvt_pk_bf16_f32 v35, v102, v103
  v_mfma_f32_16x16x32_bf16 v[124:127], v[136:139], a[140:143], v[124:127]
  s_waitcnt vmcnt(26)
  v_mfma_f32_16x16x32_bf16 v[112:115], v[140:143], a[144:147], v[112:115]
  buffer_load_dwordx4 v[136:139], v2, s[8:11], s40 offen offset:0 sc1
  v_mfma_f32_16x16x32_bf16 v[116:119], v[140:143], a[148:151], v[116:119]
  v_cvt_pk_bf16_f32 v36, v104, v105
  v_mfma_f32_16x16x32_bf16 v[120:123], v[140:143], a[152:155], v[120:123]
  v_mfma_f32_16x16x32_bf16 v[124:127], v[140:143], a[156:159], v[124:127]
  v_cvt_pk_bf16_f32 v37, v106, v107
  s_waitcnt vmcnt(26)
  v_mfma_f32_16x16x32_bf16 v[112:115], v[144:147], a[160:163], v[112:115]
  buffer_load_dwordx4 v[140:143], v2, s[8:11], s40 offen offset:1024 sc1
  s_add_u32 s40, s40, 2048
  v_mfma_f32_16x16x32_bf16 v[116:119], v[144:147], a[164:167], v[116:119]
  v_mfma_f32_16x16x32_bf16 v[120:123], v[144:147], a[168:171], v[120:123]
  v_cvt_pk_bf16_f32 v38, v108, v109
  v_mfma_f32_16x16x32_bf16 v[124:127], v[144:147], a[172:175], v[124:127]
  s_waitcnt vmcnt(26)
  v_mfma_f32_16x16x32_bf16 v[112:115], v[148:151], a[176:179], v[112:115]
  buffer_load_dwordx4 v[144:147], v2, s[8:11], s40 offen offset:0 sc1
  v_cvt_pk_bf16_f32 v39, v110, v111
  v_mfma_f32_16x16x32_bf16 v[116:119], v[148:151], a[180:183], v[116:119]
  v_mfma_f32_16x16x32_bf16 v[120:123], v[148:151], a[184:187], v[120:123]
  v_mfma_f32_16x16x32_bf16 v[124:127], v[148:151], a[188:191], v[124:127]
  buffer_store_dwordx4 v[32:35], v2, s[16:19], s44 offen offset:0 sc1
  s_waitcnt vmcnt(27)
  v_mfma_f32_16x16x32_bf16 v[112:115], v[152:155], a[192:195], v[112:115]
  buffer_load_dwordx4 v[148:151], v2, s[8:11], s40 offen offset:1024 sc1
  s_add_u32 s40, s40, 2048
  v_mfma_f32_16x16x32_bf16 v[116:119], v[152:155], a[196:199], v[116:119]
  buffer_store_dwordx4 v[36:39], v2, s[16:19], s44 offen offset:1024 sc1
  v_mfma_f32_16x16x32_bf16 v[120:123], v[152:155], a[200:203], v[120:123]
  v_mfma_f32_16x16x32_bf16 v[124:127], v[152:155], a[204:207], v[124:127]
  s_waitcnt vmcnt(28)
  v_mfma_f32_16x16x32_bf16 v[112:115], v[156:159], a[208:211], v[112:115]
  v_mfma_f32_16x16x32_bf16 v[116:119], v[156:159], a[212:215], v[116:119]
  v_mfma_f32_16x16x32_bf16 v[120:123], v[156:159], a[216:219], v[120:123]
  v_mfma_f32_16x16x32_bf16 v[124:127], v[156:159], a[220:223], v[124:127]
  s_waitcnt vmcnt(27)
  v_mfma_f32_16x16x32_bf16 v[112:115], v[160:163], a[224:227], v[112:115]
  v_mfma_f32_16x16x32_bf16 v[116:119], v[160:163], a[228:231], v[116:119]
  v_mfma_f32_16x16x32_bf16 v[120:123], v[160:163], a[232:235], v[120:123]
  v_mfma_f32_16x16x32_bf16 v[124:127], v[160:163], a[236:239], v[124:127]
  s_waitcnt vmcnt(26)
  v_mfma_f32_16x16x32_bf16 v[112:115], v[164:167], a[240:243], v[112:115]
  v_mfma_f32_16x16x32_bf16 v[116:119], v[164:167], a[244:247], v[116:119]
  v_mfma_f32_16x16x32_bf16 v[120:123], v[164:167], a[248:251], v[120:123]
  v_mfma_f32_16x16x32_bf16 v[124:127], v[164:167], a[252:255], v[124:127]
  s_waitcnt vmcnt(25)
  v_mfma_f32_16x16x32_bf16 v[112:115], v[168:171], v[224:227], v[112:115]
  v_mfma_f32_16x16x32_bf16 v[116:119], v[168:171], v[228:231], v[116:119]
  v_mfma_f32_16x16x32_bf16 v[120:123], v[168:171], v[232:235], v[120:123]
  v_mfma_f32_16x16x32_bf16 v[124:127], v[168:171], v[236:239], v[124:127]
  s_waitcnt vmcnt(22)
  v_mfma_f32_16x16x32_bf16 v[112:115], v[172:175], v[240:243], v[112:115]
  v_mfma_f32_16x16x32_bf16 v[116:119], v[172:175], v[244:247], v[116:119]
  v_mfma_f32_16x16x32_bf16 v[120:123], v[172:175], v[248:251], v[120:123]
  v_mfma_f32_16x16x32_bf16 v[124:127], v[172:175], v[252:255], v[124:127]
  s_waitcnt vmcnt(20)
  v_mfma_f32_16x16x32_bf16 v[96:99], v[176:179], a[0:3], 0
  v_mfma_f32_16x16x32_bf16 v[100:103], v[176:179], a[4:7], 0
  v_mfma_f32_16x16x32_bf16 v[104:107], v[176:179], a[8:11], 0
  v_mfma_f32_16x16x32_bf16 v[108:111], v[176:179], a[12:15], 0
  s_waitcnt vmcnt(19)
  v_mfma_f32_16x16x32_bf16 v[96:99], v[180:183], a[16:19], v[96:99]
  s_add_u32 s69, s28, 7
  s_and_b32 s69, s69, 7
  v_mfma_f32_16x16x32_bf16 v[100:103], v[180:183], a[20:23], v[100:103]
  s_lshl_b32 s69, s69, 13
  s_add_u32 s44, s64, s69
  v_mfma_f32_16x16x32_bf16 v[104:107], v[180:183], a[24:27], v[104:107]
  v_cvt_pk_bf16_f32 v24, v112, v113
  v_cvt_pk_bf16_f32 v25, v114, v115
  v_mfma_f32_16x16x32_bf16 v[108:111], v[180:183], a[28:31], v[108:111]
  v_cvt_pk_bf16_f32 v26, v116, v117
  s_waitcnt vmcnt(18)
  v_mfma_f32_16x16x32_bf16 v[96:99], v[184:187], a[32:35], v[96:99]
  v_cvt_pk_bf16_f32 v27, v118, v119
  v_cvt_pk_bf16_f32 v28, v120, v121
  v_mfma_f32_16x16x32_bf16 v[100:103], v[184:187], a[36:39], v[100:103]
  v_cvt_pk_bf16_f32 v29, v122, v123
  v_cvt_pk_bf16_f32 v30, v124, v125
  v_mfma_f32_16x16x32_bf16 v[104:107], v[184:187], a[40:43], v[104:107]
  v_cvt_pk_bf16_f32 v31, v126, v127
  buffer_store_dwordx4 v[24:27], v2, s[16:19], s44 offen offset:0 sc1
  v_mfma_f32_16x16x32_bf16 v[108:111], v[184:187], a[44:47], v[108:111]
  buffer_store_dwordx4 v[28:31], v2, s[16:19], s44 offen offset:1024 sc1
  s_waitcnt vmcnt(19)
  v_mfma_f32_16x16x32_bf16 v[96:99], v[188:191], a[48:51], v[96:99]
  v_mfma_f32_16x16x32_bf16 v[100:103], v[188:191], a[52:55], v[100:103]
  v_mfma_f32_16x16x32_bf16 v[104:107], v[188:191], a[56:59], v[104:107]
  v_mfma_f32_16x16x32_bf16 v[108:111], v[188:191], a[60:63], v[108:111]
  s_waitcnt vmcnt(18)
  s_waitcnt vmcnt(11)
  v_cmp_ne_u32 vcc, s100, v44
  s_cbranch_vccz F_r1ok
  s_mov_b32 s95, 200000
FM1_poll:
  buffer_load_dword v44, v46, s[52:55], 0 offen sc1
  s_waitcnt vmcnt(0)
  v_cmp_ne_u32 vcc, s100, v44
  s_cbranch_vccz FM1_go
  s_sub_u32 s95, s95, 1
  s_cmp_eq_u32 s95, 0
  s_cbranch_scc1 FM1_go
  s_sleep 1
  s_branch FM1_poll
FM1_go:
F_r1ok:
  s_sub_u32 s69, s28, 1
  s_and_b32 s69, s69, 7
  s_mul_i32 s69, s69, 2359296
  s_add_u32 s69, s69, s66
  s_add_u32 m0, s68, 0
  s_add_u32 s70, s69, 0
  buffer_load_dwordx4 v2, s[16:19], s70 offen sc1 lds
  s_add_u32 m0, s68, 1024
  s_add_u32 s70, s69, 1024
  buffer_load_dwordx4 v2, s[16:19], s70 offen sc1 lds
  s_sub_u32 s69, s28, 2
  s_and_b32 s69, s69, 7
  s_mul_i32 s69, s69, 2359296
  s_add_u32 s69, s69, s66
  s_add_u32 m0, s68, 2048
  s_add_u32 s70, s69, 0
  buffer_load_dwordx4 v2, s[16:19], s70 offen sc1 lds
  s_add_u32 m0, s68, 3072
  s_add_u32 s70, s69, 1024
  buffer_load_dwordx4 v2, s[16:19], s70 offen sc1 lds
  s_sub_u32 s69, s28, 3
  s_and_b32 s69, s69, 7
  s_mul_i32 s69, s69, 2359296
  s_add_u32 s69, s69, s66
  s_add_u32 m0, s68, 4096
  s_add_u32 s70, s69, 0
  buffer_load_dwordx4 v2, s[16:19], s70 offen sc1 lds
  s_add_u32 m0, s68, 5120
  s_add_u32 s70, s69, 1024
  buffer_load_dwordx4 v2, s[16:19], s70 offen sc1 lds
  s_sub_u32 s69, s28, 4
  s_and_b32 s69, s69, 7
  s_mul_i32 s69, s69, 2359296
  s_add_u32 s69, s69, s66
  s_add_u32 m0, s68, 6144
  s_add_u32 s70, s69, 0
  buffer_load_dwordx4 v2, s[16:19], s70 offen sc1 lds
  s_add_u32 m0, s68, 7168
  s_add_u32 s70, s69, 1024
  buffer_load_dwordx4 v2, s[16:19], s70 offen sc1 lds
  s_lshr_b32 s69, s28, 1
  s_cmp_lg_u32 s69, s30
  s_cbranch_scc1 F_r2
  s_mul_i32 s69, s29, 72
  s_add_u32 s69, s69, s28
  s_add_u32 s69, s69, 64
  s_lshl_b32 s69, s69, 10
  s_add_u32 m0, s45, 0
  s_add_u32 s70, s69, 0
  buffer_load_dwordx4 v2, s[16:19], s70 offen sc1 lds
  s_add_u32 m0, s45, 1024
  s_add_u32 s70, s69, 2359296
  buffer_load_dwordx4 v2, s[16:19], s70 offen sc1 lds
  s_add_u32 m0, s45, 2048
  s_add_u32 s70, s69, 4718592
  buffer_load_dwordx4 v2, s[16:19], s70 offen sc1 lds
  s_add_u32 m0, s45, 3072
  s_add_u32 s70, s69, 7077888
  buffer_load_dwordx4 v2, s[16:19], s70 offen sc1 lds
  s_add_u32 m0, s45, 4096
  s_add_u32 s70, s69, 9437184
  buffer_load_dwordx4 v2, s[16:19], s70 offen sc1 lds
  s_add_u32 m0, s45, 5120
  s_add_u32 s70, s69, 11796480
  buffer_load_dwordx4 v2, s[16:19], s70 offen sc1 lds
  s_add_u32 m0, s45, 6144
  s_add_u32 s70, s69, 14155776
  buffer_load_dwordx4 v2, s[16:19], s70 offen sc1 lds
  s_add_u32 m0, s45, 7168
  s_add_u32 s70, s69, 16515072
  buffer_load_dwordx4 v2, s[16:19], s70 offen sc1 lds
  buffer_load_dwordx4 v[164:167], v2, s[20:23], s69 offen sc1
  s_lshr_b32 s70, s28, 1
  s_lshl_b32 s70, s70, 5
  s_add_u32 s70, s70, 6784
  buffer_load_dwordx2 v[168:169], v48, s[72:75], s70 offen sc1
F_r2:
  buffer_load_dwordx4 v[152:155], v2, s[20:23], s66 offen sc1
  buffer_load_dwordx4 v[156:159], v2, s[20:23], s66 offen offset:1024 sc1
  buffer_load_dwordx2 v[160:161], v48, s[72:75], s71 offen sc1
  v_mfma_f32_16x16x32_bf16 v[96:99], v[192:195], a[64:67], v[96:99]
  v_mfma_f32_16x16x32_bf16 v[100:103], v[192:195], a[68:71], v[100:103]
  v_mfma_f32_16x16x32_bf16 v[104:107], v[192:195], a[72:75], v[104:107]
  v_mfma_f32_16x16x32_bf16 v[108:111], v[192:195], a[76:79], v[108:111]
  v_mfma_f32_16x16x32_bf16 v[96:99], v[196:199], a[80:83], v[96:99]
  v_mfma_f32_16x16x32_bf16 v[100:103], v[196:199], a[84:87], v[100:103]
  v_mfma_f32_16x16x32_bf16 v[104:107], v[196:199], a[88:91], v[104:107]
  v_mfma_f32_16x16x32_bf16 v[108:111], v[196:199], a[92:95], v[108:111]
  v_mfma_f32_16x16x32_bf16 v[96:99], v[200:203], a[96:99], v[96:99]
  v_mfma_f32_16x16x32_bf16 v[100:103], v[200:203], a[100:103], v[100:103]
  v_mfma_f32_16x16x32_bf16 v[104:107], v[200:203], a[104:107], v[104:107]
  v_mfma_f32_16x16x32_bf16 v[108:111], v[200:203], a[108:111], v[108:111]
  v_mfma_f32_16x16x32_bf16 v[96:99], v[204:207], a[112:115], v[96:99]
  v_mfma_f32_16x16x32_bf16 v[100:103], v[204:207], a[116:119], v[100:103]
  v_mfma_f32_16x16x32_bf16 v[104:107], v[204:207], a[120:123], v[104:107]
  v_mfma_f32_16x16x32_bf16 v[108:111], v[204:207], a[124:127], v[108:111]
  v_mfma_f32_16x16x32_bf16 v[96:99], v[208:211], a[128:131], v[96:99]
  v_mfma_f32_16x16x32_bf16 v[100:103], v[208:211], a[132:135], v[100:103]
  v_mfma_f32_16x16x32_bf16 v[104:107], v[208:211], a[136:139], v[104:107]
  v_mfma_f32_16x16x32_bf16 v[108:111], v[208:211], a[140:143], v[108:111]
  v_mfma_f32_16x16x32_bf16 v[96:99], v[212:215], a[144:147], v[96:99]
  v_mfma_f32_16x16x32_bf16 v[100:103], v[212:215], a[148:151], v[100:103]
  v_mfma_f32_16x16x32_bf16 v[104:107], v[212:215], a[152:155], v[104:107]
  v_mfma_f32_16x16x32_bf16 v[108:111], v[212:215], a[156:159], v[108:111]
  v_mfma_f32_16x16x32_bf16 v[96:99], v[216:219], a[160:163], v[96:99]
  v_mfma_f32_16x16x32_bf16 v[100:103], v[216:219], a[164:167], v[100:103]
  v_mfma_f32_16x16x32_bf16 v[104:107], v[216:219], a[168:171], v[104:107]
  v_mfma_f32_16x16x32_bf16 v[108:111], v[216:219], a[172:175], v[108:111]
  s_waitcnt vmcnt(21)
  v_mfma_f32_16x16x32_bf16 v[96:99], v[220:223], a[176:179], v[96:99]
  v_mfma_f32_16x16x32_bf16 v[100:103], v[220:223], a[180:183], v[100:103]
  v_mfma_f32_16x16x32_bf16 v[104:107], v[220:223], a[184:187], v[104:107]
  v_mfma_f32_16x16x32_bf16 v[108:111], v[220:223], a[188:191], v[108:111]
  s_waitcnt vmcnt(20)
  v_mfma_f32_16x16x32_bf16 v[96:99], v[128:131], a[192:195], v[96:99]
  v_mfma_f32_16x16x32_bf16 v[100:103], v[128:131], a[196:199], v[100:103]
  v_mfma_f32_16x16x32_bf16 v[104:107], v[128:131], a[200:203], v[104:107]
  v_mfma_f32_16x16x32_bf16 v[108:111], v[128:131], a[204:207], v[108:111]
  s_waitcnt vmcnt(19)
  v_mfma_f32_16x16x32_bf16 v[96:99], v[132:135], a[208:211], v[96:99]
  v_mfma_f32_16x16x32_bf16 v[100:103], v[132:135], a[212:215], v[100:103]
  v_mfma_f32_16x16x32_bf16 v[104:107], v[132:135], a[216:219], v[104:107]
  v_mfma_f32_16x16x32_bf16 v[108:111], v[132:135], a[220:223], v[108:111]
  s_waitcnt vmcnt(18)
  v_mfma_f32_16x16x32_bf16 v[96:99], v[136:139], a[224:227], v[96:99]
  v_mfma_f32_16x16x32_bf16 v[100:103], v[136:139], a[228:231], v[100:103]
  v_mfma_f32_16x16x32_bf16 v[104:107], v[136:139], a[232:235], v[104:107]
  v_mfma_f32_16x16x32_bf16 v[108:111], v[136:139], a[236:239], v[108:111]
  s_waitcnt vmcnt(17)
  s_waitcnt vmcnt(11)
  s_add_u32 s69, s67, 360448
  v_mov_b32 v42, s69
  v_mov_b32 v43, s100
  v_cmp_eq_u32 vcc, 0, v1
  s_and_saveexec_b64 s[90:91], vcc
  buffer_store_dword v43, v42, s[52:55], 0 offen sc1
  s_mov_b64 exec, s[90:91]
  v_mfma_f32_16x16x32_bf16 v[96:99], v[140:143], a[240:243], v[96:99]
  v_mfma_f32_16x16x32_bf16 v[100:103], v[140:143], a[244:247], v[100:103]
  v_mfma_f32_16x16x32_bf16 v[104:107], v[140:143], a[248:251], v[104:107]
  v_mfma_f32_16x16x32_bf16 v[108:111], v[140:143], a[252:255], v[108:111]
  v_mfma_f32_16x16x32_bf16 v[96:99], v[144:147], v[224:227], v[96:99]
  v_mfma_f32_16x16x32_bf16 v[100:103], v[144:147], v[228:231], v[100:103]
  v_mfma_f32_16x16x32_bf16 v[104:107], v[144:147], v[232:235], v[104:107]
  v_mfma_f32_16x16x32_bf16 v[108:111], v[144:147], v[236:239], v[108:111]
  v_mfma_f32_16x16x32_bf16 v[96:99], v[148:151], v[240:243], v[96:99]
  v_mfma_f32_16x16x32_bf16 v[100:103], v[148:151], v[244:247], v[100:103]
  v_mfma_f32_16x16x32_bf16 v[104:107], v[148:151], v[248:251], v[104:107]
  v_mfma_f32_16x16x32_bf16 v[108:111], v[148:151], v[252:255], v[108:111]
  s_waitcnt vmcnt(1)
  buffer_load_dword v44, v47, s[52:55], 0 offen sc1
  v_add_u32 v9, s68, v2
  ds_read_b128 v[176:179], v9 offset:0
  ds_read_b128 v[180:183], v9 offset:1024
  ds_read_b128 v[184:187], v9 offset:2048
  ds_read_b128 v[188:191], v9 offset:3072
  ds_read_b128 v[192:195], v9 offset:4096
  ds_read_b128 v[196:199], v9 offset:5120
  ds_read_b128 v[200:203], v9 offset:6144
  ds_read_b128 v[204:207], v9 offset:7168
  s_nop 4
  s_waitcnt lgkmcnt(7)
  v_lshlrev_b32 v10, 16, v176
  v_and_b32 v11, 0xffff0000, v176
  v_pk_add_f32 v[96:97], v[96:97], v[10:11]
  v_lshlrev_b32 v10, 16, v177
  v_and_b32 v11, 0xffff0000, v177
  v_pk_add_f32 v[98:99], v[98:99], v[10:11]
  v_lshlrev_b32 v10, 16, v178
  v_and_b32 v11, 0xffff0000, v178
  v_pk_add_f32 v[100:101], v[100:101], v[10:11]
  v_lshlrev_b32 v10, 16, v179
  v_and_b32 v11, 0xffff0000, v179
  v_pk_add_f32 v[102:103], v[102:103], v[10:11]
  s_waitcnt lgkmcnt(6)
  v_lshlrev_b32 v10, 16, v180
  v_and_b32 v11, 0xffff0000, v180
  v_pk_add_f32 v[104:105], v[104:105], v[10:11]
  v_lshlrev_b32 v10, 16, v181
  v_and_b32 v11, 0xffff0000, v181
  v_pk_add_f32 v[106:107], v[106:107], v[10:11]
  v_lshlrev_b32 v10, 16, v182
  v_and_b32 v11, 0xffff0000, v182
  v_pk_add_f32 v[108:109], v[108:109], v[10:11]
  v_lshlrev_b32 v10, 16, v183
  v_and_b32 v11, 0xffff0000, v183
  v_pk_add_f32 v[110:111], v[110:111], v[10:11]
  s_waitcnt lgkmcnt(5)
  v_lshlrev_b32 v10, 16, v184
  v_and_b32 v11, 0xffff0000, v184
  v_pk_add_f32 v[96:97], v[96:97], v[10:11]
  v_lshlrev_b32 v10, 16, v185
  v_and_b32 v11, 0xffff0000, v185
  v_pk_add_f32 v[98:99], v[98:99], v[10:11]
  v_lshlrev_b32 v10, 16, v186
  v_and_b32 v11, 0xffff0000, v186
  v_pk_add_f32 v[100:101], v[100:101], v[10:11]
  v_lshlrev_b32 v10, 16, v187
  v_and_b32 v11, 0xffff0000, v187
  v_pk_add_f32 v[102:103], v[102:103], v[10:11]
  s_waitcnt lgkmcnt(4)
  v_lshlrev_b32 v10, 16, v188
  v_and_b32 v11, 0xffff0000, v188
  v_pk_add_f32 v[104:105], v[104:105], v[10:11]
  v_lshlrev_b32 v10, 16, v189
  v_and_b32 v11, 0xffff0000, v189
  v_pk_add_f32 v[106:107], v[106:107], v[10:11]
  v_lshlrev_b32 v10, 16, v190
  v_and_b32 v11, 0xffff0000, v190
  v_pk_add_f32 v[108:109], v[108:109], v[10:11]
  v_lshlrev_b32 v10, 16, v191
  v_and_b32 v11, 0xffff0000, v191
  v_pk_add_f32 v[110:111], v[110:111], v[10:11]
  s_waitcnt lgkmcnt(3)
  v_lshlrev_b32 v10, 16, v192
  v_and_b32 v11, 0xffff0000, v192
  v_pk_add_f32 v[96:97], v[96:97], v[10:11]
  v_lshlrev_b32 v10, 16, v193
  v_and_b32 v11, 0xffff0000, v193
  v_pk_add_f32 v[98:99], v[98:99], v[10:11]
  v_lshlrev_b32 v10, 16, v194
  v_and_b32 v11, 0xffff0000, v194
  v_pk_add_f32 v[100:101], v[100:101], v[10:11]
  v_lshlrev_b32 v10, 16, v195
  v_and_b32 v11, 0xffff0000, v195
  v_pk_add_f32 v[102:103], v[102:103], v[10:11]
  s_waitcnt lgkmcnt(2)
  v_lshlrev_b32 v10, 16, v196
  v_and_b32 v11, 0xffff0000, v196
  v_pk_add_f32 v[104:105], v[104:105], v[10:11]
  v_lshlrev_b32 v10, 16, v197
  v_and_b32 v11, 0xffff0000, v197
  v_pk_add_f32 v[106:107], v[106:107], v[10:11]
  v_lshlrev_b32 v10, 16, v198
  v_and_b32 v11, 0xffff0000, v198
  v_pk_add_f32 v[108:109], v[108:109], v[10:11]
  v_lshlrev_b32 v10, 16, v199
  v_and_b32 v11, 0xffff0000, v199
  v_pk_add_f32 v[110:111], v[110:111], v[10:11]
  s_waitcnt lgkmcnt(1)
  v_lshlrev_b32 v10, 16, v200
  v_and_b32 v11, 0xffff0000, v200
  v_pk_add_f32 v[96:97], v[96:97], v[10:11]
  v_lshlrev_b32 v10, 16, v201
  v_and_b32 v11, 0xffff0000, v201
  v_pk_add_f32 v[98:99], v[98:99], v[10:11]
  v_lshlrev_b32 v10, 16, v202
  v_and_b32 v11, 0xffff0000, v202
  v_pk_add_f32 v[100:101], v[100:101], v[10:11]
  v_lshlrev_b32 v10, 16, v203
  v_and_b32 v11, 0xffff0000, v203
  v_pk_add_f32 v[102:103], v[102:103], v[10:11]
  s_waitcnt lgkmcnt(0)
  v_lshlrev_b32 v10, 16, v204
  v_and_b32 v11, 0xffff0000, v204
  v_pk_add_f32 v[104:105], v[104:105], v[10:11]
  v_lshlrev_b32 v10, 16, v205
  v_and_b32 v11, 0xffff0000, v205
  v_pk_add_f32 v[106:107], v[106:107], v[10:11]
  v_lshlrev_b32 v10, 16, v206
  v_and_b32 v11, 0xffff0000, v206
  v_pk_add_f32 v[108:109], v[108:109], v[10:11]
  v_lshlrev_b32 v10, 16, v207
  v_and_b32 v11, 0xffff0000, v207
  v_pk_add_f32 v[110:111], v[110:111], v[10:11]
  s_lshr_b32 s69, s28, 1
  s_cmp_lg_u32 s69, s30
  s_cbranch_scc1 T_no8
  v_add_u32 v9, 0x10000, v2
  ds_read_b128 v[208:211], v9 offset:0
  ds_read_b128 v[212:215], v9 offset:1024
  ds_read_b128 v[216:219], v9 offset:2048
  ds_read_b128 v[220:223], v9 offset:3072
  ds_read_b128 v[224:227], v9 offset:4096
  ds_read_b128 v[228:231], v9 offset:5120
  ds_read_b128 v[232:235], v9 offset:6144
  ds_read_b128 v[236:239], v9 offset:7168
  s_waitcnt lgkmcnt(0)
  v_lshlrev_b32 v240, 16, v208
  v_and_b32 v241, 0xffff0000, v208
  v_lshlrev_b32 v242, 16, v209
  v_and_b32 v243, 0xffff0000, v209
  v_lshlrev_b32 v244, 16, v210
  v_and_b32 v245, 0xffff0000, v210
  v_lshlrev_b32 v246, 16, v211
  v_and_b32 v247, 0xffff0000, v211
  v_lshlrev_b32 v10, 16, v212
  v_and_b32 v11, 0xffff0000, v212
  v_pk_add_f32 v[240:241], v[240:241], v[10:11]
  v_lshlrev_b32 v10, 16, v213
  v_and_b32 v11, 0xffff0000, v213
  v_pk_add_f32 v[242:243], v[242:243], v[10:11]
  v_lshlrev_b32 v10, 16, v214
  v_and_b32 v11, 0xffff0000, v214
  v_pk_add_f32 v[244:245], v[244:245], v[10:11]
  v_lshlrev_b32 v10, 16, v215
  v_and_b32 v11, 0xffff0000, v215
  v_pk_add_f32 v[246:247], v[246:247], v[10:11]
  v_lshlrev_b32 v10, 16, v216
  v_and_b32 v11, 0xffff0000, v216
  v_pk_add_f32 v[240:241], v[240:241], v[10:11]
  v_lshlrev_b32 v10, 16, v217
  v_and_b32 v11, 0xffff0000, v217
  v_pk_add_f32 v[242:243], v[242:243], v[10:11]
  v_lshlrev_b32 v10, 16, v218
  v_and_b32 v11, 0xffff0000, v218
  v_pk_add_f32 v[244:245], v[244:245], v[10:11]
  v_lshlrev_b32 v10, 16, v219
  v_and_b32 v11, 0xffff0000, v219
  v_pk_add_f32 v[246:247], v[246:247], v[10:11]
  v_lshlrev_b32 v10, 16, v220
  v_and_b32 v11, 0xffff0000, v220
  v_pk_add_f32 v[240:241], v[240:241], v[10:11]
  v_lshlrev_b32 v10, 16, v221
  v_and_b32 v11, 0xffff0000, v221
  v_pk_add_f32 v[242:243], v[242:243], v[10:11]
  v_lshlrev_b32 v10, 16, v222
  v_and_b32 v11, 0xffff0000, v222
  v_pk_add_f32 v[244:245], v[244:245], v[10:11]
  v_lshlrev_b32 v10, 16, v223
  v_and_b32 v11, 0xffff0000, v223
  v_pk_add_f32 v[246:247], v[246:247], v[10:11]
  v_lshlrev_b32 v10, 16, v224
  v_and_b32 v11, 0xffff0000, v224
  v_pk_add_f32 v[240:241], v[240:241], v[10:11]
  v_lshlrev_b32 v10, 16, v225
  v_and_b32 v11, 0xffff0000, v225
  v_pk_add_f32 v[242:243], v[242:243], v[10:11]
  v_lshlrev_b32 v10, 16, v226
  v_and_b32 v11, 0xffff0000, v226
  v_pk_add_f32 v[244:245], v[244:245], v[10:11]
  v_lshlrev_b32 v10, 16, v227
  v_and_b32 v11, 0xffff0000, v227
  v_pk_add_f32 v[246:247], v[246:247], v[10:11]
  v_lshlrev_b32 v10, 16, v228
  v_and_b32 v11, 0xffff0000, v228
  v_pk_add_f32 v[240:241], v[240:241], v[10:11]
  v_lshlrev_b32 v10, 16, v229
  v_and_b32 v11, 0xffff0000, v229
  v_pk_add_f32 v[242:243], v[242:243], v[10:11]
  v_lshlrev_b32 v10, 16, v230
  v_and_b32 v11, 0xffff0000, v230
  v_pk_add_f32 v[244:245], v[244:245], v[10:11]
  v_lshlrev_b32 v10, 16, v231
  v_and_b32 v11, 0xffff0000, v231
  v_pk_add_f32 v[246:247], v[246:247], v[10:11]
  v_lshlrev_b32 v10, 16, v232
  v_and_b32 v11, 0xffff0000, v232
  v_pk_add_f32 v[240:241], v[240:241], v[10:11]
  v_lshlrev_b32 v10, 16, v233
  v_and_b32 v11, 0xffff0000, v233
  v_pk_add_f32 v[242:243], v[242:243], v[10:11]
  v_lshlrev_b32 v10, 16, v234
  v_and_b32 v11, 0xffff0000, v234
  v_pk_add_f32 v[244:245], v[244:245], v[10:11]
  v_lshlrev_b32 v10, 16, v235
  v_and_b32 v11, 0xffff0000, v235
  v_pk_add_f32 v[246:247], v[246:247], v[10:11]
  v_lshlrev_b32 v10, 16, v236
  v_and_b32 v11, 0xffff0000, v236
  v_pk_add_f32 v[240:241], v[240:241], v[10:11]
  v_lshlrev_b32 v10, 16, v237
  v_and_b32 v11, 0xffff0000, v237
  v_pk_add_f32 v[242:243], v[242:243], v[10:11]
  v_lshlrev_b32 v10, 16, v238
  v_and_b32 v11, 0xffff0000, v238
  v_pk_add_f32 v[244:245], v[244:245], v[10:11]
  v_lshlrev_b32 v10, 16, v239
  v_and_b32 v11, 0xffff0000, v239
  v_pk_add_f32 v[246:247], v[246:247], v[10:11]
  s_and_b32 s69, s28, 1
  s_mul_i32 s69, s69, 36864
  s_lshr_b32 s70, s28, 1
  s_lshl_b32 s70, s70, 5
  s_add_u32 s69, s69, s70
  s_add_u32 s69, s69, 1024
  v_lshlrev_b32 v12, 16, v168
  v_and_b32 v13, 0xffff0000, v168
  v_lshlrev_b32 v14, 16, v169
  v_and_b32 v15, 0xffff0000, v169
  v_cvt_pk_bf16_f32 v9, v240, v241
  v_lshlrev_b32 v10, 16, v9
  v_and_b32 v11, 0xffff0000, v9
  v_pk_mul_f32 v[10:11], v[10:11], v[12:13]
  v_cvt_pk_bf16_f32 v9, v10, v11
  v_lshlrev_b32 v10, 16, v9
  v_and_b32 v11, 0xffff0000, v9
  v_lshlrev_b32 v16, 16, v164
  v_and_b32 v17, 0xffff0000, v164
  v_pk_add_f32 v[10:11], v[10:11], v[16:17]
  v_cvt_pk_bf16_f32 v20, v10, v11
  v_cvt_pk_bf16_f32 v9, v242, v243
  v_lshlrev_b32 v10, 16, v9
  v_and_b32 v11, 0xffff0000, v9
  v_pk_mul_f32 v[10:11], v[10:11], v[14:15]
  v_cvt_pk_bf16_f32 v9, v10, v11
  v_lshlrev_b32 v10, 16, v9
  v_and_b32 v11, 0xffff0000, v9
  v_lshlrev_b32 v16, 16, v165
  v_and_b32 v17, 0xffff0000, v165
  v_pk_add_f32 v[10:11], v[10:11], v[16:17]
  v_cvt_pk_bf16_f32 v21, v10, v11
  v_cvt_pk_bf16_f32 v9, v244, v245
  v_lshlrev_b32 v10, 16, v9
  v_and_b32 v11, 0xffff0000, v9
  v_pk_mul_f32 v[10:11], v[10:11], v[12:13]
  v_cvt_pk_bf16_f32 v9, v10, v11
  v_lshlrev_b32 v10, 16, v9
  v_and_b32 v11, 0xffff0000, v9
  v_lshlrev_b32 v16, 16, v166
  v_and_b32 v17, 0xffff0000, v166
  v_pk_add_f32 v[10:11], v[10:11], v[16:17]
  v_cvt_pk_bf16_f32 v22, v10, v11
  v_cvt_pk_bf16_f32 v9, v246, v247
  v_lshlrev_b32 v10, 16, v9
  v_and_b32 v11, 0xffff0000, v9
  v_pk_mul_f32 v[10:11], v[10:11], v[14:15]
  v_cvt_pk_bf16_f32 v9, v10, v11
  v_lshlrev_b32 v10, 16, v9
  v_and_b32 v11, 0xffff0000, v9
  v_lshlrev_b32 v16, 16, v167
  v_and_b32 v17, 0xffff0000, v167
  v_pk_add_f32 v[10:11], v[10:11], v[16:17]
  v_cvt_pk_bf16_f32 v23, v10, v11
  s_nop 1
  v_permlane16_swap_b32 v20, v22
  v_permlane16_swap_b32 v21, v23
  s_nop 1
  buffer_store_dwordx4 v[20:23], v49, s[76:79], s69 offen
T_no8:
  s_waitcnt vmcnt(0)
  v_cmp_ne_u32 vcc, s100, v44
  s_cbranch_vccz T_p2ok
  s_mov_b32 s95, 200000
TP2_poll:
  buffer_load_dword v44, v47, s[52:55], 0 offen sc1
  s_waitcnt vmcnt(0)
  v_cmp_ne_u32 vcc, s100, v44
  s_cbranch_vccz TP2_go
  s_sub_u32 s95, s95, 1
  s_cmp_eq_u32 s95, 0
  s_cbranch_scc1 TP2_go
  s_sleep 1
  s_branch TP2_poll
TP2_go:
T_p2ok:
  s_add_u32 s69, s28, 1
  s_and_b32 s69, s69, 7
  s_mul_i32 s69, s69, 2359296
  s_add_u32 s69, s69, s66
  buffer_load_dwordx4 v[128:131], v2, s[16:19], s69 offen offset:0 sc1
  buffer_load_dwordx4 v[132:135], v2, s[16:19], s69 offen offset:1024 sc1
  s_add_u32 s69, s28, 2
  s_and_b32 s69, s69, 7
  s_mul_i32 s69, s69, 2359296
  s_add_u32 s69, s69, s66
  buffer_load_dwordx4 v[136:139], v2, s[16:19], s69 offen offset:0 sc1
  buffer_load_dwordx4 v[140:143], v2, s[16:19], s69 offen offset:1024 sc1
  s_add_u32 s69, s28, 3
  s_and_b32 s69, s69, 7
  s_mul_i32 s69, s69, 2359296
  s_add_u32 s69, s69, s66
  buffer_load_dwordx4 v[144:147], v2, s[16:19], s69 offen offset:0 sc1
  buffer_load_dwordx4 v[148:151], v2, s[16:19], s69 offen offset:1024 sc1
  s_waitcnt vmcnt(5)
  v_lshlrev_b32 v10, 16, v128
  v_and_b32 v11, 0xffff0000, v128
  v_pk_add_f32 v[96:97], v[96:97], v[10:11]
  v_lshlrev_b32 v10, 16, v129
  v_and_b32 v11, 0xffff0000, v129
  v_pk_add_f32 v[98:99], v[98:99], v[10:11]
  v_lshlrev_b32 v10, 16, v130
  v_and_b32 v11, 0xffff0000, v130
  v_pk_add_f32 v[100:101], v[100:101], v[10:11]
  v_lshlrev_b32 v10, 16, v131
  v_and_b32 v11, 0xffff0000, v131
  v_pk_add_f32 v[102:103], v[102:103], v[10:11]
  s_waitcnt vmcnt(4)
  v_lshlrev_b32 v10, 16, v132
  v_and_b32 v11, 0xffff0000, v132
  v_pk_add_f32 v[104:105], v[104:105], v[10:11]
  v_lshlrev_b32 v10, 16, v133
  v_and_b32 v11, 0xffff0000, v133
  v_pk_add_f32 v[106:107], v[106:107], v[10:11]
  v_lshlrev_b32 v10, 16, v134
  v_and_b32 v11, 0xffff0000, v134
  v_pk_add_f32 v[108:109], v[108:109], v[10:11]
  v_lshlrev_b32 v10, 16, v135
  v_and_b32 v11, 0xffff0000, v135
  v_pk_add_f32 v[110:111], v[110:111], v[10:11]
  s_waitcnt vmcnt(3)
  v_lshlrev_b32 v10, 16, v136
  v_and_b32 v11, 0xffff0000, v136
  v_pk_add_f32 v[96:97], v[96:97], v[10:11]
  v_lshlrev_b32 v10, 16, v137
  v_and_b32 v11, 0xffff0000, v137
  v_pk_add_f32 v[98:99], v[98:99], v[10:11]
  v_lshlrev_b32 v10, 16, v138
  v_and_b32 v11, 0xffff0000, v138
  v_pk_add_f32 v[100:101], v[100:101], v[10:11]
  v_lshlrev_b32 v10, 16, v139
  v_and_b32 v11, 0xffff0000, v139
  v_pk_add_f32 v[102:103], v[102:103], v[10:11]
  s_waitcnt vmcnt(2)
  v_lshlrev_b32 v10, 16, v140
  v_and_b32 v11, 0xffff0000, v140
  v_pk_add_f32 v[104:105], v[104:105], v[10:11]
  v_lshlrev_b32 v10, 16, v141
  v_and_b32 v11, 0xffff0000, v141
  v_pk_add_f32 v[106:107], v[106:107], v[10:11]
  v_lshlrev_b32 v10, 16, v142
  v_and_b32 v11, 0xffff0000, v142
  v_pk_add_f32 v[108:109], v[108:109], v[10:11]
  v_lshlrev_b32 v10, 16, v143
  v_and_b32 v11, 0xffff0000, v143
  v_pk_add_f32 v[110:111], v[110:111], v[10:11]
  s_waitcnt vmcnt(1)
  v_lshlrev_b32 v10, 16, v144
  v_and_b32 v11, 0xffff0000, v144
  v_pk_add_f32 v[96:97], v[96:97], v[10:11]
  v_lshlrev_b32 v10, 16, v145
  v_and_b32 v11, 0xffff0000, v145
  v_pk_add_f32 v[98:99], v[98:99], v[10:11]
  v_lshlrev_b32 v10, 16, v146
  v_and_b32 v11, 0xffff0000, v146
  v_pk_add_f32 v[100:101], v[100:101], v[10:11]
  v_lshlrev_b32 v10, 16, v147
  v_and_b32 v11, 0xffff0000, v147
  v_pk_add_f32 v[102:103], v[102:103], v[10:11]
  s_waitcnt vmcnt(0)
  v_lshlrev_b32 v10, 16, v148
  v_and_b32 v11, 0xffff0000, v148
  v_pk_add_f32 v[104:105], v[104:105], v[10:11]
  v_lshlrev_b32 v10, 16, v149
  v_and_b32 v11, 0xffff0000, v149
  v_pk_add_f32 v[106:107], v[106:107], v[10:11]
  v_lshlrev_b32 v10, 16, v150
  v_and_b32 v11, 0xffff0000, v150
  v_pk_add_f32 v[108:109], v[108:109], v[10:11]
  v_lshlrev_b32 v10, 16, v151
  v_and_b32 v11, 0xffff0000, v151
  v_pk_add_f32 v[110:111], v[110:111], v[10:11]
  s_lshl_b32 s69, s28, 2
  s_add_u32 s69, s69, s30
  s_lshl_b32 s69, s69, 5
  s_add_u32 s70, s69, 0
  v_lshlrev_b32 v12, 16, v160
  v_and_b32 v13, 0xffff0000, v160
  v_lshlrev_b32 v14, 16, v161
  v_and_b32 v15, 0xffff0000, v161
  v_cvt_pk_bf16_f32 v9, v96, v97
  v_lshlrev_b32 v10, 16, v9
  v_and_b32 v11, 0xffff0000, v9
  v_pk_mul_f32 v[10:11], v[10:11], v[12:13]
  v_cvt_pk_bf16_f32 v9, v10, v11
  v_lshlrev_b32 v10, 16, v9
  v_and_b32 v11, 0xffff0000, v9
  v_lshlrev_b32 v16, 16, v152
  v_and_b32 v17, 0xffff0000, v152
  v_pk_add_f32 v[10:11], v[10:11], v[16:17]
  v_cvt_pk_bf16_f32 v24, v10, v11
  v_cvt_pk_bf16_f32 v9, v98, v99
  v_lshlrev_b32 v10, 16, v9
  v_and_b32 v11, 0xffff0000, v9
  v_pk_mul_f32 v[10:11], v[10:11], v[14:15]
  v_cvt_pk_bf16_f32 v9, v10, v11
  v_lshlrev_b32 v10, 16, v9
  v_and_b32 v11, 0xffff0000, v9
  v_lshlrev_b32 v16, 16, v153
  v_and_b32 v17, 0xffff0000, v153
  v_pk_add_f32 v[10:11], v[10:11], v[16:17]
  v_cvt_pk_bf16_f32 v25, v10, v11
  v_cvt_pk_bf16_f32 v9, v100, v101
  v_lshlrev_b32 v10, 16, v9
  v_and_b32 v11, 0xffff0000, v9
  v_pk_mul_f32 v[10:11], v[10:11], v[12:13]
  v_cvt_pk_bf16_f32 v9, v10, v11
  v_lshlrev_b32 v10, 16, v9
  v_and_b32 v11, 0xffff0000, v9
  v_lshlrev_b32 v16, 16, v154
  v_and_b32 v17, 0xffff0000, v154
  v_pk_add_f32 v[10:11], v[10:11], v[16:17]
  v_cvt_pk_bf16_f32 v26, v10, v11
  v_cvt_pk_bf16_f32 v9, v102, v103
  v_lshlrev_b32 v10, 16, v9
  v_and_b32 v11, 0xffff0000, v9
  v_pk_mul_f32 v[10:11], v[10:11], v[14:15]
  v_cvt_pk_bf16_f32 v9, v10, v11
  v_lshlrev_b32 v10, 16, v9
  v_and_b32 v11, 0xffff0000, v9
  v_lshlrev_b32 v16, 16, v155
  v_and_b32 v17, 0xffff0000, v155
  v_pk_add_f32 v[10:11], v[10:11], v[16:17]
  v_cvt_pk_bf16_f32 v27, v10, v11
  s_nop 1
  v_permlane16_swap_b32 v24, v26
  v_permlane16_swap_b32 v25, v27
  s_nop 1
  buffer_store_dwordx4 v[24:27], v49, s[76:79], s70 offen
  s_add_u32 s70, s69, 36864
  v_lshlrev_b32 v12, 16, v160
  v_and_b32 v13, 0xffff0000, v160
  v_lshlrev_b32 v14, 16, v161
  v_and_b32 v15, 0xffff0000, v161
  v_cvt_pk_bf16_f32 v9, v104, v105
  v_lshlrev_b32 v10, 16, v9
  v_and_b32 v11, 0xffff0000, v9
  v_pk_mul_f32 v[10:11], v[10:11], v[12:13]
  v_cvt_pk_bf16_f32 v9, v10, v11
  v_lshlrev_b32 v10, 16, v9
  v_and_b32 v11, 0xffff0000, v9
  v_lshlrev_b32 v16, 16, v156
  v_and_b32 v17, 0xffff0000, v156
  v_pk_add_f32 v[10:11], v[10:11], v[16:17]
  v_cvt_pk_bf16_f32 v28, v10, v11
  v_cvt_pk_bf16_f32 v9, v106, v107
  v_lshlrev_b32 v10, 16, v9
  v_and_b32 v11, 0xffff0000, v9
  v_pk_mul_f32 v[10:11], v[10:11], v[14:15]
  v_cvt_pk_bf16_f32 v9, v10, v11
  v_lshlrev_b32 v10, 16, v9
  v_and_b32 v11, 0xffff0000, v9
  v_lshlrev_b32 v16, 16, v157
  v_and_b32 v17, 0xffff0000, v157
  v_pk_add_f32 v[10:11], v[10:11], v[16:17]
  v_cvt_pk_bf16_f32 v29, v10, v11
  v_cvt_pk_bf16_f32 v9, v108, v109
  v_lshlrev_b32 v10, 16, v9
  v_and_b32 v11, 0xffff0000, v9
  v_pk_mul_f32 v[10:11], v[10:11], v[12:13]
  v_cvt_pk_bf16_f32 v9, v10, v11
  v_lshlrev_b32 v10, 16, v9
  v_and_b32 v11, 0xffff0000, v9
  v_lshlrev_b32 v16, 16, v158
  v_and_b32 v17, 0xffff0000, v158
  v_pk_add_f32 v[10:11], v[10:11], v[16:17]
  v_cvt_pk_bf16_f32 v30, v10, v11
  v_cvt_pk_bf16_f32 v9, v110, v111
  v_lshlrev_b32 v10, 16, v9
  v_and_b32 v11, 0xffff0000, v9
  v_pk_mul_f32 v[10:11], v[10:11], v[14:15]
  v_cvt_pk_bf16_f32 v9, v10, v11
  v_lshlrev_b32 v10, 16, v9
  v_and_b32 v11, 0xffff0000, v9
  v_lshlrev_b32 v16, 16, v159
  v_and_b32 v17, 0xffff0000, v159
  v_pk_add_f32 v[10:11], v[10:11], v[16:17]
  v_cvt_pk_bf16_f32 v31, v10, v11
  s_nop 1
  v_permlane16_swap_b32 v28, v30
  v_permlane16_swap_b32 v29, v31
  s_nop 1
  buffer_store_dwordx4 v[28:31], v49, s[76:79], s70 offen
  s_endpgm
MG_end:
.section .rodata,"a"
.p2align 6
.amdhsa_kernel mega_kernel
  .amdhsa_next_free_vgpr 512
  .amdhsa_next_free_sgpr 102
  .amdhsa_accum_offset 256
  .amdhsa_group_segment_fixed_size 0
  .amdhsa_kernarg_size 120
  .amdhsa_user_sgpr_count 2
  .amdhsa_user_sgpr_kernarg_segment_ptr 1
  .amdhsa_system_sgpr_workgroup_id_x 1
  .amdhsa_float_denorm_mode_32 3
  .amdhsa_float_denorm_mode_16_64 3
.end_amdhsa_kernel
```
